```python
import torch

def _softmax(x, axis=-1):
    return torch.softmax(x, dim=axis)
def _gelu(x):
    return torch.nn.functional.gelu(x, approximate="tanh")
def _silu(x):
    return torch.nn.functional.silu(x)
def _sigmoid(x):
    return torch.sigmoid(x)
def _layernorm(x, axis=-1, eps=1e-5):
    m = x.mean(dim=axis, keepdim=True)
    v = x.var(dim=axis, keepdim=True, unbiased=False)
    return (x - m) / torch.sqrt(v + eps)
def _scatter_add(tgt, idx, src, axis=0):
    return tgt.clone().index_add_(axis, idx, src)
def _segment_sum(src, seg, n):
    out = torch.zeros((n,) + src.shape[1:], dtype=src.dtype)
    return out.index_add_(0, seg, src)
def _pad(x, pw):
    flat = tuple(v for pair in reversed(pw) for v in pair)
    return torch.nn.functional.pad(x, flat)

kernel_name = 'gated_mix__mha_block__glu_gated_glu__prompt'

def setup_inputs():

    _w = (lambda a: (lambda t: t.to(torch.bfloat16) if t.is_floating_point() else t)(torch.as_tensor(a)))
    def _A_setup():
        B, S, D, H = 1, 2048, 640, 32
        return {
            "x": _w((lambda *s: torch.randn(*s, dtype=torch.bfloat16) * 0.05)(B, S, D)),
            "wqkv": _w((lambda *s: torch.randn(*s, dtype=torch.bfloat16) * 0.8)(D, 3 * D)),
            "wo": _w((lambda *s: torch.randn(*s, dtype=torch.bfloat16) * 0.1)(D, D)),
        }
    _A_in = _A_setup()

    def _B_setup():
        B, S, D, F = 1, 2048, 640, 1728
        return {
            "x": _w((lambda *s: torch.randn(*s, dtype=torch.bfloat16) * 0.05)(B, S, D)),
            "w_gate": _w((lambda *s: torch.randn(*s, dtype=torch.bfloat16) * 0.8)(D, F)),
            "w_up": _w((lambda *s: torch.randn(*s, dtype=torch.bfloat16) * 0.05)(D, F)),
            "w_down": _w((lambda *s: torch.randn(*s, dtype=torch.bfloat16) * 0.05)(F, D)),
        }
    _B_in = _B_setup()

    return {
        "A_x": _A_in["x"],
        "A_wqkv": _A_in["wqkv"],
        "A_wo": _A_in["wo"],
        "B_x": _B_in["x"],
        "B_w_gate": _B_in["w_gate"],
        "B_w_up": _B_in["w_up"],
        "B_w_down": _B_in["w_down"],
        "gate_w": _w((lambda *s: torch.randn(*s, dtype=torch.bfloat16) * 0.05)(640) * 16.0),
    }

def reference(A_x, A_wqkv, A_wo, B_x, B_w_gate, B_w_up, B_w_down, gate_w):
    def _A_ref(x, wqkv, wo):
        B, S, D = x.shape
        H = 32
        Dh = D // H
        qkv = (lambda x, *d: x.permute(*d))((x @ wqkv).reshape(B, S, 3, H, Dh), 2, 0, 3, 1, 4)
        q, k, v = qkv[0], qkv[1], qkv[2]
        scores = torch.einsum("bhqd,bhkd->bhqk", q, k) * (Dh ** -0.5)
        p = _softmax(scores, axis=-1)
        o = torch.einsum("bhqk,bhkd->bhqd", p, v)
        return (lambda x, *d: x.permute(*d))(o, 0, 2, 1, 3).reshape(B, S, D) @ wo

    def _B_ref(x, w_gate, w_up, w_down):
        g = torch.einsum("bsd,df->bsf", x, w_gate)
        u = torch.einsum("bsd,df->bsf", x, w_up)
        h = _sigmoid(g) * u
        return torch.einsum("bsf,fd->bsd", h, w_down)

    x = A_x
    g = _sigmoid((x * gate_w).sum(-1, keepdims=True))
    a = _A_ref(x, A_wqkv, A_wo)
    b = _B_ref(x, B_w_gate, B_w_up, B_w_down)
    return g * a + (1 - g) * b
```

```asm
; @launch kernel=k1_kernel grid=(256,1,1) block=(768,1,1) lds=147456
; @launch kernel=k2_kernel grid=(256,1,1) block=(768,1,1) lds=160832
.amdgcn_target "amdgcn-amd-amdhsa--gfx950"
.text
.globl k1_kernel
.p2align 8
.type k1_kernel,@function
k1_kernel:
    s_cmp_ge_u32 s2, 256
    s_cbranch_scc1 k1_kernel_END
    s_load_dwordx4 s[4:7], s[0:1], 0
    s_load_dwordx2 s[10:11], s[0:1], 56
    s_load_dwordx4 s[12:15], s[0:1], 32
    s_load_dwordx2 s[16:17], s[0:1], 80
    s_load_dwordx2 s[8:9], s[0:1], 16
    s_load_dwordx2 s[54:55], s[0:1], 48
    v_and_b32 v1, 63, v0
    v_lshrrev_b32 v2, 6, v0
    s_and_b32 s18, s2, 7
    s_lshr_b32 s19, s2, 3
    v_readfirstlane_b32 s22, v2
    s_and_b32 s26, s19, 1
    s_lshr_b32 s21, s19, 1
    s_mul_i32 s27, s26, 6
    s_add_u32 s27, s27, s18
    s_lshl_b32 s20, s18, 1
    s_add_u32 s20, s20, s26
    s_cmp_lt_u32 s18, 6
    s_cselect_b32 s20, s27, s20
    v_lshrrev_b32 v3, 3, v1
    v_lshrrev_b32 v4, 4, v1
    s_lshl_b32 s26, s22, 2
    v_add_u32 v4, s26, v4
    v_xor_b32 v4, v4, v1
    v_and_b32 v4, 7, v4
    s_lshl_b32 s26, s21, 7
    s_lshl_b32 s27, s22, 3
    s_add_u32 s26, s26, s27
    v_add_u32 v3, s26, v3
    v_mul_u32_u24 v3, 1280, v3
    v_lshl_add_u32 v10, v4, 4, v3
    s_lshl_b32 s45, s22, 10
    s_add_u32 s45, s45, 98304
    s_and_b32 s23, s22, 1
    s_lshr_b32 s24, s22, 1
    s_mov_b32 s25, 0
    s_cmp_eq_u32 s20, 15
    s_cbranch_scc1 k1_kernel_GATE
    s_lshl_b32 s44, s22, 11
    s_cmp_lt_u32 s20, 6
    s_cbranch_scc0 k1_kernel_GLU
    s_lshl_b32 s26, s22, 7
    s_cmp_lt_u32 s22, 8
    s_cbranch_scc1 k1_kernel_QW
    s_add_u32 s26, s22, 8
    s_lshl_b32 s44, s26, 10
    s_lshl_b32 s26, s26, 6
    s_and_b32 s25, s24, 1
    s_mov_b32 s24, 4
k1_kernel_QW:
    s_mul_i32 s29, s20, 640
    v_add_u32 v3, s26, v1
    v_mul_u32_u24 v4, 1639, v3
    v_lshrrev_b32 v4, 16, v4
    v_mul_u32_u24 v5, 40, v4
    v_sub_u32 v5, v3, v5
    v_lshrrev_b32 v6, 1, v4
    v_and_b32 v6, 4, v6
    v_and_or_b32 v6, v4, 2, v6
    v_xor_b32 v5, v5, v6
    v_mul_u32_u24 v4, 3840, v4
    v_lshl_add_u32 v4, v5, 4, v4
    v_add_u32 v11, s29, v4
    s_add_u32 s26, s26, 64
    v_add_u32 v3, s26, v1
    v_mul_u32_u24 v4, 1639, v3
    v_lshrrev_b32 v4, 16, v4
    v_mul_u32_u24 v5, 40, v4
    v_sub_u32 v5, v3, v5
    v_lshrrev_b32 v6, 1, v4
    v_and_b32 v6, 4, v6
    v_and_or_b32 v6, v4, 2, v6
    v_xor_b32 v5, v5, v6
    v_mul_u32_u24 v4, 3840, v4
    v_lshl_add_u32 v4, v5, 4, v4
    v_add_u32 v12, s29, v4
    s_add_u32 s26, s26, 64
    s_mov_b32 s48, 122880
    s_waitcnt lgkmcnt(0)
    s_mov_b32 s36, s6
    s_and_b32 s37, s7, 0xffff
    s_mov_b32 s38, 2457600
    s_mov_b32 s39, 0x20000
    s_branch k1_kernel_DEC
k1_kernel_GLU:
    s_cmp_lt_u32 s22, 6
    s_cselect_b32 s27, 0, 6
    s_sub_u32 s26, s22, s27
    s_lshl_b32 s26, s26, 7
    s_sub_u32 s29, s20, 6
    s_mul_i32 s29, s29, 384
    v_add_u32 v3, s26, v1
    v_mul_u32_u24 v4, 2731, v3
    v_lshrrev_b32 v4, 16, v4
    v_mul_u32_u24 v5, 24, v4
    v_sub_u32 v5, v3, v5
    v_lshrrev_b32 v6, 1, v4
    v_and_b32 v6, 4, v6
    v_and_or_b32 v6, v4, 2, v6
    v_xor_b32 v5, v5, v6
    v_mul_u32_u24 v4, 3456, v4
    v_lshl_add_u32 v4, v5, 4, v4
    v_add_u32 v11, s29, v4
    s_add_u32 s26, s26, 64
    v_add_u32 v3, s26, v1
    v_mul_u32_u24 v4, 2731, v3
    v_lshrrev_b32 v4, 16, v4
    v_mul_u32_u24 v5, 24, v4
    v_sub_u32 v5, v3, v5
    v_lshrrev_b32 v6, 1, v4
    v_and_b32 v6, 4, v6
    v_and_or_b32 v6, v4, 2, v6
    v_xor_b32 v5, v5, v6
    v_mul_u32_u24 v4, 3456, v4
    v_lshl_add_u32 v4, v5, 4, v4
    v_add_u32 v12, s29, v4
    s_add_u32 s26, s26, 64
    s_mov_b32 s48, 110592
    s_waitcnt lgkmcnt(0)
    s_cmp_lt_u32 s22, 6
    s_cselect_b32 s36, s12, s14
    s_cselect_b32 s37, s13, s15
    s_and_b32 s37, s37, 0xffff
    s_mov_b32 s38, 2211840
    s_mov_b32 s39, 0x20000
k1_kernel_DEC:
    s_mov_b32 s32, s4
    s_and_b32 s33, s5, 0xffff
    s_mov_b32 s34, 2621440
    s_mov_b32 s35, 0x20000
    s_mov_b32 s47, 0
    s_cmp_lt_u32 s22, 8
    s_cbranch_scc0 k1_kernel_PRO_NX
    s_add_u32 m0, s45, 0
    s_mov_b32 s46, 0
    buffer_load_dwordx4 v10, s[32:35], s46 offen lds
    s_add_u32 m0, s44, 0
    s_nop 0
    buffer_load_dwordx4 v11, s[36:39], s47 offen lds
    s_add_u32 m0, s44, 1024
    s_nop 0
    buffer_load_dwordx4 v12, s[36:39], s47 offen lds
    s_add_u32 s47, s47, s48
    s_add_u32 m0, s45, 8192
    s_mov_b32 s46, 81920
    buffer_load_dwordx4 v10, s[32:35], s46 offen lds
    s_add_u32 m0, s44, 24576
    s_nop 0
    buffer_load_dwordx4 v11, s[36:39], s47 offen lds
    s_add_u32 m0, s44, 25600
    s_nop 0
    buffer_load_dwordx4 v12, s[36:39], s47 offen lds
    s_add_u32 s47, s47, s48
    s_add_u32 m0, s45, 16384
    s_mov_b32 s46, 128
    buffer_load_dwordx4 v10, s[32:35], s46 offen lds
    s_add_u32 m0, s44, 49152
    s_nop 0
    buffer_load_dwordx4 v11, s[36:39], s47 offen lds
    s_add_u32 m0, s44, 50176
    s_nop 0
    buffer_load_dwordx4 v12, s[36:39], s47 offen lds
    s_add_u32 s47, s47, s48
    s_add_u32 m0, s45, 24576
    s_mov_b32 s46, 82048
    buffer_load_dwordx4 v10, s[32:35], s46 offen lds
    s_branch k1_kernel_PRO_D
k1_kernel_PRO_NX:
    s_cmp_lt_u32 s20, 6
    s_cbranch_scc1 k1_kernel_PRO_H
    s_add_u32 m0, s44, 0
    s_nop 0
    buffer_load_dwordx4 v11, s[36:39], s47 offen lds
    s_add_u32 m0, s44, 1024
    s_nop 0
    buffer_load_dwordx4 v12, s[36:39], s47 offen lds
    s_add_u32 s47, s47, s48
    s_add_u32 m0, s44, 24576
    s_nop 0
    buffer_load_dwordx4 v11, s[36:39], s47 offen lds
    s_add_u32 m0, s44, 25600
    s_nop 0
    buffer_load_dwordx4 v12, s[36:39], s47 offen lds
    s_add_u32 s47, s47, s48
    s_add_u32 m0, s44, 49152
    s_nop 0
    buffer_load_dwordx4 v11, s[36:39], s47 offen lds
    s_add_u32 m0, s44, 50176
    s_nop 0
    buffer_load_dwordx4 v12, s[36:39], s47 offen lds
    s_add_u32 s47, s47, s48
    s_branch k1_kernel_PRO_D
k1_kernel_PRO_H:
    s_add_u32 m0, s44, 0
    s_nop 0
    buffer_load_dwordx4 v11, s[36:39], s47 offen lds
    s_add_u32 s47, s47, s48
    s_add_u32 m0, s44, 24576
    s_nop 0
    buffer_load_dwordx4 v11, s[36:39], s47 offen lds
    s_add_u32 s47, s47, s48
    s_add_u32 m0, s44, 49152
    s_nop 0
    buffer_load_dwordx4 v11, s[36:39], s47 offen lds
    s_add_u32 s47, s47, s48
k1_kernel_PRO_D:
    v_and_b32 v3, 15, v1
    v_lshrrev_b32 v4, 4, v1
    v_lshrrev_b32 v5, 1, v3
    v_xor_b32 v5, v5, v4
    v_lshlrev_b32 v5, 4, v5
    v_lshl_add_u32 v5, v3, 7, v5
    s_lshl_b32 s26, s23, 13
    s_lshl_b32 s27, s25, 12
    s_add_u32 s26, s26, s27
    s_add_u32 s26, s26, 98304
    v_add_u32 v13, s26, v5
    v_xor_b32 v14, 64, v13
    v_lshrrev_b32 v5, 2, v3
    v_lshl_add_u32 v6, v4, 3, v5
    v_lshrrev_b32 v5, 1, v5
    v_and_b32 v7, 1, v4
    v_lshl_or_b32 v5, v7, 1, v5
    v_and_b32 v7, 3, v3
    v_lshlrev_b32 v7, 3, v7
    s_cmp_lt_u32 s20, 6
    s_cbranch_scc0 k1_kernel_RA_GLU
    v_mul_u32_u24 v6, 640, v6
    v_add_u32 v6, v6, v7
    s_lshl_b32 s26, s24, 7
    v_add_u32 v6, s26, v6
    v_xor_b32 v8, 0, v5
    v_lshl_add_u32 v15, v8, 5, v6
    v_xor_b32 v8, 1, v5
    v_lshl_add_u32 v16, v8, 5, v6
    v_xor_b32 v8, 2, v5
    v_lshl_add_u32 v17, v8, 5, v6
    v_xor_b32 v8, 3, v5
    v_lshl_add_u32 v18, v8, 5, v6
    s_branch k1_kernel_RA
k1_kernel_RA_GLU:
    v_mul_u32_u24 v6, 384, v6
    v_add_u32 v6, v6, v7
    s_lshl_b32 s26, s24, 1
    s_add_u32 s26, s26, 0
    s_and_b32 s27, s26, 3
    s_andn2_b32 s26, s26, 3
    s_lshl_b32 s26, s26, 5
    v_xor_b32 v8, s27, v5
    v_lshl_add_u32 v8, v8, 5, v6
    v_add_u32 v15, s26, v8
    v_add_u32 v17, 12288, v15
    s_lshl_b32 s26, s24, 1
    s_add_u32 s26, s26, 1
    s_and_b32 s27, s26, 3
    s_andn2_b32 s26, s26, 3
    s_lshl_b32 s26, s26, 5
    v_xor_b32 v8, s27, v5
    v_lshl_add_u32 v8, v8, 5, v6
    v_add_u32 v16, s26, v8
    v_add_u32 v18, 12288, v16
k1_kernel_RA:
    v_add_u32 v19, 49152, v15
    v_add_u32 v20, 49152, v16
    v_add_u32 v21, 49152, v17
    v_add_u32 v22, 49152, v18
    s_mov_b32 s40, s16
    s_and_b32 s41, s17, 0xffff
    s_mov_b32 s42, 268435456
    s_mov_b32 s43, 0x20000
    v_mov_b32 v155, 0
    v_mov_b32 v156, 0
    v_mov_b32 v157, 0
    v_mov_b32 v158, 0
    v_mov_b32 v159, 0
    v_mov_b32 v160, 0
    v_mov_b32 v161, 0
    v_mov_b32 v162, 0
    v_mov_b32 v163, 0
    v_mov_b32 v164, 0
    v_mov_b32 v165, 0
    v_mov_b32 v166, 0
    v_mov_b32 v167, 0
    s_cmp_lt_u32 s20, 6
    s_cbranch_scc0 k1_kernel_NOEA
    s_cmp_lt_u32 s20, 2
    s_mov_b32 s50, 163840
    s_cselect_b32 s50, 81920, s50
    s_mov_b32 s51, 2560
    s_cselect_b32 s51, 1280, s51
    s_mov_b32 s49, 2621440
    s_cselect_b32 s49, 0, s49
    s_mov_b32 s52, 0x3f800000
    s_cselect_b32 s52, 0x3ea52b5c, s52
    s_cmp_lt_u32 s20, 4
    s_cselect_b32 s49, s49, 2622720
    v_add_u32 v3, 0, v1
    v_mul_u32_u24 v4, 820, v3
    v_lshrrev_b32 v4, 16, v4
    v_mul_u32_u24 v5, 80, v4
    v_sub_u32 v5, v3, v5
    v_mul_lo_u32 v4, v4, s51
    v_lshl_add_u32 v163, v5, 4, v4
    v_add_u32 v3, 64, v1
    v_mul_u32_u24 v4, 820, v3
    v_lshrrev_b32 v4, 16, v4
    v_mul_u32_u24 v5, 80, v4
    v_sub_u32 v5, v3, v5
    v_mul_lo_u32 v4, v4, s51
    v_lshl_add_u32 v164, v5, 4, v4
    v_add_u32 v3, 128, v1
    v_mul_u32_u24 v4, 820, v3
    v_lshrrev_b32 v4, 16, v4
    v_mul_u32_u24 v5, 80, v4
    v_sub_u32 v5, v3, v5
    v_mul_lo_u32 v4, v4, s51
    v_lshl_add_u32 v165, v5, 4, v4
    v_add_u32 v3, 192, v1
    v_mul_u32_u24 v4, 820, v3
    v_lshrrev_b32 v4, 16, v4
    v_mul_u32_u24 v5, 80, v4
    v_sub_u32 v5, v3, v5
    v_mul_lo_u32 v4, v4, s51
    v_lshl_add_u32 v166, v5, 4, v4
    v_add_u32 v3, 256, v1
    v_mul_u32_u24 v4, 820, v3
    v_lshrrev_b32 v4, 16, v4
    v_mul_u32_u24 v5, 80, v4
    v_sub_u32 v5, v3, v5
    v_mul_lo_u32 v4, v4, s51
    v_lshl_add_u32 v167, v5, 4, v4
    s_cmp_lt_u32 s20, 4
    s_cbranch_scc0 k1_kernel_EAV
    v_and_b32 v2, 15, v1
    v_lshrrev_b32 v3, 4, v1
    s_lshl_b32 s26, s24, 4
    v_add_u32 v3, s26, v3
    s_mul_i32 s27, s23, 2560
    s_mul_i32 s28, s25, 1280
    s_add_u32 s27, s27, s28
    v_add_u32 v4, 0, v3
    v_mul_u32_u24 v5, 13108, v4
    v_lshrrev_b32 v5, 16, v5
    v_mul_u32_u24 v6, 5, v5
    v_sub_u32 v6, v4, v6
    v_mul_u32_u24 v5, 5120, v5
    v_add_u32 v5, s27, v5
    v_lshrrev_b32 v7, 1, v6
    v_lshlrev_b32 v7, 9, v7
    v_and_b32 v8, 1, v6
    v_lshl_add_u32 v7, v8, 3, v7
    v_lshl_add_u32 v7, v2, 4, v7
    v_lshlrev_b32 v8, 3, v2
    v_add_u32 v8, 1024, v8
    v_cmp_eq_u32 vcc, 4, v6
    v_mov_b32 v9, 256
    v_mov_b32 v4, 128
    v_cndmask_b32 v7, v7, v8, vcc
    v_cndmask_b32 v9, v9, v4, vcc
    v_add_u32 v155, v5, v7
    v_add_u32 v159, v155, v9
    v_add_u32 v4, 4, v3
    v_mul_u32_u24 v5, 13108, v4
    v_lshrrev_b32 v5, 16, v5
    v_mul_u32_u24 v6, 5, v5
    v_sub_u32 v6, v4, v6
    v_mul_u32_u24 v5, 5120, v5
    v_add_u32 v5, s27, v5
    v_lshrrev_b32 v7, 1, v6
    v_lshlrev_b32 v7, 9, v7
    v_and_b32 v8, 1, v6
    v_lshl_add_u32 v7, v8, 3, v7
    v_lshl_add_u32 v7, v2, 4, v7
    v_lshlrev_b32 v8, 3, v2
    v_add_u32 v8, 1024, v8
    v_cmp_eq_u32 vcc, 4, v6
    v_mov_b32 v9, 256
    v_mov_b32 v4, 128
    v_cndmask_b32 v7, v7, v8, vcc
    v_cndmask_b32 v9, v9, v4, vcc
    v_add_u32 v156, v5, v7
    v_add_u32 v160, v156, v9
    v_add_u32 v4, 8, v3
    v_mul_u32_u24 v5, 13108, v4
    v_lshrrev_b32 v5, 16, v5
    v_mul_u32_u24 v6, 5, v5
    v_sub_u32 v6, v4, v6
    v_mul_u32_u24 v5, 5120, v5
    v_add_u32 v5, s27, v5
    v_lshrrev_b32 v7, 1, v6
    v_lshlrev_b32 v7, 9, v7
    v_and_b32 v8, 1, v6
    v_lshl_add_u32 v7, v8, 3, v7
    v_lshl_add_u32 v7, v2, 4, v7
    v_lshlrev_b32 v8, 3, v2
    v_add_u32 v8, 1024, v8
    v_cmp_eq_u32 vcc, 4, v6
    v_mov_b32 v9, 256
    v_mov_b32 v4, 128
    v_cndmask_b32 v7, v7, v8, vcc
    v_cndmask_b32 v9, v9, v4, vcc
    v_add_u32 v157, v5, v7
    v_add_u32 v161, v157, v9
    v_add_u32 v4, 12, v3
    v_mul_u32_u24 v5, 13108, v4
    v_lshrrev_b32 v5, 16, v5
    v_mul_u32_u24 v6, 5, v5
    v_sub_u32 v6, v4, v6
    v_mul_u32_u24 v5, 5120, v5
    v_add_u32 v5, s27, v5
    v_lshrrev_b32 v7, 1, v6
    v_lshlrev_b32 v7, 9, v7
    v_and_b32 v8, 1, v6
    v_lshl_add_u32 v7, v8, 3, v7
    v_lshl_add_u32 v7, v2, 4, v7
    v_lshlrev_b32 v8, 3, v2
    v_add_u32 v8, 1024, v8
    v_cmp_eq_u32 vcc, 4, v6
    v_mov_b32 v9, 256
    v_mov_b32 v4, 128
    v_cndmask_b32 v7, v7, v8, vcc
    v_cndmask_b32 v9, v9, v4, vcc
    v_add_u32 v158, v5, v7
    v_add_u32 v162, v158, v9
    s_branch k1_kernel_NOEA
k1_kernel_EAV:
    v_and_b32 v2, 15, v1
    v_lshrrev_b32 v3, 4, v1
    s_lshl_b32 s26, s24, 6
    v_add_u32 v2, s26, v2
    v_and_b32 v4, 1, v3
    v_mul_u32_u24 v4, 320, v4
    v_lshrrev_b32 v3, 1, v3
    v_lshl_add_u32 v3, v3, 3, v4
    s_mul_i32 s27, s23, 2560
    s_mul_i32 s28, s25, 1280
    s_add_u32 s27, s27, s28
    v_add_u32 v3, s27, v3
    v_add_u32 v4, 0, v2
    v_mul_u32_u24 v5, 3277, v4
    v_lshrrev_b32 v5, 16, v5
    v_mul_u32_u24 v6, 20, v5
    v_sub_u32 v6, v4, v6
    v_mul_u32_u24 v5, 5120, v5
    v_lshl_add_u32 v5, v6, 4, v5
    v_add_u32 v155, v5, v3
    v_add_u32 v4, 16, v2
    v_mul_u32_u24 v5, 3277, v4
    v_lshrrev_b32 v5, 16, v5
    v_mul_u32_u24 v6, 20, v5
    v_sub_u32 v6, v4, v6
    v_mul_u32_u24 v5, 5120, v5
    v_lshl_add_u32 v5, v6, 4, v5
    v_add_u32 v156, v5, v3
    v_add_u32 v4, 32, v2
    v_mul_u32_u24 v5, 3277, v4
    v_lshrrev_b32 v5, 16, v5
    v_mul_u32_u24 v6, 20, v5
    v_sub_u32 v6, v4, v6
    v_mul_u32_u24 v5, 5120, v5
    v_lshl_add_u32 v5, v6, 4, v5
    v_add_u32 v157, v5, v3
    v_add_u32 v4, 48, v2
    v_mul_u32_u24 v5, 3277, v4
    v_lshrrev_b32 v5, 16, v5
    v_mul_u32_u24 v6, 20, v5
    v_sub_u32 v6, v4, v6
    v_mul_u32_u24 v5, 5120, v5
    v_lshl_add_u32 v5, v6, 4, v5
    v_add_u32 v158, v5, v3
k1_kernel_NOEA:
    s_cmp_lt_u32 s22, 8
    s_cselect_b32 s27, 0, 1
    s_cmp_lt_u32 s20, 4
    s_cselect_b32 s26, 0, 2
    s_cmp_lt_u32 s20, 6
    s_cselect_b32 s26, s26, 4
    s_add_u32 s26, s26, s27
    s_cmp_eq_u32 s26, 1
    s_cbranch_scc1 k1_kernel_VAR1
    s_cmp_eq_u32 s26, 2
    s_cbranch_scc1 k1_kernel_VAR2
    s_cmp_eq_u32 s26, 3
    s_cbranch_scc1 k1_kernel_VAR3
    s_cmp_eq_u32 s26, 4
    s_cbranch_scc1 k1_kernel_VAR4
    s_cmp_eq_u32 s26, 5
    s_cbranch_scc1 k1_kernel_VAR5
    s_waitcnt vmcnt(6)
    s_barrier
    ds_read_b64_tr_b16 v[40:41], v15 offset:0
    ds_read_b64_tr_b16 v[42:43], v15 offset:2560
    ds_read_b128 v[24:27], v13 offset:0
    ds_read_b64_tr_b16 v[44:45], v16 offset:0
    ds_read_b64_tr_b16 v[46:47], v16 offset:2560
    ds_read_b128 v[28:31], v13 offset:2048
    ds_read_b64_tr_b16 v[48:49], v17 offset:0
    ds_read_b64_tr_b16 v[50:51], v17 offset:2560
    ds_read_b128 v[32:35], v13 offset:4096
    ds_read_b64_tr_b16 v[52:53], v18 offset:0
    ds_read_b64_tr_b16 v[54:55], v18 offset:2560
    ds_read_b128 v[36:39], v13 offset:6144
    s_add_u32 m0, s44, 73728
    s_nop 0
    buffer_load_dwordx4 v11, s[36:39], s47 offen lds
    s_add_u32 m0, s44, 74752
    s_nop 0
    buffer_load_dwordx4 v12, s[36:39], s47 offen lds
    s_add_u32 s47, s47, s48
    s_add_u32 m0, s45, 32768
    s_mov_b32 s46, 256
    buffer_load_dwordx4 v10, s[32:35], s46 offen lds
    s_waitcnt lgkmcnt(0)
    v_mfma_f32_16x16x32_bf16 v[88:91], v[40:43], v[24:27], 0
    s_waitcnt vmcnt(6)
    s_barrier
    ds_read_b64_tr_b16 v[72:73], v15 offset:24576
    ds_read_b64_tr_b16 v[74:75], v15 offset:27136
    v_mfma_f32_16x16x32_bf16 v[92:95], v[40:43], v[28:31], 0
    ds_read_b128 v[56:59], v14 offset:0
    v_mfma_f32_16x16x32_bf16 v[96:99], v[40:43], v[32:35], 0
    ds_read_b64_tr_b16 v[76:77], v16 offset:24576
    v_mfma_f32_16x16x32_bf16 v[100:103], v[40:43], v[36:39], 0
    ds_read_b64_tr_b16 v[78:79], v16 offset:27136
    v_mfma_f32_16x16x32_bf16 v[104:107], v[44:47], v[24:27], 0
    ds_read_b128 v[60:63], v14 offset:2048
    v_mfma_f32_16x16x32_bf16 v[108:111], v[44:47], v[28:31], 0
    ds_read_b64_tr_b16 v[80:81], v17 offset:24576
    v_mfma_f32_16x16x32_bf16 v[112:115], v[44:47], v[32:35], 0
    ds_read_b64_tr_b16 v[82:83], v17 offset:27136
    v_mfma_f32_16x16x32_bf16 v[116:119], v[44:47], v[36:39], 0
    ds_read_b128 v[64:67], v14 offset:4096
    v_mfma_f32_16x16x32_bf16 v[120:123], v[48:51], v[24:27], 0
    ds_read_b64_tr_b16 v[84:85], v18 offset:24576
    v_mfma_f32_16x16x32_bf16 v[124:127], v[48:51], v[28:31], 0
    ds_read_b64_tr_b16 v[86:87], v18 offset:27136
    v_mfma_f32_16x16x32_bf16 v[128:131], v[48:51], v[32:35], 0
    ds_read_b128 v[68:71], v14 offset:6144
    v_mfma_f32_16x16x32_bf16 v[132:135], v[48:51], v[36:39], 0
    s_add_u32 m0, s44, 0
    s_nop 0
    buffer_load_dwordx4 v11, s[36:39], s47 offen lds
    v_mfma_f32_16x16x32_bf16 v[136:139], v[52:55], v[24:27], 0
    v_mfma_f32_16x16x32_bf16 v[140:143], v[52:55], v[28:31], 0
    s_add_u32 m0, s44, 1024
    s_nop 0
    buffer_load_dwordx4 v12, s[36:39], s47 offen lds
    s_add_u32 s47, s47, s48
    v_mfma_f32_16x16x32_bf16 v[144:147], v[52:55], v[32:35], 0
    v_mfma_f32_16x16x32_bf16 v[148:151], v[52:55], v[36:39], 0
    s_add_u32 m0, s45, 40960
    s_mov_b32 s46, 82176
    buffer_load_dwordx4 v10, s[32:35], s46 offen lds
    s_waitcnt lgkmcnt(0)
    v_mfma_f32_16x16x32_bf16 v[88:91], v[72:75], v[56:59], v[88:91]
    s_waitcnt vmcnt(6)
    s_barrier
    ds_read_b64_tr_b16 v[40:41], v19 offset:0
    ds_read_b64_tr_b16 v[42:43], v19 offset:2560
    v_mfma_f32_16x16x32_bf16 v[92:95], v[72:75], v[60:63], v[92:95]
    ds_read_b128 v[24:27], v13 offset:16384
    v_mfma_f32_16x16x32_bf16 v[96:99], v[72:75], v[64:67], v[96:99]
    ds_read_b64_tr_b16 v[44:45], v20 offset:0
    v_mfma_f32_16x16x32_bf16 v[100:103], v[72:75], v[68:71], v[100:103]
    ds_read_b64_tr_b16 v[46:47], v20 offset:2560
    v_mfma_f32_16x16x32_bf16 v[104:107], v[76:79], v[56:59], v[104:107]
    ds_read_b128 v[28:31], v13 offset:18432
    v_mfma_f32_16x16x32_bf16 v[108:111], v[76:79], v[60:63], v[108:111]
    ds_read_b64_tr_b16 v[48:49], v21 offset:0
    v_mfma_f32_16x16x32_bf16 v[112:115], v[76:79], v[64:67], v[112:115]
    ds_read_b64_tr_b16 v[50:51], v21 offset:2560
    v_mfma_f32_16x16x32_bf16 v[116:119], v[76:79], v[68:71], v[116:119]
    ds_read_b128 v[32:35], v13 offset:20480
    v_mfma_f32_16x16x32_bf16 v[120:123], v[80:83], v[56:59], v[120:123]
    ds_read_b64_tr_b16 v[52:53], v22 offset:0
    v_mfma_f32_16x16x32_bf16 v[124:127], v[80:83], v[60:63], v[124:127]
    ds_read_b64_tr_b16 v[54:55], v22 offset:2560
    v_mfma_f32_16x16x32_bf16 v[128:131], v[80:83], v[64:67], v[128:131]
    ds_read_b128 v[36:39], v13 offset:22528
    v_mfma_f32_16x16x32_bf16 v[132:135], v[80:83], v[68:71], v[132:135]
    s_add_u32 m0, s44, 24576
    s_nop 0
    buffer_load_dwordx4 v11, s[36:39], s47 offen lds
    v_mfma_f32_16x16x32_bf16 v[136:139], v[84:87], v[56:59], v[136:139]
    v_mfma_f32_16x16x32_bf16 v[140:143], v[84:87], v[60:63], v[140:143]
    s_add_u32 m0, s44, 25600
    s_nop 0
    buffer_load_dwordx4 v12, s[36:39], s47 offen lds
    s_add_u32 s47, s47, s48
    v_mfma_f32_16x16x32_bf16 v[144:147], v[84:87], v[64:67], v[144:147]
    v_mfma_f32_16x16x32_bf16 v[148:151], v[84:87], v[68:71], v[148:151]
    s_add_u32 m0, s45, 0
    s_mov_b32 s46, 384
    buffer_load_dwordx4 v10, s[32:35], s46 offen lds
    s_waitcnt lgkmcnt(0)
    v_mfma_f32_16x16x32_bf16 v[88:91], v[40:43], v[24:27], v[88:91]
    s_waitcnt vmcnt(6)
    s_barrier
    ds_read_b64_tr_b16 v[72:73], v19 offset:24576
    ds_read_b64_tr_b16 v[74:75], v19 offset:27136
    v_mfma_f32_16x16x32_bf16 v[92:95], v[40:43], v[28:31], v[92:95]
    ds_read_b128 v[56:59], v14 offset:16384
    v_mfma_f32_16x16x32_bf16 v[96:99], v[40:43], v[32:35], v[96:99]
    ds_read_b64_tr_b16 v[76:77], v20 offset:24576
    v_mfma_f32_16x16x32_bf16 v[100:103], v[40:43], v[36:39], v[100:103]
    ds_read_b64_tr_b16 v[78:79], v20 offset:27136
    v_mfma_f32_16x16x32_bf16 v[104:107], v[44:47], v[24:27], v[104:107]
    ds_read_b128 v[60:63], v14 offset:18432
    v_mfma_f32_16x16x32_bf16 v[108:111], v[44:47], v[28:31], v[108:111]
    ds_read_b64_tr_b16 v[80:81], v21 offset:24576
    v_mfma_f32_16x16x32_bf16 v[112:115], v[44:47], v[32:35], v[112:115]
    ds_read_b64_tr_b16 v[82:83], v21 offset:27136
    v_mfma_f32_16x16x32_bf16 v[116:119], v[44:47], v[36:39], v[116:119]
    ds_read_b128 v[64:67], v14 offset:20480
    v_mfma_f32_16x16x32_bf16 v[120:123], v[48:51], v[24:27], v[120:123]
    ds_read_b64_tr_b16 v[84:85], v22 offset:24576
    v_mfma_f32_16x16x32_bf16 v[124:127], v[48:51], v[28:31], v[124:127]
    ds_read_b64_tr_b16 v[86:87], v22 offset:27136
    v_mfma_f32_16x16x32_bf16 v[128:131], v[48:51], v[32:35], v[128:131]
    ds_read_b128 v[68:71], v14 offset:22528
    v_mfma_f32_16x16x32_bf16 v[132:135], v[48:51], v[36:39], v[132:135]
    s_add_u32 m0, s44, 49152
    s_nop 0
    buffer_load_dwordx4 v11, s[36:39], s47 offen lds
    v_mfma_f32_16x16x32_bf16 v[136:139], v[52:55], v[24:27], v[136:139]
    v_mfma_f32_16x16x32_bf16 v[140:143], v[52:55], v[28:31], v[140:143]
    s_add_u32 m0, s44, 50176
    s_nop 0
    buffer_load_dwordx4 v12, s[36:39], s47 offen lds
    s_add_u32 s47, s47, s48
    v_mfma_f32_16x16x32_bf16 v[144:147], v[52:55], v[32:35], v[144:147]
    v_mfma_f32_16x16x32_bf16 v[148:151], v[52:55], v[36:39], v[148:151]
    s_add_u32 m0, s45, 8192
    s_mov_b32 s46, 82304
    buffer_load_dwordx4 v10, s[32:35], s46 offen lds
    s_waitcnt lgkmcnt(0)
    v_mfma_f32_16x16x32_bf16 v[88:91], v[72:75], v[56:59], v[88:91]
    s_waitcnt vmcnt(6)
    s_barrier
    ds_read_b64_tr_b16 v[40:41], v15 offset:0
    ds_read_b64_tr_b16 v[42:43], v15 offset:2560
    v_mfma_f32_16x16x32_bf16 v[92:95], v[72:75], v[60:63], v[92:95]
    ds_read_b128 v[24:27], v13 offset:32768
    v_mfma_f32_16x16x32_bf16 v[96:99], v[72:75], v[64:67], v[96:99]
    ds_read_b64_tr_b16 v[44:45], v16 offset:0
    v_mfma_f32_16x16x32_bf16 v[100:103], v[72:75], v[68:71], v[100:103]
    ds_read_b64_tr_b16 v[46:47], v16 offset:2560
    v_mfma_f32_16x16x32_bf16 v[104:107], v[76:79], v[56:59], v[104:107]
    ds_read_b128 v[28:31], v13 offset:34816
    v_mfma_f32_16x16x32_bf16 v[108:111], v[76:79], v[60:63], v[108:111]
    ds_read_b64_tr_b16 v[48:49], v17 offset:0
    v_mfma_f32_16x16x32_bf16 v[112:115], v[76:79], v[64:67], v[112:115]
    ds_read_b64_tr_b16 v[50:51], v17 offset:2560
    v_mfma_f32_16x16x32_bf16 v[116:119], v[76:79], v[68:71], v[116:119]
    ds_read_b128 v[32:35], v13 offset:36864
    v_mfma_f32_16x16x32_bf16 v[120:123], v[80:83], v[56:59], v[120:123]
    ds_read_b64_tr_b16 v[52:53], v18 offset:0
    v_mfma_f32_16x16x32_bf16 v[124:127], v[80:83], v[60:63], v[124:127]
    ds_read_b64_tr_b16 v[54:55], v18 offset:2560
    v_mfma_f32_16x16x32_bf16 v[128:131], v[80:83], v[64:67], v[128:131]
    ds_read_b128 v[36:39], v13 offset:38912
    v_mfma_f32_16x16x32_bf16 v[132:135], v[80:83], v[68:71], v[132:135]
    s_add_u32 m0, s44, 73728
    s_nop 0
    buffer_load_dwordx4 v11, s[36:39], s47 offen lds
    v_mfma_f32_16x16x32_bf16 v[136:139], v[84:87], v[56:59], v[136:139]
    v_mfma_f32_16x16x32_bf16 v[140:143], v[84:87], v[60:63], v[140:143]
    s_add_u32 m0, s44, 74752
    s_nop 0
    buffer_load_dwordx4 v12, s[36:39], s47 offen lds
    s_add_u32 s47, s47, s48
    v_mfma_f32_16x16x32_bf16 v[144:147], v[84:87], v[64:67], v[144:147]
    v_mfma_f32_16x16x32_bf16 v[148:151], v[84:87], v[68:71], v[148:151]
    s_add_u32 m0, s45, 16384
    s_mov_b32 s46, 512
    buffer_load_dwordx4 v10, s[32:35], s46 offen lds
    s_waitcnt lgkmcnt(0)
    v_mfma_f32_16x16x32_bf16 v[88:91], v[40:43], v[24:27], v[88:91]
    s_waitcnt vmcnt(6)
    s_barrier
    ds_read_b64_tr_b16 v[72:73], v15 offset:24576
    ds_read_b64_tr_b16 v[74:75], v15 offset:27136
    v_mfma_f32_16x16x32_bf16 v[92:95], v[40:43], v[28:31], v[92:95]
    ds_read_b128 v[56:59], v14 offset:32768
    v_mfma_f32_16x16x32_bf16 v[96:99], v[40:43], v[32:35], v[96:99]
    ds_read_b64_tr_b16 v[76:77], v16 offset:24576
    v_mfma_f32_16x16x32_bf16 v[100:103], v[40:43], v[36:39], v[100:103]
    ds_read_b64_tr_b16 v[78:79], v16 offset:27136
    v_mfma_f32_16x16x32_bf16 v[104:107], v[44:47], v[24:27], v[104:107]
    ds_read_b128 v[60:63], v14 offset:34816
    v_mfma_f32_16x16x32_bf16 v[108:111], v[44:47], v[28:31], v[108:111]
    ds_read_b64_tr_b16 v[80:81], v17 offset:24576
    v_mfma_f32_16x16x32_bf16 v[112:115], v[44:47], v[32:35], v[112:115]
    ds_read_b64_tr_b16 v[82:83], v17 offset:27136
    v_mfma_f32_16x16x32_bf16 v[116:119], v[44:47], v[36:39], v[116:119]
    ds_read_b128 v[64:67], v14 offset:36864
    v_mfma_f32_16x16x32_bf16 v[120:123], v[48:51], v[24:27], v[120:123]
    ds_read_b64_tr_b16 v[84:85], v18 offset:24576
    v_mfma_f32_16x16x32_bf16 v[124:127], v[48:51], v[28:31], v[124:127]
    ds_read_b64_tr_b16 v[86:87], v18 offset:27136
    v_mfma_f32_16x16x32_bf16 v[128:131], v[48:51], v[32:35], v[128:131]
    ds_read_b128 v[68:71], v14 offset:38912
    v_mfma_f32_16x16x32_bf16 v[132:135], v[48:51], v[36:39], v[132:135]
    s_add_u32 m0, s44, 0
    s_nop 0
    buffer_load_dwordx4 v11, s[36:39], s47 offen lds
    v_mfma_f32_16x16x32_bf16 v[136:139], v[52:55], v[24:27], v[136:139]
    v_mfma_f32_16x16x32_bf16 v[140:143], v[52:55], v[28:31], v[140:143]
    s_add_u32 m0, s44, 1024
    s_nop 0
    buffer_load_dwordx4 v12, s[36:39], s47 offen lds
    s_add_u32 s47, s47, s48
    v_mfma_f32_16x16x32_bf16 v[144:147], v[52:55], v[32:35], v[144:147]
    v_mfma_f32_16x16x32_bf16 v[148:151], v[52:55], v[36:39], v[148:151]
    s_add_u32 m0, s45, 24576
    s_mov_b32 s46, 82432
    buffer_load_dwordx4 v10, s[32:35], s46 offen lds
    s_waitcnt lgkmcnt(0)
    v_mfma_f32_16x16x32_bf16 v[88:91], v[72:75], v[56:59], v[88:91]
    s_waitcnt vmcnt(6)
    s_barrier
    ds_read_b64_tr_b16 v[40:41], v19 offset:0
    ds_read_b64_tr_b16 v[42:43], v19 offset:2560
    v_mfma_f32_16x16x32_bf16 v[92:95], v[72:75], v[60:63], v[92:95]
    ds_read_b128 v[24:27], v13 offset:0
    v_mfma_f32_16x16x32_bf16 v[96:99], v[72:75], v[64:67], v[96:99]
    ds_read_b64_tr_b16 v[44:45], v20 offset:0
    v_mfma_f32_16x16x32_bf16 v[100:103], v[72:75], v[68:71], v[100:103]
    ds_read_b64_tr_b16 v[46:47], v20 offset:2560
    v_mfma_f32_16x16x32_bf16 v[104:107], v[76:79], v[56:59], v[104:107]
    ds_read_b128 v[28:31], v13 offset:2048
    v_mfma_f32_16x16x32_bf16 v[108:111], v[76:79], v[60:63], v[108:111]
    ds_read_b64_tr_b16 v[48:49], v21 offset:0
    v_mfma_f32_16x16x32_bf16 v[112:115], v[76:79], v[64:67], v[112:115]
    ds_read_b64_tr_b16 v[50:51], v21 offset:2560
    v_mfma_f32_16x16x32_bf16 v[116:119], v[76:79], v[68:71], v[116:119]
    ds_read_b128 v[32:35], v13 offset:4096
    v_mfma_f32_16x16x32_bf16 v[120:123], v[80:83], v[56:59], v[120:123]
    ds_read_b64_tr_b16 v[52:53], v22 offset:0
    v_mfma_f32_16x16x32_bf16 v[124:127], v[80:83], v[60:63], v[124:127]
    ds_read_b64_tr_b16 v[54:55], v22 offset:2560
    v_mfma_f32_16x16x32_bf16 v[128:131], v[80:83], v[64:67], v[128:131]
    ds_read_b128 v[36:39], v13 offset:6144
    v_mfma_f32_16x16x32_bf16 v[132:135], v[80:83], v[68:71], v[132:135]
    s_add_u32 m0, s44, 24576
    s_nop 0
    buffer_load_dwordx4 v11, s[36:39], s47 offen lds
    v_mfma_f32_16x16x32_bf16 v[136:139], v[84:87], v[56:59], v[136:139]
    v_mfma_f32_16x16x32_bf16 v[140:143], v[84:87], v[60:63], v[140:143]
    s_add_u32 m0, s44, 25600
    s_nop 0
    buffer_load_dwordx4 v12, s[36:39], s47 offen lds
    s_add_u32 s47, s47, s48
    v_mfma_f32_16x16x32_bf16 v[144:147], v[84:87], v[64:67], v[144:147]
    v_mfma_f32_16x16x32_bf16 v[148:151], v[84:87], v[68:71], v[148:151]
    s_add_u32 m0, s45, 32768
    s_mov_b32 s46, 640
    buffer_load_dwordx4 v10, s[32:35], s46 offen lds
    s_waitcnt lgkmcnt(0)
    v_mfma_f32_16x16x32_bf16 v[88:91], v[40:43], v[24:27], v[88:91]
    s_waitcnt vmcnt(6)
    s_barrier
    ds_read_b64_tr_b16 v[72:73], v19 offset:24576
    ds_read_b64_tr_b16 v[74:75], v19 offset:27136
    v_mfma_f32_16x16x32_bf16 v[92:95], v[40:43], v[28:31], v[92:95]
    ds_read_b128 v[56:59], v14 offset:0
    v_mfma_f32_16x16x32_bf16 v[96:99], v[40:43], v[32:35], v[96:99]
    ds_read_b64_tr_b16 v[76:77], v20 offset:24576
    v_mfma_f32_16x16x32_bf16 v[100:103], v[40:43], v[36:39], v[100:103]
    ds_read_b64_tr_b16 v[78:79], v20 offset:27136
    v_mfma_f32_16x16x32_bf16 v[104:107], v[44:47], v[24:27], v[104:107]
    ds_read_b128 v[60:63], v14 offset:2048
    v_mfma_f32_16x16x32_bf16 v[108:111], v[44:47], v[28:31], v[108:111]
    ds_read_b64_tr_b16 v[80:81], v21 offset:24576
    v_mfma_f32_16x16x32_bf16 v[112:115], v[44:47], v[32:35], v[112:115]
    ds_read_b64_tr_b16 v[82:83], v21 offset:27136
    v_mfma_f32_16x16x32_bf16 v[116:119], v[44:47], v[36:39], v[116:119]
    ds_read_b128 v[64:67], v14 offset:4096
    v_mfma_f32_16x16x32_bf16 v[120:123], v[48:51], v[24:27], v[120:123]
    ds_read_b64_tr_b16 v[84:85], v22 offset:24576
    v_mfma_f32_16x16x32_bf16 v[124:127], v[48:51], v[28:31], v[124:127]
    ds_read_b64_tr_b16 v[86:87], v22 offset:27136
    v_mfma_f32_16x16x32_bf16 v[128:131], v[48:51], v[32:35], v[128:131]
    ds_read_b128 v[68:71], v14 offset:6144
    v_mfma_f32_16x16x32_bf16 v[132:135], v[48:51], v[36:39], v[132:135]
    s_add_u32 m0, s44, 49152
    s_nop 0
    buffer_load_dwordx4 v11, s[36:39], s47 offen lds
    v_mfma_f32_16x16x32_bf16 v[136:139], v[52:55], v[24:27], v[136:139]
    v_mfma_f32_16x16x32_bf16 v[140:143], v[52:55], v[28:31], v[140:143]
    s_add_u32 m0, s44, 50176
    s_nop 0
    buffer_load_dwordx4 v12, s[36:39], s47 offen lds
    s_add_u32 s47, s47, s48
    v_mfma_f32_16x16x32_bf16 v[144:147], v[52:55], v[32:35], v[144:147]
    v_mfma_f32_16x16x32_bf16 v[148:151], v[52:55], v[36:39], v[148:151]
    s_add_u32 m0, s45, 40960
    s_mov_b32 s46, 82560
    buffer_load_dwordx4 v10, s[32:35], s46 offen lds
    s_waitcnt lgkmcnt(0)
    v_mfma_f32_16x16x32_bf16 v[88:91], v[72:75], v[56:59], v[88:91]
    s_waitcnt vmcnt(6)
    s_barrier
    ds_read_b64_tr_b16 v[40:41], v15 offset:0
    ds_read_b64_tr_b16 v[42:43], v15 offset:2560
    v_mfma_f32_16x16x32_bf16 v[92:95], v[72:75], v[60:63], v[92:95]
    ds_read_b128 v[24:27], v13 offset:16384
    v_mfma_f32_16x16x32_bf16 v[96:99], v[72:75], v[64:67], v[96:99]
    ds_read_b64_tr_b16 v[44:45], v16 offset:0
    v_mfma_f32_16x16x32_bf16 v[100:103], v[72:75], v[68:71], v[100:103]
    ds_read_b64_tr_b16 v[46:47], v16 offset:2560
    v_mfma_f32_16x16x32_bf16 v[104:107], v[76:79], v[56:59], v[104:107]
    ds_read_b128 v[28:31], v13 offset:18432
    v_mfma_f32_16x16x32_bf16 v[108:111], v[76:79], v[60:63], v[108:111]
    ds_read_b64_tr_b16 v[48:49], v17 offset:0
    v_mfma_f32_16x16x32_bf16 v[112:115], v[76:79], v[64:67], v[112:115]
    ds_read_b64_tr_b16 v[50:51], v17 offset:2560
    v_mfma_f32_16x16x32_bf16 v[116:119], v[76:79], v[68:71], v[116:119]
    ds_read_b128 v[32:35], v13 offset:20480
    v_mfma_f32_16x16x32_bf16 v[120:123], v[80:83], v[56:59], v[120:123]
    ds_read_b64_tr_b16 v[52:53], v18 offset:0
    v_mfma_f32_16x16x32_bf16 v[124:127], v[80:83], v[60:63], v[124:127]
    ds_read_b64_tr_b16 v[54:55], v18 offset:2560
    v_mfma_f32_16x16x32_bf16 v[128:131], v[80:83], v[64:67], v[128:131]
    ds_read_b128 v[36:39], v13 offset:22528
    v_mfma_f32_16x16x32_bf16 v[132:135], v[80:83], v[68:71], v[132:135]
    s_add_u32 m0, s44, 73728
    s_nop 0
    buffer_load_dwordx4 v11, s[36:39], s47 offen lds
    v_mfma_f32_16x16x32_bf16 v[136:139], v[84:87], v[56:59], v[136:139]
    v_mfma_f32_16x16x32_bf16 v[140:143], v[84:87], v[60:63], v[140:143]
    s_add_u32 m0, s44, 74752
    s_nop 0
    buffer_load_dwordx4 v12, s[36:39], s47 offen lds
    s_add_u32 s47, s47, s48
    v_mfma_f32_16x16x32_bf16 v[144:147], v[84:87], v[64:67], v[144:147]
    v_mfma_f32_16x16x32_bf16 v[148:151], v[84:87], v[68:71], v[148:151]
    s_add_u32 m0, s45, 0
    s_mov_b32 s46, 768
    buffer_load_dwordx4 v10, s[32:35], s46 offen lds
    s_waitcnt lgkmcnt(0)
    v_mfma_f32_16x16x32_bf16 v[88:91], v[40:43], v[24:27], v[88:91]
    s_waitcnt vmcnt(6)
    s_barrier
    ds_read_b64_tr_b16 v[72:73], v15 offset:24576
    ds_read_b64_tr_b16 v[74:75], v15 offset:27136
    v_mfma_f32_16x16x32_bf16 v[92:95], v[40:43], v[28:31], v[92:95]
    ds_read_b128 v[56:59], v14 offset:16384
    v_mfma_f32_16x16x32_bf16 v[96:99], v[40:43], v[32:35], v[96:99]
    ds_read_b64_tr_b16 v[76:77], v16 offset:24576
    v_mfma_f32_16x16x32_bf16 v[100:103], v[40:43], v[36:39], v[100:103]
    ds_read_b64_tr_b16 v[78:79], v16 offset:27136
    v_mfma_f32_16x16x32_bf16 v[104:107], v[44:47], v[24:27], v[104:107]
    ds_read_b128 v[60:63], v14 offset:18432
    v_mfma_f32_16x16x32_bf16 v[108:111], v[44:47], v[28:31], v[108:111]
    ds_read_b64_tr_b16 v[80:81], v17 offset:24576
    v_mfma_f32_16x16x32_bf16 v[112:115], v[44:47], v[32:35], v[112:115]
    ds_read_b64_tr_b16 v[82:83], v17 offset:27136
    v_mfma_f32_16x16x32_bf16 v[116:119], v[44:47], v[36:39], v[116:119]
    ds_read_b128 v[64:67], v14 offset:20480
    v_mfma_f32_16x16x32_bf16 v[120:123], v[48:51], v[24:27], v[120:123]
    ds_read_b64_tr_b16 v[84:85], v18 offset:24576
    v_mfma_f32_16x16x32_bf16 v[124:127], v[48:51], v[28:31], v[124:127]
    ds_read_b64_tr_b16 v[86:87], v18 offset:27136
    v_mfma_f32_16x16x32_bf16 v[128:131], v[48:51], v[32:35], v[128:131]
    ds_read_b128 v[68:71], v14 offset:22528
    v_mfma_f32_16x16x32_bf16 v[132:135], v[48:51], v[36:39], v[132:135]
    s_add_u32 m0, s44, 0
    s_nop 0
    buffer_load_dwordx4 v11, s[36:39], s47 offen lds
    v_mfma_f32_16x16x32_bf16 v[136:139], v[52:55], v[24:27], v[136:139]
    v_mfma_f32_16x16x32_bf16 v[140:143], v[52:55], v[28:31], v[140:143]
    s_add_u32 m0, s44, 1024
    s_nop 0
    buffer_load_dwordx4 v12, s[36:39], s47 offen lds
    s_add_u32 s47, s47, s48
    v_mfma_f32_16x16x32_bf16 v[144:147], v[52:55], v[32:35], v[144:147]
    v_mfma_f32_16x16x32_bf16 v[148:151], v[52:55], v[36:39], v[148:151]
    s_add_u32 m0, s45, 8192
    s_mov_b32 s46, 82688
    buffer_load_dwordx4 v10, s[32:35], s46 offen lds
    s_waitcnt lgkmcnt(0)
    v_mfma_f32_16x16x32_bf16 v[88:91], v[72:75], v[56:59], v[88:91]
    s_waitcnt vmcnt(6)
    s_barrier
    ds_read_b64_tr_b16 v[40:41], v19 offset:0
    ds_read_b64_tr_b16 v[42:43], v19 offset:2560
    v_mfma_f32_16x16x32_bf16 v[92:95], v[72:75], v[60:63], v[92:95]
    ds_read_b128 v[24:27], v13 offset:32768
    v_mfma_f32_16x16x32_bf16 v[96:99], v[72:75], v[64:67], v[96:99]
    ds_read_b64_tr_b16 v[44:45], v20 offset:0
    v_mfma_f32_16x16x32_bf16 v[100:103], v[72:75], v[68:71], v[100:103]
    ds_read_b64_tr_b16 v[46:47], v20 offset:2560
    v_mfma_f32_16x16x32_bf16 v[104:107], v[76:79], v[56:59], v[104:107]
    ds_read_b128 v[28:31], v13 offset:34816
    v_mfma_f32_16x16x32_bf16 v[108:111], v[76:79], v[60:63], v[108:111]
    ds_read_b64_tr_b16 v[48:49], v21 offset:0
    v_mfma_f32_16x16x32_bf16 v[112:115], v[76:79], v[64:67], v[112:115]
    ds_read_b64_tr_b16 v[50:51], v21 offset:2560
    v_mfma_f32_16x16x32_bf16 v[116:119], v[76:79], v[68:71], v[116:119]
    ds_read_b128 v[32:35], v13 offset:36864
    v_mfma_f32_16x16x32_bf16 v[120:123], v[80:83], v[56:59], v[120:123]
    ds_read_b64_tr_b16 v[52:53], v22 offset:0
    v_mfma_f32_16x16x32_bf16 v[124:127], v[80:83], v[60:63], v[124:127]
    ds_read_b64_tr_b16 v[54:55], v22 offset:2560
    v_mfma_f32_16x16x32_bf16 v[128:131], v[80:83], v[64:67], v[128:131]
    ds_read_b128 v[36:39], v13 offset:38912
    v_mfma_f32_16x16x32_bf16 v[132:135], v[80:83], v[68:71], v[132:135]
    s_add_u32 m0, s44, 24576
    s_nop 0
    buffer_load_dwordx4 v11, s[36:39], s47 offen lds
    v_mfma_f32_16x16x32_bf16 v[136:139], v[84:87], v[56:59], v[136:139]
    v_mfma_f32_16x16x32_bf16 v[140:143], v[84:87], v[60:63], v[140:143]
    s_add_u32 m0, s44, 25600
    s_nop 0
    buffer_load_dwordx4 v12, s[36:39], s47 offen lds
    s_add_u32 s47, s47, s48
    v_mfma_f32_16x16x32_bf16 v[144:147], v[84:87], v[64:67], v[144:147]
    v_mfma_f32_16x16x32_bf16 v[148:151], v[84:87], v[68:71], v[148:151]
    s_add_u32 m0, s45, 16384
    s_mov_b32 s46, 896
    buffer_load_dwordx4 v10, s[32:35], s46 offen lds
    s_waitcnt lgkmcnt(0)
    v_mfma_f32_16x16x32_bf16 v[88:91], v[40:43], v[24:27], v[88:91]
    s_waitcnt vmcnt(6)
    s_barrier
    ds_read_b64_tr_b16 v[72:73], v19 offset:24576
    ds_read_b64_tr_b16 v[74:75], v19 offset:27136
    v_mfma_f32_16x16x32_bf16 v[92:95], v[40:43], v[28:31], v[92:95]
    ds_read_b128 v[56:59], v14 offset:32768
    v_mfma_f32_16x16x32_bf16 v[96:99], v[40:43], v[32:35], v[96:99]
    ds_read_b64_tr_b16 v[76:77], v20 offset:24576
    v_mfma_f32_16x16x32_bf16 v[100:103], v[40:43], v[36:39], v[100:103]
    ds_read_b64_tr_b16 v[78:79], v20 offset:27136
    v_mfma_f32_16x16x32_bf16 v[104:107], v[44:47], v[24:27], v[104:107]
    ds_read_b128 v[60:63], v14 offset:34816
    v_mfma_f32_16x16x32_bf16 v[108:111], v[44:47], v[28:31], v[108:111]
    ds_read_b64_tr_b16 v[80:81], v21 offset:24576
    v_mfma_f32_16x16x32_bf16 v[112:115], v[44:47], v[32:35], v[112:115]
    ds_read_b64_tr_b16 v[82:83], v21 offset:27136
    v_mfma_f32_16x16x32_bf16 v[116:119], v[44:47], v[36:39], v[116:119]
    ds_read_b128 v[64:67], v14 offset:36864
    v_mfma_f32_16x16x32_bf16 v[120:123], v[48:51], v[24:27], v[120:123]
    ds_read_b64_tr_b16 v[84:85], v22 offset:24576
    v_mfma_f32_16x16x32_bf16 v[124:127], v[48:51], v[28:31], v[124:127]
    ds_read_b64_tr_b16 v[86:87], v22 offset:27136
    v_mfma_f32_16x16x32_bf16 v[128:131], v[48:51], v[32:35], v[128:131]
    ds_read_b128 v[68:71], v14 offset:38912
    v_mfma_f32_16x16x32_bf16 v[132:135], v[48:51], v[36:39], v[132:135]
    s_add_u32 m0, s44, 49152
    s_nop 0
    buffer_load_dwordx4 v11, s[36:39], s47 offen lds
    v_mfma_f32_16x16x32_bf16 v[136:139], v[52:55], v[24:27], v[136:139]
    v_mfma_f32_16x16x32_bf16 v[140:143], v[52:55], v[28:31], v[140:143]
    s_add_u32 m0, s44, 50176
    s_nop 0
    buffer_load_dwordx4 v12, s[36:39], s47 offen lds
    s_add_u32 s47, s47, s48
    v_mfma_f32_16x16x32_bf16 v[144:147], v[52:55], v[32:35], v[144:147]
    v_mfma_f32_16x16x32_bf16 v[148:151], v[52:55], v[36:39], v[148:151]
    s_add_u32 m0, s45, 24576
    s_mov_b32 s46, 82816
    buffer_load_dwordx4 v10, s[32:35], s46 offen lds
    s_waitcnt lgkmcnt(0)
    v_mfma_f32_16x16x32_bf16 v[88:91], v[72:75], v[56:59], v[88:91]
    s_waitcnt vmcnt(6)
    s_barrier
    ds_read_b64_tr_b16 v[40:41], v15 offset:0
    ds_read_b64_tr_b16 v[42:43], v15 offset:2560
    v_mfma_f32_16x16x32_bf16 v[92:95], v[72:75], v[60:63], v[92:95]
    ds_read_b128 v[24:27], v13 offset:0
    v_mfma_f32_16x16x32_bf16 v[96:99], v[72:75], v[64:67], v[96:99]
    ds_read_b64_tr_b16 v[44:45], v16 offset:0
    v_mfma_f32_16x16x32_bf16 v[100:103], v[72:75], v[68:71], v[100:103]
    ds_read_b64_tr_b16 v[46:47], v16 offset:2560
    v_mfma_f32_16x16x32_bf16 v[104:107], v[76:79], v[56:59], v[104:107]
    ds_read_b128 v[28:31], v13 offset:2048
    v_mfma_f32_16x16x32_bf16 v[108:111], v[76:79], v[60:63], v[108:111]
    ds_read_b64_tr_b16 v[48:49], v17 offset:0
    v_mfma_f32_16x16x32_bf16 v[112:115], v[76:79], v[64:67], v[112:115]
    ds_read_b64_tr_b16 v[50:51], v17 offset:2560
    v_mfma_f32_16x16x32_bf16 v[116:119], v[76:79], v[68:71], v[116:119]
    ds_read_b128 v[32:35], v13 offset:4096
    v_mfma_f32_16x16x32_bf16 v[120:123], v[80:83], v[56:59], v[120:123]
    ds_read_b64_tr_b16 v[52:53], v18 offset:0
    v_mfma_f32_16x16x32_bf16 v[124:127], v[80:83], v[60:63], v[124:127]
    ds_read_b64_tr_b16 v[54:55], v18 offset:2560
    v_mfma_f32_16x16x32_bf16 v[128:131], v[80:83], v[64:67], v[128:131]
    ds_read_b128 v[36:39], v13 offset:6144
    v_mfma_f32_16x16x32_bf16 v[132:135], v[80:83], v[68:71], v[132:135]
    s_add_u32 m0, s44, 73728
    s_nop 0
    buffer_load_dwordx4 v11, s[36:39], s47 offen lds
    v_mfma_f32_16x16x32_bf16 v[136:139], v[84:87], v[56:59], v[136:139]
    v_mfma_f32_16x16x32_bf16 v[140:143], v[84:87], v[60:63], v[140:143]
    s_add_u32 m0, s44, 74752
    s_nop 0
    buffer_load_dwordx4 v12, s[36:39], s47 offen lds
    s_add_u32 s47, s47, s48
    v_mfma_f32_16x16x32_bf16 v[144:147], v[84:87], v[64:67], v[144:147]
    v_mfma_f32_16x16x32_bf16 v[148:151], v[84:87], v[68:71], v[148:151]
    s_add_u32 m0, s45, 32768
    s_mov_b32 s46, 1024
    buffer_load_dwordx4 v10, s[32:35], s46 offen lds
    s_waitcnt lgkmcnt(0)
    v_mfma_f32_16x16x32_bf16 v[88:91], v[40:43], v[24:27], v[88:91]
    s_waitcnt vmcnt(6)
    s_barrier
    ds_read_b64_tr_b16 v[72:73], v15 offset:24576
    ds_read_b64_tr_b16 v[74:75], v15 offset:27136
    v_mfma_f32_16x16x32_bf16 v[92:95], v[40:43], v[28:31], v[92:95]
    ds_read_b128 v[56:59], v14 offset:0
    v_mfma_f32_16x16x32_bf16 v[96:99], v[40:43], v[32:35], v[96:99]
    ds_read_b64_tr_b16 v[76:77], v16 offset:24576
    v_mfma_f32_16x16x32_bf16 v[100:103], v[40:43], v[36:39], v[100:103]
    ds_read_b64_tr_b16 v[78:79], v16 offset:27136
    v_mfma_f32_16x16x32_bf16 v[104:107], v[44:47], v[24:27], v[104:107]
    ds_read_b128 v[60:63], v14 offset:2048
    v_mfma_f32_16x16x32_bf16 v[108:111], v[44:47], v[28:31], v[108:111]
    ds_read_b64_tr_b16 v[80:81], v17 offset:24576
    v_mfma_f32_16x16x32_bf16 v[112:115], v[44:47], v[32:35], v[112:115]
    ds_read_b64_tr_b16 v[82:83], v17 offset:27136
    v_mfma_f32_16x16x32_bf16 v[116:119], v[44:47], v[36:39], v[116:119]
    ds_read_b128 v[64:67], v14 offset:4096
    v_mfma_f32_16x16x32_bf16 v[120:123], v[48:51], v[24:27], v[120:123]
    ds_read_b64_tr_b16 v[84:85], v18 offset:24576
    v_mfma_f32_16x16x32_bf16 v[124:127], v[48:51], v[28:31], v[124:127]
    ds_read_b64_tr_b16 v[86:87], v18 offset:27136
    v_mfma_f32_16x16x32_bf16 v[128:131], v[48:51], v[32:35], v[128:131]
    ds_read_b128 v[68:71], v14 offset:6144
    v_mfma_f32_16x16x32_bf16 v[132:135], v[48:51], v[36:39], v[132:135]
    s_add_u32 m0, s44, 0
    s_nop 0
    buffer_load_dwordx4 v11, s[36:39], s47 offen lds
    v_mfma_f32_16x16x32_bf16 v[136:139], v[52:55], v[24:27], v[136:139]
    v_mfma_f32_16x16x32_bf16 v[140:143], v[52:55], v[28:31], v[140:143]
    s_add_u32 m0, s44, 1024
    s_nop 0
    buffer_load_dwordx4 v12, s[36:39], s47 offen lds
    s_add_u32 s47, s47, s48
    v_mfma_f32_16x16x32_bf16 v[144:147], v[52:55], v[32:35], v[144:147]
    v_mfma_f32_16x16x32_bf16 v[148:151], v[52:55], v[36:39], v[148:151]
    s_add_u32 m0, s45, 40960
    s_mov_b32 s46, 82944
    buffer_load_dwordx4 v10, s[32:35], s46 offen lds
    s_waitcnt lgkmcnt(0)
    v_mfma_f32_16x16x32_bf16 v[88:91], v[72:75], v[56:59], v[88:91]
    s_waitcnt vmcnt(6)
    s_barrier
    ds_read_b64_tr_b16 v[40:41], v19 offset:0
    ds_read_b64_tr_b16 v[42:43], v19 offset:2560
    v_mfma_f32_16x16x32_bf16 v[92:95], v[72:75], v[60:63], v[92:95]
    ds_read_b128 v[24:27], v13 offset:16384
    v_mfma_f32_16x16x32_bf16 v[96:99], v[72:75], v[64:67], v[96:99]
    ds_read_b64_tr_b16 v[44:45], v20 offset:0
    v_mfma_f32_16x16x32_bf16 v[100:103], v[72:75], v[68:71], v[100:103]
    ds_read_b64_tr_b16 v[46:47], v20 offset:2560
    v_mfma_f32_16x16x32_bf16 v[104:107], v[76:79], v[56:59], v[104:107]
    ds_read_b128 v[28:31], v13 offset:18432
    v_mfma_f32_16x16x32_bf16 v[108:111], v[76:79], v[60:63], v[108:111]
    ds_read_b64_tr_b16 v[48:49], v21 offset:0
    v_mfma_f32_16x16x32_bf16 v[112:115], v[76:79], v[64:67], v[112:115]
    ds_read_b64_tr_b16 v[50:51], v21 offset:2560
    v_mfma_f32_16x16x32_bf16 v[116:119], v[76:79], v[68:71], v[116:119]
    ds_read_b128 v[32:35], v13 offset:20480
    v_mfma_f32_16x16x32_bf16 v[120:123], v[80:83], v[56:59], v[120:123]
    ds_read_b64_tr_b16 v[52:53], v22 offset:0
    v_mfma_f32_16x16x32_bf16 v[124:127], v[80:83], v[60:63], v[124:127]
    ds_read_b64_tr_b16 v[54:55], v22 offset:2560
    v_mfma_f32_16x16x32_bf16 v[128:131], v[80:83], v[64:67], v[128:131]
    ds_read_b128 v[36:39], v13 offset:22528
    v_mfma_f32_16x16x32_bf16 v[132:135], v[80:83], v[68:71], v[132:135]
    s_add_u32 m0, s44, 24576
    s_nop 0
    buffer_load_dwordx4 v11, s[36:39], s47 offen lds
    v_mfma_f32_16x16x32_bf16 v[136:139], v[84:87], v[56:59], v[136:139]
    v_mfma_f32_16x16x32_bf16 v[140:143], v[84:87], v[60:63], v[140:143]
    s_add_u32 m0, s44, 25600
    s_nop 0
    buffer_load_dwordx4 v12, s[36:39], s47 offen lds
    s_add_u32 s47, s47, s48
    v_mfma_f32_16x16x32_bf16 v[144:147], v[84:87], v[64:67], v[144:147]
    v_mfma_f32_16x16x32_bf16 v[148:151], v[84:87], v[68:71], v[148:151]
    s_add_u32 m0, s45, 0
    s_mov_b32 s46, 1152
    buffer_load_dwordx4 v10, s[32:35], s46 offen lds
    s_waitcnt lgkmcnt(0)
    v_mfma_f32_16x16x32_bf16 v[88:91], v[40:43], v[24:27], v[88:91]
    s_waitcnt vmcnt(6)
    s_barrier
    ds_read_b64_tr_b16 v[72:73], v19 offset:24576
    ds_read_b64_tr_b16 v[74:75], v19 offset:27136
    v_mfma_f32_16x16x32_bf16 v[92:95], v[40:43], v[28:31], v[92:95]
    ds_read_b128 v[56:59], v14 offset:16384
    v_mfma_f32_16x16x32_bf16 v[96:99], v[40:43], v[32:35], v[96:99]
    ds_read_b64_tr_b16 v[76:77], v20 offset:24576
    v_mfma_f32_16x16x32_bf16 v[100:103], v[40:43], v[36:39], v[100:103]
    ds_read_b64_tr_b16 v[78:79], v20 offset:27136
    v_mfma_f32_16x16x32_bf16 v[104:107], v[44:47], v[24:27], v[104:107]
    ds_read_b128 v[60:63], v14 offset:18432
    v_mfma_f32_16x16x32_bf16 v[108:111], v[44:47], v[28:31], v[108:111]
    ds_read_b64_tr_b16 v[80:81], v21 offset:24576
    v_mfma_f32_16x16x32_bf16 v[112:115], v[44:47], v[32:35], v[112:115]
    ds_read_b64_tr_b16 v[82:83], v21 offset:27136
    v_mfma_f32_16x16x32_bf16 v[116:119], v[44:47], v[36:39], v[116:119]
    ds_read_b128 v[64:67], v14 offset:20480
    v_mfma_f32_16x16x32_bf16 v[120:123], v[48:51], v[24:27], v[120:123]
    ds_read_b64_tr_b16 v[84:85], v22 offset:24576
    v_mfma_f32_16x16x32_bf16 v[124:127], v[48:51], v[28:31], v[124:127]
    ds_read_b64_tr_b16 v[86:87], v22 offset:27136
    v_mfma_f32_16x16x32_bf16 v[128:131], v[48:51], v[32:35], v[128:131]
    ds_read_b128 v[68:71], v14 offset:22528
    v_mfma_f32_16x16x32_bf16 v[132:135], v[48:51], v[36:39], v[132:135]
    s_add_u32 m0, s44, 49152
    s_nop 0
    buffer_load_dwordx4 v11, s[36:39], s47 offen lds
    v_mfma_f32_16x16x32_bf16 v[136:139], v[52:55], v[24:27], v[136:139]
    v_mfma_f32_16x16x32_bf16 v[140:143], v[52:55], v[28:31], v[140:143]
    s_add_u32 m0, s44, 50176
    s_nop 0
    buffer_load_dwordx4 v12, s[36:39], s47 offen lds
    s_add_u32 s47, s47, s48
    v_mfma_f32_16x16x32_bf16 v[144:147], v[52:55], v[32:35], v[144:147]
    v_mfma_f32_16x16x32_bf16 v[148:151], v[52:55], v[36:39], v[148:151]
    s_add_u32 m0, s45, 8192
    s_mov_b32 s46, 83072
    buffer_load_dwordx4 v10, s[32:35], s46 offen lds
    s_waitcnt lgkmcnt(0)
    v_mfma_f32_16x16x32_bf16 v[88:91], v[72:75], v[56:59], v[88:91]
    s_waitcnt vmcnt(6)
    s_barrier
    ds_read_b64_tr_b16 v[40:41], v15 offset:0
    ds_read_b64_tr_b16 v[42:43], v15 offset:2560
    v_mfma_f32_16x16x32_bf16 v[92:95], v[72:75], v[60:63], v[92:95]
    ds_read_b128 v[24:27], v13 offset:32768
    v_mfma_f32_16x16x32_bf16 v[96:99], v[72:75], v[64:67], v[96:99]
    ds_read_b64_tr_b16 v[44:45], v16 offset:0
    v_mfma_f32_16x16x32_bf16 v[100:103], v[72:75], v[68:71], v[100:103]
    ds_read_b64_tr_b16 v[46:47], v16 offset:2560
    v_mfma_f32_16x16x32_bf16 v[104:107], v[76:79], v[56:59], v[104:107]
    ds_read_b128 v[28:31], v13 offset:34816
    v_mfma_f32_16x16x32_bf16 v[108:111], v[76:79], v[60:63], v[108:111]
    ds_read_b64_tr_b16 v[48:49], v17 offset:0
    v_mfma_f32_16x16x32_bf16 v[112:115], v[76:79], v[64:67], v[112:115]
    ds_read_b64_tr_b16 v[50:51], v17 offset:2560
    v_mfma_f32_16x16x32_bf16 v[116:119], v[76:79], v[68:71], v[116:119]
    ds_read_b128 v[32:35], v13 offset:36864
    v_mfma_f32_16x16x32_bf16 v[120:123], v[80:83], v[56:59], v[120:123]
    ds_read_b64_tr_b16 v[52:53], v18 offset:0
    v_mfma_f32_16x16x32_bf16 v[124:127], v[80:83], v[60:63], v[124:127]
    ds_read_b64_tr_b16 v[54:55], v18 offset:2560
    v_mfma_f32_16x16x32_bf16 v[128:131], v[80:83], v[64:67], v[128:131]
    ds_read_b128 v[36:39], v13 offset:38912
    v_mfma_f32_16x16x32_bf16 v[132:135], v[80:83], v[68:71], v[132:135]
    s_add_u32 m0, s44, 73728
    s_nop 0
    buffer_load_dwordx4 v11, s[36:39], s47 offen lds
    v_mfma_f32_16x16x32_bf16 v[136:139], v[84:87], v[56:59], v[136:139]
    v_mfma_f32_16x16x32_bf16 v[140:143], v[84:87], v[60:63], v[140:143]
    s_add_u32 m0, s44, 74752
    s_nop 0
    buffer_load_dwordx4 v12, s[36:39], s47 offen lds
    s_add_u32 s47, s47, s48
    v_mfma_f32_16x16x32_bf16 v[144:147], v[84:87], v[64:67], v[144:147]
    v_mfma_f32_16x16x32_bf16 v[148:151], v[84:87], v[68:71], v[148:151]
    s_waitcnt lgkmcnt(0)
    v_mfma_f32_16x16x32_bf16 v[88:91], v[40:43], v[24:27], v[88:91]
    s_waitcnt vmcnt(5)
    s_barrier
    ds_read_b64_tr_b16 v[72:73], v15 offset:24576
    ds_read_b64_tr_b16 v[74:75], v15 offset:27136
    v_mfma_f32_16x16x32_bf16 v[92:95], v[40:43], v[28:31], v[92:95]
    ds_read_b128 v[56:59], v14 offset:32768
    v_mfma_f32_16x16x32_bf16 v[96:99], v[40:43], v[32:35], v[96:99]
    ds_read_b64_tr_b16 v[76:77], v16 offset:24576
    v_mfma_f32_16x16x32_bf16 v[100:103], v[40:43], v[36:39], v[100:103]
    ds_read_b64_tr_b16 v[78:79], v16 offset:27136
    v_mfma_f32_16x16x32_bf16 v[104:107], v[44:47], v[24:27], v[104:107]
    ds_read_b128 v[60:63], v14 offset:34816
    v_mfma_f32_16x16x32_bf16 v[108:111], v[44:47], v[28:31], v[108:111]
    ds_read_b64_tr_b16 v[80:81], v17 offset:24576
    v_mfma_f32_16x16x32_bf16 v[112:115], v[44:47], v[32:35], v[112:115]
    ds_read_b64_tr_b16 v[82:83], v17 offset:27136
    v_mfma_f32_16x16x32_bf16 v[116:119], v[44:47], v[36:39], v[116:119]
    ds_read_b128 v[64:67], v14 offset:36864
    v_mfma_f32_16x16x32_bf16 v[120:123], v[48:51], v[24:27], v[120:123]
    ds_read_b64_tr_b16 v[84:85], v18 offset:24576
    v_mfma_f32_16x16x32_bf16 v[124:127], v[48:51], v[28:31], v[124:127]
    ds_read_b64_tr_b16 v[86:87], v18 offset:27136
    v_mfma_f32_16x16x32_bf16 v[128:131], v[48:51], v[32:35], v[128:131]
    ds_read_b128 v[68:71], v14 offset:38912
    v_mfma_f32_16x16x32_bf16 v[132:135], v[48:51], v[36:39], v[132:135]
    v_mfma_f32_16x16x32_bf16 v[136:139], v[52:55], v[24:27], v[136:139]
    v_mfma_f32_16x16x32_bf16 v[140:143], v[52:55], v[28:31], v[140:143]
    v_mfma_f32_16x16x32_bf16 v[144:147], v[52:55], v[32:35], v[144:147]
    v_mfma_f32_16x16x32_bf16 v[148:151], v[52:55], v[36:39], v[148:151]
    s_waitcnt lgkmcnt(0)
    v_mfma_f32_16x16x32_bf16 v[88:91], v[72:75], v[56:59], v[88:91]
    s_waitcnt vmcnt(2)
    s_barrier
    ds_read_b64_tr_b16 v[40:41], v19 offset:0
    ds_read_b64_tr_b16 v[42:43], v19 offset:2560
    v_mfma_f32_16x16x32_bf16 v[92:95], v[72:75], v[60:63], v[92:95]
    ds_read_b128 v[24:27], v13 offset:0
    v_mfma_f32_16x16x32_bf16 v[96:99], v[72:75], v[64:67], v[96:99]
    ds_read_b64_tr_b16 v[44:45], v20 offset:0
    v_mfma_f32_16x16x32_bf16 v[100:103], v[72:75], v[68:71], v[100:103]
    ds_read_b64_tr_b16 v[46:47], v20 offset:2560
    v_mfma_f32_16x16x32_bf16 v[104:107], v[76:79], v[56:59], v[104:107]
    ds_read_b128 v[28:31], v13 offset:2048
    v_mfma_f32_16x16x32_bf16 v[108:111], v[76:79], v[60:63], v[108:111]
    ds_read_b64_tr_b16 v[48:49], v21 offset:0
    v_mfma_f32_16x16x32_bf16 v[112:115], v[76:79], v[64:67], v[112:115]
    ds_read_b64_tr_b16 v[50:51], v21 offset:2560
    v_mfma_f32_16x16x32_bf16 v[116:119], v[76:79], v[68:71], v[116:119]
    ds_read_b128 v[32:35], v13 offset:4096
    v_mfma_f32_16x16x32_bf16 v[120:123], v[80:83], v[56:59], v[120:123]
    ds_read_b64_tr_b16 v[52:53], v22 offset:0
    v_mfma_f32_16x16x32_bf16 v[124:127], v[80:83], v[60:63], v[124:127]
    ds_read_b64_tr_b16 v[54:55], v22 offset:2560
    v_mfma_f32_16x16x32_bf16 v[128:131], v[80:83], v[64:67], v[128:131]
    ds_read_b128 v[36:39], v13 offset:6144
    v_mfma_f32_16x16x32_bf16 v[132:135], v[80:83], v[68:71], v[132:135]
    v_mfma_f32_16x16x32_bf16 v[136:139], v[84:87], v[56:59], v[136:139]
    v_mfma_f32_16x16x32_bf16 v[140:143], v[84:87], v[60:63], v[140:143]
    v_mfma_f32_16x16x32_bf16 v[144:147], v[84:87], v[64:67], v[144:147]
    v_mfma_f32_16x16x32_bf16 v[148:151], v[84:87], v[68:71], v[148:151]
    s_waitcnt lgkmcnt(0)
    v_mfma_f32_16x16x32_bf16 v[88:91], v[40:43], v[24:27], v[88:91]
    s_waitcnt vmcnt(0)
    s_barrier
    ds_read_b64_tr_b16 v[72:73], v19 offset:24576
    ds_read_b64_tr_b16 v[74:75], v19 offset:27136
    v_mfma_f32_16x16x32_bf16 v[92:95], v[40:43], v[28:31], v[92:95]
    ds_read_b128 v[56:59], v14 offset:0
    v_mfma_f32_16x16x32_bf16 v[96:99], v[40:43], v[32:35], v[96:99]
    ds_read_b64_tr_b16 v[76:77], v20 offset:24576
    v_mfma_f32_16x16x32_bf16 v[100:103], v[40:43], v[36:39], v[100:103]
    ds_read_b64_tr_b16 v[78:79], v20 offset:27136
    v_mfma_f32_16x16x32_bf16 v[104:107], v[44:47], v[24:27], v[104:107]
    ds_read_b128 v[60:63], v14 offset:2048
    v_mfma_f32_16x16x32_bf16 v[108:111], v[44:47], v[28:31], v[108:111]
    ds_read_b64_tr_b16 v[80:81], v21 offset:24576
    v_mfma_f32_16x16x32_bf16 v[112:115], v[44:47], v[32:35], v[112:115]
    ds_read_b64_tr_b16 v[82:83], v21 offset:27136
    v_mfma_f32_16x16x32_bf16 v[116:119], v[44:47], v[36:39], v[116:119]
    ds_read_b128 v[64:67], v14 offset:4096
    v_mfma_f32_16x16x32_bf16 v[120:123], v[48:51], v[24:27], v[120:123]
    ds_read_b64_tr_b16 v[84:85], v22 offset:24576
    v_mfma_f32_16x16x32_bf16 v[124:127], v[48:51], v[28:31], v[124:127]
    ds_read_b64_tr_b16 v[86:87], v22 offset:27136
    v_mfma_f32_16x16x32_bf16 v[128:131], v[48:51], v[32:35], v[128:131]
    ds_read_b128 v[68:71], v14 offset:6144
    v_mfma_f32_16x16x32_bf16 v[132:135], v[48:51], v[36:39], v[132:135]
    v_mfma_f32_16x16x32_bf16 v[136:139], v[52:55], v[24:27], v[136:139]
    v_mfma_f32_16x16x32_bf16 v[140:143], v[52:55], v[28:31], v[140:143]
    v_mfma_f32_16x16x32_bf16 v[144:147], v[52:55], v[32:35], v[144:147]
    v_mfma_f32_16x16x32_bf16 v[148:151], v[52:55], v[36:39], v[148:151]
    s_waitcnt lgkmcnt(0)
    v_mfma_f32_16x16x32_bf16 v[88:91], v[72:75], v[56:59], v[88:91]
    v_mfma_f32_16x16x32_bf16 v[92:95], v[72:75], v[60:63], v[92:95]
    v_mfma_f32_16x16x32_bf16 v[96:99], v[72:75], v[64:67], v[96:99]
    v_mfma_f32_16x16x32_bf16 v[100:103], v[72:75], v[68:71], v[100:103]
    v_mfma_f32_16x16x32_bf16 v[104:107], v[76:79], v[56:59], v[104:107]
    v_mfma_f32_16x16x32_bf16 v[108:111], v[76:79], v[60:63], v[108:111]
    v_mfma_f32_16x16x32_bf16 v[112:115], v[76:79], v[64:67], v[112:115]
    v_mfma_f32_16x16x32_bf16 v[116:119], v[76:79], v[68:71], v[116:119]
    v_mfma_f32_16x16x32_bf16 v[120:123], v[80:83], v[56:59], v[120:123]
    v_mfma_f32_16x16x32_bf16 v[124:127], v[80:83], v[60:63], v[124:127]
    v_mfma_f32_16x16x32_bf16 v[128:131], v[80:83], v[64:67], v[128:131]
    v_mfma_f32_16x16x32_bf16 v[132:135], v[80:83], v[68:71], v[132:135]
    v_mfma_f32_16x16x32_bf16 v[136:139], v[84:87], v[56:59], v[136:139]
    v_mfma_f32_16x16x32_bf16 v[140:143], v[84:87], v[60:63], v[140:143]
    v_mfma_f32_16x16x32_bf16 v[144:147], v[84:87], v[64:67], v[144:147]
    v_mfma_f32_16x16x32_bf16 v[148:151], v[84:87], v[68:71], v[148:151]
    s_branch k1_kernel_EPI_QK
k1_kernel_VAR1:
    s_waitcnt vmcnt(2)
    s_barrier
    ds_read_b64_tr_b16 v[40:41], v15 offset:0
    ds_read_b64_tr_b16 v[42:43], v15 offset:2560
    ds_read_b128 v[24:27], v13 offset:0
    ds_read_b64_tr_b16 v[44:45], v16 offset:0
    ds_read_b64_tr_b16 v[46:47], v16 offset:2560
    ds_read_b128 v[28:31], v13 offset:2048
    ds_read_b64_tr_b16 v[48:49], v17 offset:0
    ds_read_b64_tr_b16 v[50:51], v17 offset:2560
    ds_read_b64_tr_b16 v[52:53], v18 offset:0
    ds_read_b64_tr_b16 v[54:55], v18 offset:2560
    s_add_u32 m0, s44, 73728
    s_nop 0
    buffer_load_dwordx4 v11, s[36:39], s47 offen lds
    s_add_u32 s47, s47, s48
    s_waitcnt lgkmcnt(0)
    v_mfma_f32_16x16x32_bf16 v[88:91], v[40:43], v[24:27], 0
    s_waitcnt vmcnt(2)
    s_barrier
    ds_read_b64_tr_b16 v[72:73], v15 offset:24576
    ds_read_b64_tr_b16 v[74:75], v15 offset:27136
    v_mfma_f32_16x16x32_bf16 v[92:95], v[40:43], v[28:31], 0
    ds_read_b128 v[56:59], v14 offset:0
    ds_read_b64_tr_b16 v[76:77], v16 offset:24576
    v_mfma_f32_16x16x32_bf16 v[104:107], v[44:47], v[24:27], 0
    ds_read_b64_tr_b16 v[78:79], v16 offset:27136
    ds_read_b128 v[60:63], v14 offset:2048
    v_mfma_f32_16x16x32_bf16 v[108:111], v[44:47], v[28:31], 0
    ds_read_b64_tr_b16 v[80:81], v17 offset:24576
    ds_read_b64_tr_b16 v[82:83], v17 offset:27136
    v_mfma_f32_16x16x32_bf16 v[120:123], v[48:51], v[24:27], 0
    ds_read_b64_tr_b16 v[84:85], v18 offset:24576
    ds_read_b64_tr_b16 v[86:87], v18 offset:27136
    v_mfma_f32_16x16x32_bf16 v[124:127], v[48:51], v[28:31], 0
    v_mfma_f32_16x16x32_bf16 v[136:139], v[52:55], v[24:27], 0
    s_add_u32 m0, s44, 0
    s_nop 0
    buffer_load_dwordx4 v11, s[36:39], s47 offen lds
    s_add_u32 s47, s47, s48
    v_mfma_f32_16x16x32_bf16 v[140:143], v[52:55], v[28:31], 0
    s_waitcnt lgkmcnt(0)
    v_mfma_f32_16x16x32_bf16 v[88:91], v[72:75], v[56:59], v[88:91]
    s_waitcnt vmcnt(2)
    s_barrier
    ds_read_b64_tr_b16 v[40:41], v19 offset:0
    ds_read_b64_tr_b16 v[42:43], v19 offset:2560
    v_mfma_f32_16x16x32_bf16 v[92:95], v[72:75], v[60:63], v[92:95]
    ds_read_b128 v[24:27], v13 offset:16384
    ds_read_b64_tr_b16 v[44:45], v20 offset:0
    v_mfma_f32_16x16x32_bf16 v[104:107], v[76:79], v[56:59], v[104:107]
    ds_read_b64_tr_b16 v[46:47], v20 offset:2560
    ds_read_b128 v[28:31], v13 offset:18432
    v_mfma_f32_16x16x32_bf16 v[108:111], v[76:79], v[60:63], v[108:111]
    ds_read_b64_tr_b16 v[48:49], v21 offset:0
    ds_read_b64_tr_b16 v[50:51], v21 offset:2560
    v_mfma_f32_16x16x32_bf16 v[120:123], v[80:83], v[56:59], v[120:123]
    ds_read_b64_tr_b16 v[52:53], v22 offset:0
    ds_read_b64_tr_b16 v[54:55], v22 offset:2560
    v_mfma_f32_16x16x32_bf16 v[124:127], v[80:83], v[60:63], v[124:127]
    v_mfma_f32_16x16x32_bf16 v[136:139], v[84:87], v[56:59], v[136:139]
    s_add_u32 m0, s44, 24576
    s_nop 0
    buffer_load_dwordx4 v11, s[36:39], s47 offen lds
    s_add_u32 s47, s47, s48
    v_mfma_f32_16x16x32_bf16 v[140:143], v[84:87], v[60:63], v[140:143]
    s_waitcnt lgkmcnt(0)
    v_mfma_f32_16x16x32_bf16 v[88:91], v[40:43], v[24:27], v[88:91]
    s_waitcnt vmcnt(2)
    s_barrier
    ds_read_b64_tr_b16 v[72:73], v19 offset:24576
    ds_read_b64_tr_b16 v[74:75], v19 offset:27136
    v_mfma_f32_16x16x32_bf16 v[92:95], v[40:43], v[28:31], v[92:95]
    ds_read_b128 v[56:59], v14 offset:16384
    ds_read_b64_tr_b16 v[76:77], v20 offset:24576
    v_mfma_f32_16x16x32_bf16 v[104:107], v[44:47], v[24:27], v[104:107]
    ds_read_b64_tr_b16 v[78:79], v20 offset:27136
    ds_read_b128 v[60:63], v14 offset:18432
    v_mfma_f32_16x16x32_bf16 v[108:111], v[44:47], v[28:31], v[108:111]
    ds_read_b64_tr_b16 v[80:81], v21 offset:24576
    ds_read_b64_tr_b16 v[82:83], v21 offset:27136
    v_mfma_f32_16x16x32_bf16 v[120:123], v[48:51], v[24:27], v[120:123]
    ds_read_b64_tr_b16 v[84:85], v22 offset:24576
    ds_read_b64_tr_b16 v[86:87], v22 offset:27136
    v_mfma_f32_16x16x32_bf16 v[124:127], v[48:51], v[28:31], v[124:127]
    v_mfma_f32_16x16x32_bf16 v[136:139], v[52:55], v[24:27], v[136:139]
    s_add_u32 m0, s44, 49152
    s_nop 0
    buffer_load_dwordx4 v11, s[36:39], s47 offen lds
    s_add_u32 s47, s47, s48
    v_mfma_f32_16x16x32_bf16 v[140:143], v[52:55], v[28:31], v[140:143]
    s_waitcnt lgkmcnt(0)
    v_mfma_f32_16x16x32_bf16 v[88:91], v[72:75], v[56:59], v[88:91]
    s_waitcnt vmcnt(2)
    s_barrier
    ds_read_b64_tr_b16 v[40:41], v15 offset:0
    ds_read_b64_tr_b16 v[42:43], v15 offset:2560
    v_mfma_f32_16x16x32_bf16 v[92:95], v[72:75], v[60:63], v[92:95]
    ds_read_b128 v[24:27], v13 offset:32768
    ds_read_b64_tr_b16 v[44:45], v16 offset:0
    v_mfma_f32_16x16x32_bf16 v[104:107], v[76:79], v[56:59], v[104:107]
    ds_read_b64_tr_b16 v[46:47], v16 offset:2560
    ds_read_b128 v[28:31], v13 offset:34816
    v_mfma_f32_16x16x32_bf16 v[108:111], v[76:79], v[60:63], v[108:111]
    ds_read_b64_tr_b16 v[48:49], v17 offset:0
    ds_read_b64_tr_b16 v[50:51], v17 offset:2560
    v_mfma_f32_16x16x32_bf16 v[120:123], v[80:83], v[56:59], v[120:123]
    ds_read_b64_tr_b16 v[52:53], v18 offset:0
    ds_read_b64_tr_b16 v[54:55], v18 offset:2560
    v_mfma_f32_16x16x32_bf16 v[124:127], v[80:83], v[60:63], v[124:127]
    v_mfma_f32_16x16x32_bf16 v[136:139], v[84:87], v[56:59], v[136:139]
    s_add_u32 m0, s44, 73728
    s_nop 0
    buffer_load_dwordx4 v11, s[36:39], s47 offen lds
    s_add_u32 s47, s47, s48
    v_mfma_f32_16x16x32_bf16 v[140:143], v[84:87], v[60:63], v[140:143]
    s_waitcnt lgkmcnt(0)
    v_mfma_f32_16x16x32_bf16 v[88:91], v[40:43], v[24:27], v[88:91]
    s_waitcnt vmcnt(2)
    s_barrier
    ds_read_b64_tr_b16 v[72:73], v15 offset:24576
    ds_read_b64_tr_b16 v[74:75], v15 offset:27136
    v_mfma_f32_16x16x32_bf16 v[92:95], v[40:43], v[28:31], v[92:95]
    ds_read_b128 v[56:59], v14 offset:32768
    ds_read_b64_tr_b16 v[76:77], v16 offset:24576
    v_mfma_f32_16x16x32_bf16 v[104:107], v[44:47], v[24:27], v[104:107]
    ds_read_b64_tr_b16 v[78:79], v16 offset:27136
    ds_read_b128 v[60:63], v14 offset:34816
    v_mfma_f32_16x16x32_bf16 v[108:111], v[44:47], v[28:31], v[108:111]
    ds_read_b64_tr_b16 v[80:81], v17 offset:24576
    ds_read_b64_tr_b16 v[82:83], v17 offset:27136
    v_mfma_f32_16x16x32_bf16 v[120:123], v[48:51], v[24:27], v[120:123]
    ds_read_b64_tr_b16 v[84:85], v18 offset:24576
    ds_read_b64_tr_b16 v[86:87], v18 offset:27136
    v_mfma_f32_16x16x32_bf16 v[124:127], v[48:51], v[28:31], v[124:127]
    v_mfma_f32_16x16x32_bf16 v[136:139], v[52:55], v[24:27], v[136:139]
    s_add_u32 m0, s44, 0
    s_nop 0
    buffer_load_dwordx4 v11, s[36:39], s47 offen lds
    s_add_u32 s47, s47, s48
    v_mfma_f32_16x16x32_bf16 v[140:143], v[52:55], v[28:31], v[140:143]
    s_waitcnt lgkmcnt(0)
    v_mfma_f32_16x16x32_bf16 v[88:91], v[72:75], v[56:59], v[88:91]
    s_waitcnt vmcnt(2)
    s_barrier
    ds_read_b64_tr_b16 v[40:41], v19 offset:0
    ds_read_b64_tr_b16 v[42:43], v19 offset:2560
    v_mfma_f32_16x16x32_bf16 v[92:95], v[72:75], v[60:63], v[92:95]
    ds_read_b128 v[24:27], v13 offset:0
    ds_read_b64_tr_b16 v[44:45], v20 offset:0
    v_mfma_f32_16x16x32_bf16 v[104:107], v[76:79], v[56:59], v[104:107]
    ds_read_b64_tr_b16 v[46:47], v20 offset:2560
    ds_read_b128 v[28:31], v13 offset:2048
    v_mfma_f32_16x16x32_bf16 v[108:111], v[76:79], v[60:63], v[108:111]
    ds_read_b64_tr_b16 v[48:49], v21 offset:0
    ds_read_b64_tr_b16 v[50:51], v21 offset:2560
    v_mfma_f32_16x16x32_bf16 v[120:123], v[80:83], v[56:59], v[120:123]
    ds_read_b64_tr_b16 v[52:53], v22 offset:0
    ds_read_b64_tr_b16 v[54:55], v22 offset:2560
    v_mfma_f32_16x16x32_bf16 v[124:127], v[80:83], v[60:63], v[124:127]
    v_mfma_f32_16x16x32_bf16 v[136:139], v[84:87], v[56:59], v[136:139]
    s_add_u32 m0, s44, 24576
    s_nop 0
    buffer_load_dwordx4 v11, s[36:39], s47 offen lds
    s_add_u32 s47, s47, s48
    v_mfma_f32_16x16x32_bf16 v[140:143], v[84:87], v[60:63], v[140:143]
    s_waitcnt lgkmcnt(0)
    v_mfma_f32_16x16x32_bf16 v[88:91], v[40:43], v[24:27], v[88:91]
    s_waitcnt vmcnt(2)
    s_barrier
    ds_read_b64_tr_b16 v[72:73], v19 offset:24576
    ds_read_b64_tr_b16 v[74:75], v19 offset:27136
    v_mfma_f32_16x16x32_bf16 v[92:95], v[40:43], v[28:31], v[92:95]
    ds_read_b128 v[56:59], v14 offset:0
    ds_read_b64_tr_b16 v[76:77], v20 offset:24576
    v_mfma_f32_16x16x32_bf16 v[104:107], v[44:47], v[24:27], v[104:107]
    ds_read_b64_tr_b16 v[78:79], v20 offset:27136
    ds_read_b128 v[60:63], v14 offset:2048
    v_mfma_f32_16x16x32_bf16 v[108:111], v[44:47], v[28:31], v[108:111]
    ds_read_b64_tr_b16 v[80:81], v21 offset:24576
    ds_read_b64_tr_b16 v[82:83], v21 offset:27136
    v_mfma_f32_16x16x32_bf16 v[120:123], v[48:51], v[24:27], v[120:123]
    ds_read_b64_tr_b16 v[84:85], v22 offset:24576
    ds_read_b64_tr_b16 v[86:87], v22 offset:27136
    v_mfma_f32_16x16x32_bf16 v[124:127], v[48:51], v[28:31], v[124:127]
    v_mfma_f32_16x16x32_bf16 v[136:139], v[52:55], v[24:27], v[136:139]
    s_add_u32 m0, s44, 49152
    s_nop 0
    buffer_load_dwordx4 v11, s[36:39], s47 offen lds
    s_add_u32 s47, s47, s48
    v_mfma_f32_16x16x32_bf16 v[140:143], v[52:55], v[28:31], v[140:143]
    s_waitcnt lgkmcnt(0)
    v_mfma_f32_16x16x32_bf16 v[88:91], v[72:75], v[56:59], v[88:91]
    s_waitcnt vmcnt(2)
    s_barrier
    ds_read_b64_tr_b16 v[40:41], v15 offset:0
    ds_read_b64_tr_b16 v[42:43], v15 offset:2560
    v_mfma_f32_16x16x32_bf16 v[92:95], v[72:75], v[60:63], v[92:95]
    ds_read_b128 v[24:27], v13 offset:16384
    ds_read_b64_tr_b16 v[44:45], v16 offset:0
    v_mfma_f32_16x16x32_bf16 v[104:107], v[76:79], v[56:59], v[104:107]
    ds_read_b64_tr_b16 v[46:47], v16 offset:2560
    ds_read_b128 v[28:31], v13 offset:18432
    v_mfma_f32_16x16x32_bf16 v[108:111], v[76:79], v[60:63], v[108:111]
    ds_read_b64_tr_b16 v[48:49], v17 offset:0
    ds_read_b64_tr_b16 v[50:51], v17 offset:2560
    v_mfma_f32_16x16x32_bf16 v[120:123], v[80:83], v[56:59], v[120:123]
    ds_read_b64_tr_b16 v[52:53], v18 offset:0
    ds_read_b64_tr_b16 v[54:55], v18 offset:2560
    v_mfma_f32_16x16x32_bf16 v[124:127], v[80:83], v[60:63], v[124:127]
    v_mfma_f32_16x16x32_bf16 v[136:139], v[84:87], v[56:59], v[136:139]
    s_add_u32 m0, s44, 73728
    s_nop 0
    buffer_load_dwordx4 v11, s[36:39], s47 offen lds
    s_add_u32 s47, s47, s48
    v_mfma_f32_16x16x32_bf16 v[140:143], v[84:87], v[60:63], v[140:143]
    s_waitcnt lgkmcnt(0)
    v_mfma_f32_16x16x32_bf16 v[88:91], v[40:43], v[24:27], v[88:91]
    s_waitcnt vmcnt(2)
    s_barrier
    ds_read_b64_tr_b16 v[72:73], v15 offset:24576
    ds_read_b64_tr_b16 v[74:75], v15 offset:27136
    v_mfma_f32_16x16x32_bf16 v[92:95], v[40:43], v[28:31], v[92:95]
    ds_read_b128 v[56:59], v14 offset:16384
    ds_read_b64_tr_b16 v[76:77], v16 offset:24576
    v_mfma_f32_16x16x32_bf16 v[104:107], v[44:47], v[24:27], v[104:107]
    ds_read_b64_tr_b16 v[78:79], v16 offset:27136
    ds_read_b128 v[60:63], v14 offset:18432
    v_mfma_f32_16x16x32_bf16 v[108:111], v[44:47], v[28:31], v[108:111]
    ds_read_b64_tr_b16 v[80:81], v17 offset:24576
    ds_read_b64_tr_b16 v[82:83], v17 offset:27136
    v_mfma_f32_16x16x32_bf16 v[120:123], v[48:51], v[24:27], v[120:123]
    ds_read_b64_tr_b16 v[84:85], v18 offset:24576
    ds_read_b64_tr_b16 v[86:87], v18 offset:27136
    v_mfma_f32_16x16x32_bf16 v[124:127], v[48:51], v[28:31], v[124:127]
    v_mfma_f32_16x16x32_bf16 v[136:139], v[52:55], v[24:27], v[136:139]
    s_add_u32 m0, s44, 0
    s_nop 0
    buffer_load_dwordx4 v11, s[36:39], s47 offen lds
    s_add_u32 s47, s47, s48
    v_mfma_f32_16x16x32_bf16 v[140:143], v[52:55], v[28:31], v[140:143]
    s_waitcnt lgkmcnt(0)
    v_mfma_f32_16x16x32_bf16 v[88:91], v[72:75], v[56:59], v[88:91]
    s_waitcnt vmcnt(2)
    s_barrier
    ds_read_b64_tr_b16 v[40:41], v19 offset:0
    ds_read_b64_tr_b16 v[42:43], v19 offset:2560
    v_mfma_f32_16x16x32_bf16 v[92:95], v[72:75], v[60:63], v[92:95]
    ds_read_b128 v[24:27], v13 offset:32768
    ds_read_b64_tr_b16 v[44:45], v20 offset:0
    v_mfma_f32_16x16x32_bf16 v[104:107], v[76:79], v[56:59], v[104:107]
    ds_read_b64_tr_b16 v[46:47], v20 offset:2560
    ds_read_b128 v[28:31], v13 offset:34816
    v_mfma_f32_16x16x32_bf16 v[108:111], v[76:79], v[60:63], v[108:111]
    ds_read_b64_tr_b16 v[48:49], v21 offset:0
    ds_read_b64_tr_b16 v[50:51], v21 offset:2560
    v_mfma_f32_16x16x32_bf16 v[120:123], v[80:83], v[56:59], v[120:123]
    ds_read_b64_tr_b16 v[52:53], v22 offset:0
    ds_read_b64_tr_b16 v[54:55], v22 offset:2560
    v_mfma_f32_16x16x32_bf16 v[124:127], v[80:83], v[60:63], v[124:127]
    v_mfma_f32_16x16x32_bf16 v[136:139], v[84:87], v[56:59], v[136:139]
    s_add_u32 m0, s44, 24576
    s_nop 0
    buffer_load_dwordx4 v11, s[36:39], s47 offen lds
    s_add_u32 s47, s47, s48
    v_mfma_f32_16x16x32_bf16 v[140:143], v[84:87], v[60:63], v[140:143]
    s_waitcnt lgkmcnt(0)
    v_mfma_f32_16x16x32_bf16 v[88:91], v[40:43], v[24:27], v[88:91]
    s_waitcnt vmcnt(2)
    s_barrier
    ds_read_b64_tr_b16 v[72:73], v19 offset:24576
    ds_read_b64_tr_b16 v[74:75], v19 offset:27136
    v_mfma_f32_16x16x32_bf16 v[92:95], v[40:43], v[28:31], v[92:95]
    ds_read_b128 v[56:59], v14 offset:32768
    ds_read_b64_tr_b16 v[76:77], v20 offset:24576
    v_mfma_f32_16x16x32_bf16 v[104:107], v[44:47], v[24:27], v[104:107]
    ds_read_b64_tr_b16 v[78:79], v20 offset:27136
    ds_read_b128 v[60:63], v14 offset:34816
    v_mfma_f32_16x16x32_bf16 v[108:111], v[44:47], v[28:31], v[108:111]
    ds_read_b64_tr_b16 v[80:81], v21 offset:24576
    ds_read_b64_tr_b16 v[82:83], v21 offset:27136
    v_mfma_f32_16x16x32_bf16 v[120:123], v[48:51], v[24:27], v[120:123]
    ds_read_b64_tr_b16 v[84:85], v22 offset:24576
    ds_read_b64_tr_b16 v[86:87], v22 offset:27136
    v_mfma_f32_16x16x32_bf16 v[124:127], v[48:51], v[28:31], v[124:127]
    v_mfma_f32_16x16x32_bf16 v[136:139], v[52:55], v[24:27], v[136:139]
    s_add_u32 m0, s44, 49152
    s_nop 0
    buffer_load_dwordx4 v11, s[36:39], s47 offen lds
    s_add_u32 s47, s47, s48
    v_mfma_f32_16x16x32_bf16 v[140:143], v[52:55], v[28:31], v[140:143]
    s_waitcnt lgkmcnt(0)
    v_mfma_f32_16x16x32_bf16 v[88:91], v[72:75], v[56:59], v[88:91]
    s_waitcnt vmcnt(2)
    s_barrier
    ds_read_b64_tr_b16 v[40:41], v15 offset:0
    ds_read_b64_tr_b16 v[42:43], v15 offset:2560
    v_mfma_f32_16x16x32_bf16 v[92:95], v[72:75], v[60:63], v[92:95]
    ds_read_b128 v[24:27], v13 offset:0
    ds_read_b64_tr_b16 v[44:45], v16 offset:0
    v_mfma_f32_16x16x32_bf16 v[104:107], v[76:79], v[56:59], v[104:107]
    ds_read_b64_tr_b16 v[46:47], v16 offset:2560
    ds_read_b128 v[28:31], v13 offset:2048
    v_mfma_f32_16x16x32_bf16 v[108:111], v[76:79], v[60:63], v[108:111]
    ds_read_b64_tr_b16 v[48:49], v17 offset:0
    ds_read_b64_tr_b16 v[50:51], v17 offset:2560
    v_mfma_f32_16x16x32_bf16 v[120:123], v[80:83], v[56:59], v[120:123]
    ds_read_b64_tr_b16 v[52:53], v18 offset:0
    ds_read_b64_tr_b16 v[54:55], v18 offset:2560
    v_mfma_f32_16x16x32_bf16 v[124:127], v[80:83], v[60:63], v[124:127]
    v_mfma_f32_16x16x32_bf16 v[136:139], v[84:87], v[56:59], v[136:139]
    s_add_u32 m0, s44, 73728
    s_nop 0
    buffer_load_dwordx4 v11, s[36:39], s47 offen lds
    s_add_u32 s47, s47, s48
    v_mfma_f32_16x16x32_bf16 v[140:143], v[84:87], v[60:63], v[140:143]
    s_waitcnt lgkmcnt(0)
    v_mfma_f32_16x16x32_bf16 v[88:91], v[40:43], v[24:27], v[88:91]
    s_waitcnt vmcnt(2)
    s_barrier
    ds_read_b64_tr_b16 v[72:73], v15 offset:24576
    ds_read_b64_tr_b16 v[74:75], v15 offset:27136
    v_mfma_f32_16x16x32_bf16 v[92:95], v[40:43], v[28:31], v[92:95]
    ds_read_b128 v[56:59], v14 offset:0
    ds_read_b64_tr_b16 v[76:77], v16 offset:24576
    v_mfma_f32_16x16x32_bf16 v[104:107], v[44:47], v[24:27], v[104:107]
    ds_read_b64_tr_b16 v[78:79], v16 offset:27136
    ds_read_b128 v[60:63], v14 offset:2048
    v_mfma_f32_16x16x32_bf16 v[108:111], v[44:47], v[28:31], v[108:111]
    ds_read_b64_tr_b16 v[80:81], v17 offset:24576
    ds_read_b64_tr_b16 v[82:83], v17 offset:27136
    v_mfma_f32_16x16x32_bf16 v[120:123], v[48:51], v[24:27], v[120:123]
    ds_read_b64_tr_b16 v[84:85], v18 offset:24576
    ds_read_b64_tr_b16 v[86:87], v18 offset:27136
    v_mfma_f32_16x16x32_bf16 v[124:127], v[48:51], v[28:31], v[124:127]
    v_mfma_f32_16x16x32_bf16 v[136:139], v[52:55], v[24:27], v[136:139]
    s_add_u32 m0, s44, 0
    s_nop 0
    buffer_load_dwordx4 v11, s[36:39], s47 offen lds
    s_add_u32 s47, s47, s48
    v_mfma_f32_16x16x32_bf16 v[140:143], v[52:55], v[28:31], v[140:143]
    s_waitcnt lgkmcnt(0)
    v_mfma_f32_16x16x32_bf16 v[88:91], v[72:75], v[56:59], v[88:91]
    s_waitcnt vmcnt(2)
    s_barrier
    ds_read_b64_tr_b16 v[40:41], v19 offset:0
    ds_read_b64_tr_b16 v[42:43], v19 offset:2560
    v_mfma_f32_16x16x32_bf16 v[92:95], v[72:75], v[60:63], v[92:95]
    ds_read_b128 v[24:27], v13 offset:16384
    ds_read_b64_tr_b16 v[44:45], v20 offset:0
    v_mfma_f32_16x16x32_bf16 v[104:107], v[76:79], v[56:59], v[104:107]
    ds_read_b64_tr_b16 v[46:47], v20 offset:2560
    ds_read_b128 v[28:31], v13 offset:18432
    v_mfma_f32_16x16x32_bf16 v[108:111], v[76:79], v[60:63], v[108:111]
    ds_read_b64_tr_b16 v[48:49], v21 offset:0
    ds_read_b64_tr_b16 v[50:51], v21 offset:2560
    v_mfma_f32_16x16x32_bf16 v[120:123], v[80:83], v[56:59], v[120:123]
    ds_read_b64_tr_b16 v[52:53], v22 offset:0
    ds_read_b64_tr_b16 v[54:55], v22 offset:2560
    v_mfma_f32_16x16x32_bf16 v[124:127], v[80:83], v[60:63], v[124:127]
    v_mfma_f32_16x16x32_bf16 v[136:139], v[84:87], v[56:59], v[136:139]
    s_add_u32 m0, s44, 24576
    s_nop 0
    buffer_load_dwordx4 v11, s[36:39], s47 offen lds
    s_add_u32 s47, s47, s48
    v_mfma_f32_16x16x32_bf16 v[140:143], v[84:87], v[60:63], v[140:143]
    s_waitcnt lgkmcnt(0)
    v_mfma_f32_16x16x32_bf16 v[88:91], v[40:43], v[24:27], v[88:91]
    s_waitcnt vmcnt(2)
    s_barrier
    ds_read_b64_tr_b16 v[72:73], v19 offset:24576
    ds_read_b64_tr_b16 v[74:75], v19 offset:27136
    v_mfma_f32_16x16x32_bf16 v[92:95], v[40:43], v[28:31], v[92:95]
    ds_read_b128 v[56:59], v14 offset:16384
    ds_read_b64_tr_b16 v[76:77], v20 offset:24576
    v_mfma_f32_16x16x32_bf16 v[104:107], v[44:47], v[24:27], v[104:107]
    ds_read_b64_tr_b16 v[78:79], v20 offset:27136
    ds_read_b128 v[60:63], v14 offset:18432
    v_mfma_f32_16x16x32_bf16 v[108:111], v[44:47], v[28:31], v[108:111]
    ds_read_b64_tr_b16 v[80:81], v21 offset:24576
    ds_read_b64_tr_b16 v[82:83], v21 offset:27136
    v_mfma_f32_16x16x32_bf16 v[120:123], v[48:51], v[24:27], v[120:123]
    ds_read_b64_tr_b16 v[84:85], v22 offset:24576
    ds_read_b64_tr_b16 v[86:87], v22 offset:27136
    v_mfma_f32_16x16x32_bf16 v[124:127], v[48:51], v[28:31], v[124:127]
    v_mfma_f32_16x16x32_bf16 v[136:139], v[52:55], v[24:27], v[136:139]
    s_add_u32 m0, s44, 49152
    s_nop 0
    buffer_load_dwordx4 v11, s[36:39], s47 offen lds
    s_add_u32 s47, s47, s48
    v_mfma_f32_16x16x32_bf16 v[140:143], v[52:55], v[28:31], v[140:143]
    s_waitcnt lgkmcnt(0)
    v_mfma_f32_16x16x32_bf16 v[88:91], v[72:75], v[56:59], v[88:91]
    s_waitcnt vmcnt(2)
    s_barrier
    ds_read_b64_tr_b16 v[40:41], v15 offset:0
    ds_read_b64_tr_b16 v[42:43], v15 offset:2560
    v_mfma_f32_16x16x32_bf16 v[92:95], v[72:75], v[60:63], v[92:95]
    ds_read_b128 v[24:27], v13 offset:32768
    ds_read_b64_tr_b16 v[44:45], v16 offset:0
    v_mfma_f32_16x16x32_bf16 v[104:107], v[76:79], v[56:59], v[104:107]
    ds_read_b64_tr_b16 v[46:47], v16 offset:2560
    ds_read_b128 v[28:31], v13 offset:34816
    v_mfma_f32_16x16x32_bf16 v[108:111], v[76:79], v[60:63], v[108:111]
    ds_read_b64_tr_b16 v[48:49], v17 offset:0
    ds_read_b64_tr_b16 v[50:51], v17 offset:2560
    v_mfma_f32_16x16x32_bf16 v[120:123], v[80:83], v[56:59], v[120:123]
    ds_read_b64_tr_b16 v[52:53], v18 offset:0
    ds_read_b64_tr_b16 v[54:55], v18 offset:2560
    v_mfma_f32_16x16x32_bf16 v[124:127], v[80:83], v[60:63], v[124:127]
    v_mfma_f32_16x16x32_bf16 v[136:139], v[84:87], v[56:59], v[136:139]
    s_add_u32 m0, s44, 73728
    s_nop 0
    buffer_load_dwordx4 v11, s[36:39], s47 offen lds
    s_add_u32 s47, s47, s48
    v_mfma_f32_16x16x32_bf16 v[140:143], v[84:87], v[60:63], v[140:143]
    s_waitcnt lgkmcnt(0)
    v_mfma_f32_16x16x32_bf16 v[88:91], v[40:43], v[24:27], v[88:91]
    s_waitcnt vmcnt(2)
    s_barrier
    ds_read_b64_tr_b16 v[72:73], v15 offset:24576
    ds_read_b64_tr_b16 v[74:75], v15 offset:27136
    v_mfma_f32_16x16x32_bf16 v[92:95], v[40:43], v[28:31], v[92:95]
    ds_read_b128 v[56:59], v14 offset:32768
    ds_read_b64_tr_b16 v[76:77], v16 offset:24576
    v_mfma_f32_16x16x32_bf16 v[104:107], v[44:47], v[24:27], v[104:107]
    ds_read_b64_tr_b16 v[78:79], v16 offset:27136
    ds_read_b128 v[60:63], v14 offset:34816
    v_mfma_f32_16x16x32_bf16 v[108:111], v[44:47], v[28:31], v[108:111]
    ds_read_b64_tr_b16 v[80:81], v17 offset:24576
    ds_read_b64_tr_b16 v[82:83], v17 offset:27136
    v_mfma_f32_16x16x32_bf16 v[120:123], v[48:51], v[24:27], v[120:123]
    ds_read_b64_tr_b16 v[84:85], v18 offset:24576
    ds_read_b64_tr_b16 v[86:87], v18 offset:27136
    v_mfma_f32_16x16x32_bf16 v[124:127], v[48:51], v[28:31], v[124:127]
    v_mfma_f32_16x16x32_bf16 v[136:139], v[52:55], v[24:27], v[136:139]
    v_mfma_f32_16x16x32_bf16 v[140:143], v[52:55], v[28:31], v[140:143]
    s_waitcnt lgkmcnt(0)
    v_mfma_f32_16x16x32_bf16 v[88:91], v[72:75], v[56:59], v[88:91]
    s_waitcnt vmcnt(1)
    s_barrier
    ds_read_b64_tr_b16 v[40:41], v19 offset:0
    ds_read_b64_tr_b16 v[42:43], v19 offset:2560
    v_mfma_f32_16x16x32_bf16 v[92:95], v[72:75], v[60:63], v[92:95]
    ds_read_b128 v[24:27], v13 offset:0
    ds_read_b64_tr_b16 v[44:45], v20 offset:0
    v_mfma_f32_16x16x32_bf16 v[104:107], v[76:79], v[56:59], v[104:107]
    ds_read_b64_tr_b16 v[46:47], v20 offset:2560
    ds_read_b128 v[28:31], v13 offset:2048
    v_mfma_f32_16x16x32_bf16 v[108:111], v[76:79], v[60:63], v[108:111]
    ds_read_b64_tr_b16 v[48:49], v21 offset:0
    ds_read_b64_tr_b16 v[50:51], v21 offset:2560
    v_mfma_f32_16x16x32_bf16 v[120:123], v[80:83], v[56:59], v[120:123]
    ds_read_b64_tr_b16 v[52:53], v22 offset:0
    ds_read_b64_tr_b16 v[54:55], v22 offset:2560
    v_mfma_f32_16x16x32_bf16 v[124:127], v[80:83], v[60:63], v[124:127]
    v_mfma_f32_16x16x32_bf16 v[136:139], v[84:87], v[56:59], v[136:139]
    v_mfma_f32_16x16x32_bf16 v[140:143], v[84:87], v[60:63], v[140:143]
    s_waitcnt lgkmcnt(0)
    v_mfma_f32_16x16x32_bf16 v[88:91], v[40:43], v[24:27], v[88:91]
    s_waitcnt vmcnt(0)
    s_barrier
    ds_read_b64_tr_b16 v[72:73], v19 offset:24576
    ds_read_b64_tr_b16 v[74:75], v19 offset:27136
    v_mfma_f32_16x16x32_bf16 v[92:95], v[40:43], v[28:31], v[92:95]
    ds_read_b128 v[56:59], v14 offset:0
    ds_read_b64_tr_b16 v[76:77], v20 offset:24576
    v_mfma_f32_16x16x32_bf16 v[104:107], v[44:47], v[24:27], v[104:107]
    ds_read_b64_tr_b16 v[78:79], v20 offset:27136
    ds_read_b128 v[60:63], v14 offset:2048
    v_mfma_f32_16x16x32_bf16 v[108:111], v[44:47], v[28:31], v[108:111]
    ds_read_b64_tr_b16 v[80:81], v21 offset:24576
    ds_read_b64_tr_b16 v[82:83], v21 offset:27136
    v_mfma_f32_16x16x32_bf16 v[120:123], v[48:51], v[24:27], v[120:123]
    ds_read_b64_tr_b16 v[84:85], v22 offset:24576
    ds_read_b64_tr_b16 v[86:87], v22 offset:27136
    v_mfma_f32_16x16x32_bf16 v[124:127], v[48:51], v[28:31], v[124:127]
    v_mfma_f32_16x16x32_bf16 v[136:139], v[52:55], v[24:27], v[136:139]
    v_mfma_f32_16x16x32_bf16 v[140:143], v[52:55], v[28:31], v[140:143]
    s_waitcnt lgkmcnt(0)
    v_mfma_f32_16x16x32_bf16 v[88:91], v[72:75], v[56:59], v[88:91]
    v_mfma_f32_16x16x32_bf16 v[92:95], v[72:75], v[60:63], v[92:95]
    v_mfma_f32_16x16x32_bf16 v[104:107], v[76:79], v[56:59], v[104:107]
    v_mfma_f32_16x16x32_bf16 v[108:111], v[76:79], v[60:63], v[108:111]
    v_mfma_f32_16x16x32_bf16 v[120:123], v[80:83], v[56:59], v[120:123]
    v_mfma_f32_16x16x32_bf16 v[124:127], v[80:83], v[60:63], v[124:127]
    v_mfma_f32_16x16x32_bf16 v[136:139], v[84:87], v[56:59], v[136:139]
    v_mfma_f32_16x16x32_bf16 v[140:143], v[84:87], v[60:63], v[140:143]
    s_branch k1_kernel_EPI_QKH
k1_kernel_VAR2:
    s_waitcnt vmcnt(6)
    s_barrier
    ds_read_b64_tr_b16 v[40:41], v15 offset:0
    ds_read_b64_tr_b16 v[42:43], v15 offset:2560
    ds_read_b128 v[24:27], v13 offset:0
    ds_read_b64_tr_b16 v[44:45], v16 offset:0
    ds_read_b64_tr_b16 v[46:47], v16 offset:2560
    ds_read_b128 v[28:31], v13 offset:2048
    ds_read_b64_tr_b16 v[48:49], v17 offset:0
    ds_read_b64_tr_b16 v[50:51], v17 offset:2560
    ds_read_b128 v[32:35], v13 offset:4096
    ds_read_b64_tr_b16 v[52:53], v18 offset:0
    ds_read_b64_tr_b16 v[54:55], v18 offset:2560
    ds_read_b128 v[36:39], v13 offset:6144
    s_add_u32 m0, s44, 73728
    s_nop 0
    buffer_load_dwordx4 v11, s[36:39], s47 offen lds
    s_add_u32 m0, s44, 74752
    s_nop 0
    buffer_load_dwordx4 v12, s[36:39], s47 offen lds
    s_add_u32 s47, s47, s48
    s_add_u32 m0, s45, 32768
    s_mov_b32 s46, 256
    buffer_load_dwordx4 v10, s[32:35], s46 offen lds
    s_waitcnt lgkmcnt(0)
    v_mfma_f32_16x16x32_bf16 v[88:91], v[24:27], v[40:43], 0
    s_waitcnt vmcnt(6)
    s_barrier
    ds_read_b64_tr_b16 v[72:73], v15 offset:24576
    ds_read_b64_tr_b16 v[74:75], v15 offset:27136
    v_mfma_f32_16x16x32_bf16 v[92:95], v[28:31], v[40:43], 0
    ds_read_b128 v[56:59], v14 offset:0
    v_mfma_f32_16x16x32_bf16 v[96:99], v[32:35], v[40:43], 0
    ds_read_b64_tr_b16 v[76:77], v16 offset:24576
    v_mfma_f32_16x16x32_bf16 v[100:103], v[36:39], v[40:43], 0
    ds_read_b64_tr_b16 v[78:79], v16 offset:27136
    v_mfma_f32_16x16x32_bf16 v[104:107], v[24:27], v[44:47], 0
    ds_read_b128 v[60:63], v14 offset:2048
    v_mfma_f32_16x16x32_bf16 v[108:111], v[28:31], v[44:47], 0
    ds_read_b64_tr_b16 v[80:81], v17 offset:24576
    v_mfma_f32_16x16x32_bf16 v[112:115], v[32:35], v[44:47], 0
    ds_read_b64_tr_b16 v[82:83], v17 offset:27136
    v_mfma_f32_16x16x32_bf16 v[116:119], v[36:39], v[44:47], 0
    ds_read_b128 v[64:67], v14 offset:4096
    v_mfma_f32_16x16x32_bf16 v[120:123], v[24:27], v[48:51], 0
    ds_read_b64_tr_b16 v[84:85], v18 offset:24576
    v_mfma_f32_16x16x32_bf16 v[124:127], v[28:31], v[48:51], 0
    ds_read_b64_tr_b16 v[86:87], v18 offset:27136
    v_mfma_f32_16x16x32_bf16 v[128:131], v[32:35], v[48:51], 0
    ds_read_b128 v[68:71], v14 offset:6144
    v_mfma_f32_16x16x32_bf16 v[132:135], v[36:39], v[48:51], 0
    s_add_u32 m0, s44, 0
    s_nop 0
    buffer_load_dwordx4 v11, s[36:39], s47 offen lds
    v_mfma_f32_16x16x32_bf16 v[136:139], v[24:27], v[52:55], 0
    v_mfma_f32_16x16x32_bf16 v[140:143], v[28:31], v[52:55], 0
    s_add_u32 m0, s44, 1024
    s_nop 0
    buffer_load_dwordx4 v12, s[36:39], s47 offen lds
    s_add_u32 s47, s47, s48
    v_mfma_f32_16x16x32_bf16 v[144:147], v[32:35], v[52:55], 0
    v_mfma_f32_16x16x32_bf16 v[148:151], v[36:39], v[52:55], 0
    s_add_u32 m0, s45, 40960
    s_mov_b32 s46, 82176
    buffer_load_dwordx4 v10, s[32:35], s46 offen lds
    s_waitcnt lgkmcnt(0)
    v_mfma_f32_16x16x32_bf16 v[88:91], v[56:59], v[72:75], v[88:91]
    s_waitcnt vmcnt(6)
    s_barrier
    ds_read_b64_tr_b16 v[40:41], v19 offset:0
    ds_read_b64_tr_b16 v[42:43], v19 offset:2560
    v_mfma_f32_16x16x32_bf16 v[92:95], v[60:63], v[72:75], v[92:95]
    ds_read_b128 v[24:27], v13 offset:16384
    v_mfma_f32_16x16x32_bf16 v[96:99], v[64:67], v[72:75], v[96:99]
    ds_read_b64_tr_b16 v[44:45], v20 offset:0
    v_mfma_f32_16x16x32_bf16 v[100:103], v[68:71], v[72:75], v[100:103]
    ds_read_b64_tr_b16 v[46:47], v20 offset:2560
    v_mfma_f32_16x16x32_bf16 v[104:107], v[56:59], v[76:79], v[104:107]
    ds_read_b128 v[28:31], v13 offset:18432
    v_mfma_f32_16x16x32_bf16 v[108:111], v[60:63], v[76:79], v[108:111]
    ds_read_b64_tr_b16 v[48:49], v21 offset:0
    v_mfma_f32_16x16x32_bf16 v[112:115], v[64:67], v[76:79], v[112:115]
    ds_read_b64_tr_b16 v[50:51], v21 offset:2560
    v_mfma_f32_16x16x32_bf16 v[116:119], v[68:71], v[76:79], v[116:119]
    ds_read_b128 v[32:35], v13 offset:20480
    v_mfma_f32_16x16x32_bf16 v[120:123], v[56:59], v[80:83], v[120:123]
    ds_read_b64_tr_b16 v[52:53], v22 offset:0
    v_mfma_f32_16x16x32_bf16 v[124:127], v[60:63], v[80:83], v[124:127]
    ds_read_b64_tr_b16 v[54:55], v22 offset:2560
    v_mfma_f32_16x16x32_bf16 v[128:131], v[64:67], v[80:83], v[128:131]
    ds_read_b128 v[36:39], v13 offset:22528
    v_mfma_f32_16x16x32_bf16 v[132:135], v[68:71], v[80:83], v[132:135]
    s_add_u32 m0, s44, 24576
    s_nop 0
    buffer_load_dwordx4 v11, s[36:39], s47 offen lds
    v_mfma_f32_16x16x32_bf16 v[136:139], v[56:59], v[84:87], v[136:139]
    v_mfma_f32_16x16x32_bf16 v[140:143], v[60:63], v[84:87], v[140:143]
    s_add_u32 m0, s44, 25600
    s_nop 0
    buffer_load_dwordx4 v12, s[36:39], s47 offen lds
    s_add_u32 s47, s47, s48
    v_mfma_f32_16x16x32_bf16 v[144:147], v[64:67], v[84:87], v[144:147]
    v_mfma_f32_16x16x32_bf16 v[148:151], v[68:71], v[84:87], v[148:151]
    s_add_u32 m0, s45, 0
    s_mov_b32 s46, 384
    buffer_load_dwordx4 v10, s[32:35], s46 offen lds
    s_waitcnt lgkmcnt(0)
    v_mfma_f32_16x16x32_bf16 v[88:91], v[24:27], v[40:43], v[88:91]
    s_waitcnt vmcnt(6)
    s_barrier
    ds_read_b64_tr_b16 v[72:73], v19 offset:24576
    ds_read_b64_tr_b16 v[74:75], v19 offset:27136
    v_mfma_f32_16x16x32_bf16 v[92:95], v[28:31], v[40:43], v[92:95]
    ds_read_b128 v[56:59], v14 offset:16384
    v_mfma_f32_16x16x32_bf16 v[96:99], v[32:35], v[40:43], v[96:99]
    ds_read_b64_tr_b16 v[76:77], v20 offset:24576
    v_mfma_f32_16x16x32_bf16 v[100:103], v[36:39], v[40:43], v[100:103]
    ds_read_b64_tr_b16 v[78:79], v20 offset:27136
    v_mfma_f32_16x16x32_bf16 v[104:107], v[24:27], v[44:47], v[104:107]
    ds_read_b128 v[60:63], v14 offset:18432
    v_mfma_f32_16x16x32_bf16 v[108:111], v[28:31], v[44:47], v[108:111]
    ds_read_b64_tr_b16 v[80:81], v21 offset:24576
    v_mfma_f32_16x16x32_bf16 v[112:115], v[32:35], v[44:47], v[112:115]
    ds_read_b64_tr_b16 v[82:83], v21 offset:27136
    v_mfma_f32_16x16x32_bf16 v[116:119], v[36:39], v[44:47], v[116:119]
    ds_read_b128 v[64:67], v14 offset:20480
    v_mfma_f32_16x16x32_bf16 v[120:123], v[24:27], v[48:51], v[120:123]
    ds_read_b64_tr_b16 v[84:85], v22 offset:24576
    v_mfma_f32_16x16x32_bf16 v[124:127], v[28:31], v[48:51], v[124:127]
    ds_read_b64_tr_b16 v[86:87], v22 offset:27136
    v_mfma_f32_16x16x32_bf16 v[128:131], v[32:35], v[48:51], v[128:131]
    ds_read_b128 v[68:71], v14 offset:22528
    v_mfma_f32_16x16x32_bf16 v[132:135], v[36:39], v[48:51], v[132:135]
    s_add_u32 m0, s44, 49152
    s_nop 0
    buffer_load_dwordx4 v11, s[36:39], s47 offen lds
    v_mfma_f32_16x16x32_bf16 v[136:139], v[24:27], v[52:55], v[136:139]
    v_mfma_f32_16x16x32_bf16 v[140:143], v[28:31], v[52:55], v[140:143]
    s_add_u32 m0, s44, 50176
    s_nop 0
    buffer_load_dwordx4 v12, s[36:39], s47 offen lds
    s_add_u32 s47, s47, s48
    v_mfma_f32_16x16x32_bf16 v[144:147], v[32:35], v[52:55], v[144:147]
    v_mfma_f32_16x16x32_bf16 v[148:151], v[36:39], v[52:55], v[148:151]
    s_add_u32 m0, s45, 8192
    s_mov_b32 s46, 82304
    buffer_load_dwordx4 v10, s[32:35], s46 offen lds
    s_waitcnt lgkmcnt(0)
    v_mfma_f32_16x16x32_bf16 v[88:91], v[56:59], v[72:75], v[88:91]
    s_waitcnt vmcnt(6)
    s_barrier
    ds_read_b64_tr_b16 v[40:41], v15 offset:0
    ds_read_b64_tr_b16 v[42:43], v15 offset:2560
    v_mfma_f32_16x16x32_bf16 v[92:95], v[60:63], v[72:75], v[92:95]
    ds_read_b128 v[24:27], v13 offset:32768
    v_mfma_f32_16x16x32_bf16 v[96:99], v[64:67], v[72:75], v[96:99]
    ds_read_b64_tr_b16 v[44:45], v16 offset:0
    v_mfma_f32_16x16x32_bf16 v[100:103], v[68:71], v[72:75], v[100:103]
    ds_read_b64_tr_b16 v[46:47], v16 offset:2560
    v_mfma_f32_16x16x32_bf16 v[104:107], v[56:59], v[76:79], v[104:107]
    ds_read_b128 v[28:31], v13 offset:34816
    v_mfma_f32_16x16x32_bf16 v[108:111], v[60:63], v[76:79], v[108:111]
    ds_read_b64_tr_b16 v[48:49], v17 offset:0
    v_mfma_f32_16x16x32_bf16 v[112:115], v[64:67], v[76:79], v[112:115]
    ds_read_b64_tr_b16 v[50:51], v17 offset:2560
    v_mfma_f32_16x16x32_bf16 v[116:119], v[68:71], v[76:79], v[116:119]
    ds_read_b128 v[32:35], v13 offset:36864
    v_mfma_f32_16x16x32_bf16 v[120:123], v[56:59], v[80:83], v[120:123]
    ds_read_b64_tr_b16 v[52:53], v18 offset:0
    v_mfma_f32_16x16x32_bf16 v[124:127], v[60:63], v[80:83], v[124:127]
    ds_read_b64_tr_b16 v[54:55], v18 offset:2560
    v_mfma_f32_16x16x32_bf16 v[128:131], v[64:67], v[80:83], v[128:131]
    ds_read_b128 v[36:39], v13 offset:38912
    v_mfma_f32_16x16x32_bf16 v[132:135], v[68:71], v[80:83], v[132:135]
    s_add_u32 m0, s44, 73728
    s_nop 0
    buffer_load_dwordx4 v11, s[36:39], s47 offen lds
    v_mfma_f32_16x16x32_bf16 v[136:139], v[56:59], v[84:87], v[136:139]
    v_mfma_f32_16x16x32_bf16 v[140:143], v[60:63], v[84:87], v[140:143]
    s_add_u32 m0, s44, 74752
    s_nop 0
    buffer_load_dwordx4 v12, s[36:39], s47 offen lds
    s_add_u32 s47, s47, s48
    v_mfma_f32_16x16x32_bf16 v[144:147], v[64:67], v[84:87], v[144:147]
    v_mfma_f32_16x16x32_bf16 v[148:151], v[68:71], v[84:87], v[148:151]
    s_add_u32 m0, s45, 16384
    s_mov_b32 s46, 512
    buffer_load_dwordx4 v10, s[32:35], s46 offen lds
    s_waitcnt lgkmcnt(0)
    v_mfma_f32_16x16x32_bf16 v[88:91], v[24:27], v[40:43], v[88:91]
    s_waitcnt vmcnt(6)
    s_barrier
    ds_read_b64_tr_b16 v[72:73], v15 offset:24576
    ds_read_b64_tr_b16 v[74:75], v15 offset:27136
    v_mfma_f32_16x16x32_bf16 v[92:95], v[28:31], v[40:43], v[92:95]
    ds_read_b128 v[56:59], v14 offset:32768
    v_mfma_f32_16x16x32_bf16 v[96:99], v[32:35], v[40:43], v[96:99]
    ds_read_b64_tr_b16 v[76:77], v16 offset:24576
    v_mfma_f32_16x16x32_bf16 v[100:103], v[36:39], v[40:43], v[100:103]
    ds_read_b64_tr_b16 v[78:79], v16 offset:27136
    v_mfma_f32_16x16x32_bf16 v[104:107], v[24:27], v[44:47], v[104:107]
    ds_read_b128 v[60:63], v14 offset:34816
    v_mfma_f32_16x16x32_bf16 v[108:111], v[28:31], v[44:47], v[108:111]
    ds_read_b64_tr_b16 v[80:81], v17 offset:24576
    v_mfma_f32_16x16x32_bf16 v[112:115], v[32:35], v[44:47], v[112:115]
    ds_read_b64_tr_b16 v[82:83], v17 offset:27136
    v_mfma_f32_16x16x32_bf16 v[116:119], v[36:39], v[44:47], v[116:119]
    ds_read_b128 v[64:67], v14 offset:36864
    v_mfma_f32_16x16x32_bf16 v[120:123], v[24:27], v[48:51], v[120:123]
    ds_read_b64_tr_b16 v[84:85], v18 offset:24576
    v_mfma_f32_16x16x32_bf16 v[124:127], v[28:31], v[48:51], v[124:127]
    ds_read_b64_tr_b16 v[86:87], v18 offset:27136
    v_mfma_f32_16x16x32_bf16 v[128:131], v[32:35], v[48:51], v[128:131]
    ds_read_b128 v[68:71], v14 offset:38912
    v_mfma_f32_16x16x32_bf16 v[132:135], v[36:39], v[48:51], v[132:135]
    s_add_u32 m0, s44, 0
    s_nop 0
    buffer_load_dwordx4 v11, s[36:39], s47 offen lds
    v_mfma_f32_16x16x32_bf16 v[136:139], v[24:27], v[52:55], v[136:139]
    v_mfma_f32_16x16x32_bf16 v[140:143], v[28:31], v[52:55], v[140:143]
    s_add_u32 m0, s44, 1024
    s_nop 0
    buffer_load_dwordx4 v12, s[36:39], s47 offen lds
    s_add_u32 s47, s47, s48
    v_mfma_f32_16x16x32_bf16 v[144:147], v[32:35], v[52:55], v[144:147]
    v_mfma_f32_16x16x32_bf16 v[148:151], v[36:39], v[52:55], v[148:151]
    s_add_u32 m0, s45, 24576
    s_mov_b32 s46, 82432
    buffer_load_dwordx4 v10, s[32:35], s46 offen lds
    s_waitcnt lgkmcnt(0)
    v_mfma_f32_16x16x32_bf16 v[88:91], v[56:59], v[72:75], v[88:91]
    s_waitcnt vmcnt(6)
    s_barrier
    ds_read_b64_tr_b16 v[40:41], v19 offset:0
    ds_read_b64_tr_b16 v[42:43], v19 offset:2560
    v_mfma_f32_16x16x32_bf16 v[92:95], v[60:63], v[72:75], v[92:95]
    ds_read_b128 v[24:27], v13 offset:0
    v_mfma_f32_16x16x32_bf16 v[96:99], v[64:67], v[72:75], v[96:99]
    ds_read_b64_tr_b16 v[44:45], v20 offset:0
    v_mfma_f32_16x16x32_bf16 v[100:103], v[68:71], v[72:75], v[100:103]
    ds_read_b64_tr_b16 v[46:47], v20 offset:2560
    v_mfma_f32_16x16x32_bf16 v[104:107], v[56:59], v[76:79], v[104:107]
    ds_read_b128 v[28:31], v13 offset:2048
    v_mfma_f32_16x16x32_bf16 v[108:111], v[60:63], v[76:79], v[108:111]
    ds_read_b64_tr_b16 v[48:49], v21 offset:0
    v_mfma_f32_16x16x32_bf16 v[112:115], v[64:67], v[76:79], v[112:115]
    ds_read_b64_tr_b16 v[50:51], v21 offset:2560
    v_mfma_f32_16x16x32_bf16 v[116:119], v[68:71], v[76:79], v[116:119]
    ds_read_b128 v[32:35], v13 offset:4096
    v_mfma_f32_16x16x32_bf16 v[120:123], v[56:59], v[80:83], v[120:123]
    ds_read_b64_tr_b16 v[52:53], v22 offset:0
    v_mfma_f32_16x16x32_bf16 v[124:127], v[60:63], v[80:83], v[124:127]
    ds_read_b64_tr_b16 v[54:55], v22 offset:2560
    v_mfma_f32_16x16x32_bf16 v[128:131], v[64:67], v[80:83], v[128:131]
    ds_read_b128 v[36:39], v13 offset:6144
    v_mfma_f32_16x16x32_bf16 v[132:135], v[68:71], v[80:83], v[132:135]
    s_add_u32 m0, s44, 24576
    s_nop 0
    buffer_load_dwordx4 v11, s[36:39], s47 offen lds
    v_mfma_f32_16x16x32_bf16 v[136:139], v[56:59], v[84:87], v[136:139]
    v_mfma_f32_16x16x32_bf16 v[140:143], v[60:63], v[84:87], v[140:143]
    s_add_u32 m0, s44, 25600
    s_nop 0
    buffer_load_dwordx4 v12, s[36:39], s47 offen lds
    s_add_u32 s47, s47, s48
    v_mfma_f32_16x16x32_bf16 v[144:147], v[64:67], v[84:87], v[144:147]
    v_mfma_f32_16x16x32_bf16 v[148:151], v[68:71], v[84:87], v[148:151]
    s_add_u32 m0, s45, 32768
    s_mov_b32 s46, 640
    buffer_load_dwordx4 v10, s[32:35], s46 offen lds
    s_waitcnt lgkmcnt(0)
    v_mfma_f32_16x16x32_bf16 v[88:91], v[24:27], v[40:43], v[88:91]
    s_waitcnt vmcnt(6)
    s_barrier
    ds_read_b64_tr_b16 v[72:73], v19 offset:24576
    ds_read_b64_tr_b16 v[74:75], v19 offset:27136
    v_mfma_f32_16x16x32_bf16 v[92:95], v[28:31], v[40:43], v[92:95]
    ds_read_b128 v[56:59], v14 offset:0
    v_mfma_f32_16x16x32_bf16 v[96:99], v[32:35], v[40:43], v[96:99]
    ds_read_b64_tr_b16 v[76:77], v20 offset:24576
    v_mfma_f32_16x16x32_bf16 v[100:103], v[36:39], v[40:43], v[100:103]
    ds_read_b64_tr_b16 v[78:79], v20 offset:27136
    v_mfma_f32_16x16x32_bf16 v[104:107], v[24:27], v[44:47], v[104:107]
    ds_read_b128 v[60:63], v14 offset:2048
    v_mfma_f32_16x16x32_bf16 v[108:111], v[28:31], v[44:47], v[108:111]
    ds_read_b64_tr_b16 v[80:81], v21 offset:24576
    v_mfma_f32_16x16x32_bf16 v[112:115], v[32:35], v[44:47], v[112:115]
    ds_read_b64_tr_b16 v[82:83], v21 offset:27136
    v_mfma_f32_16x16x32_bf16 v[116:119], v[36:39], v[44:47], v[116:119]
    ds_read_b128 v[64:67], v14 offset:4096
    v_mfma_f32_16x16x32_bf16 v[120:123], v[24:27], v[48:51], v[120:123]
    ds_read_b64_tr_b16 v[84:85], v22 offset:24576
    v_mfma_f32_16x16x32_bf16 v[124:127], v[28:31], v[48:51], v[124:127]
    ds_read_b64_tr_b16 v[86:87], v22 offset:27136
    v_mfma_f32_16x16x32_bf16 v[128:131], v[32:35], v[48:51], v[128:131]
    ds_read_b128 v[68:71], v14 offset:6144
    v_mfma_f32_16x16x32_bf16 v[132:135], v[36:39], v[48:51], v[132:135]
    s_add_u32 m0, s44, 49152
    s_nop 0
    buffer_load_dwordx4 v11, s[36:39], s47 offen lds
    v_mfma_f32_16x16x32_bf16 v[136:139], v[24:27], v[52:55], v[136:139]
    v_mfma_f32_16x16x32_bf16 v[140:143], v[28:31], v[52:55], v[140:143]
    s_add_u32 m0, s44, 50176
    s_nop 0
    buffer_load_dwordx4 v12, s[36:39], s47 offen lds
    s_add_u32 s47, s47, s48
    v_mfma_f32_16x16x32_bf16 v[144:147], v[32:35], v[52:55], v[144:147]
    v_mfma_f32_16x16x32_bf16 v[148:151], v[36:39], v[52:55], v[148:151]
    s_add_u32 m0, s45, 40960
    s_mov_b32 s46, 82560
    buffer_load_dwordx4 v10, s[32:35], s46 offen lds
    s_waitcnt lgkmcnt(0)
    v_mfma_f32_16x16x32_bf16 v[88:91], v[56:59], v[72:75], v[88:91]
    s_waitcnt vmcnt(6)
    s_barrier
    ds_read_b64_tr_b16 v[40:41], v15 offset:0
    ds_read_b64_tr_b16 v[42:43], v15 offset:2560
    v_mfma_f32_16x16x32_bf16 v[92:95], v[60:63], v[72:75], v[92:95]
    ds_read_b128 v[24:27], v13 offset:16384
    v_mfma_f32_16x16x32_bf16 v[96:99], v[64:67], v[72:75], v[96:99]
    ds_read_b64_tr_b16 v[44:45], v16 offset:0
    v_mfma_f32_16x16x32_bf16 v[100:103], v[68:71], v[72:75], v[100:103]
    ds_read_b64_tr_b16 v[46:47], v16 offset:2560
    v_mfma_f32_16x16x32_bf16 v[104:107], v[56:59], v[76:79], v[104:107]
    ds_read_b128 v[28:31], v13 offset:18432
    v_mfma_f32_16x16x32_bf16 v[108:111], v[60:63], v[76:79], v[108:111]
    ds_read_b64_tr_b16 v[48:49], v17 offset:0
    v_mfma_f32_16x16x32_bf16 v[112:115], v[64:67], v[76:79], v[112:115]
    ds_read_b64_tr_b16 v[50:51], v17 offset:2560
    v_mfma_f32_16x16x32_bf16 v[116:119], v[68:71], v[76:79], v[116:119]
    ds_read_b128 v[32:35], v13 offset:20480
    v_mfma_f32_16x16x32_bf16 v[120:123], v[56:59], v[80:83], v[120:123]
    ds_read_b64_tr_b16 v[52:53], v18 offset:0
    v_mfma_f32_16x16x32_bf16 v[124:127], v[60:63], v[80:83], v[124:127]
    ds_read_b64_tr_b16 v[54:55], v18 offset:2560
    v_mfma_f32_16x16x32_bf16 v[128:131], v[64:67], v[80:83], v[128:131]
    ds_read_b128 v[36:39], v13 offset:22528
    v_mfma_f32_16x16x32_bf16 v[132:135], v[68:71], v[80:83], v[132:135]
    s_add_u32 m0, s44, 73728
    s_nop 0
    buffer_load_dwordx4 v11, s[36:39], s47 offen lds
    v_mfma_f32_16x16x32_bf16 v[136:139], v[56:59], v[84:87], v[136:139]
    v_mfma_f32_16x16x32_bf16 v[140:143], v[60:63], v[84:87], v[140:143]
    s_add_u32 m0, s44, 74752
    s_nop 0
    buffer_load_dwordx4 v12, s[36:39], s47 offen lds
    s_add_u32 s47, s47, s48
    v_mfma_f32_16x16x32_bf16 v[144:147], v[64:67], v[84:87], v[144:147]
    v_mfma_f32_16x16x32_bf16 v[148:151], v[68:71], v[84:87], v[148:151]
    s_add_u32 m0, s45, 0
    s_mov_b32 s46, 768
    buffer_load_dwordx4 v10, s[32:35], s46 offen lds
    s_waitcnt lgkmcnt(0)
    v_mfma_f32_16x16x32_bf16 v[88:91], v[24:27], v[40:43], v[88:91]
    s_waitcnt vmcnt(6)
    s_barrier
    ds_read_b64_tr_b16 v[72:73], v15 offset:24576
    ds_read_b64_tr_b16 v[74:75], v15 offset:27136
    v_mfma_f32_16x16x32_bf16 v[92:95], v[28:31], v[40:43], v[92:95]
    ds_read_b128 v[56:59], v14 offset:16384
    v_mfma_f32_16x16x32_bf16 v[96:99], v[32:35], v[40:43], v[96:99]
    ds_read_b64_tr_b16 v[76:77], v16 offset:24576
    v_mfma_f32_16x16x32_bf16 v[100:103], v[36:39], v[40:43], v[100:103]
    ds_read_b64_tr_b16 v[78:79], v16 offset:27136
    v_mfma_f32_16x16x32_bf16 v[104:107], v[24:27], v[44:47], v[104:107]
    ds_read_b128 v[60:63], v14 offset:18432
    v_mfma_f32_16x16x32_bf16 v[108:111], v[28:31], v[44:47], v[108:111]
    ds_read_b64_tr_b16 v[80:81], v17 offset:24576
    v_mfma_f32_16x16x32_bf16 v[112:115], v[32:35], v[44:47], v[112:115]
    ds_read_b64_tr_b16 v[82:83], v17 offset:27136
    v_mfma_f32_16x16x32_bf16 v[116:119], v[36:39], v[44:47], v[116:119]
    ds_read_b128 v[64:67], v14 offset:20480
    v_mfma_f32_16x16x32_bf16 v[120:123], v[24:27], v[48:51], v[120:123]
    ds_read_b64_tr_b16 v[84:85], v18 offset:24576
    v_mfma_f32_16x16x32_bf16 v[124:127], v[28:31], v[48:51], v[124:127]
    ds_read_b64_tr_b16 v[86:87], v18 offset:27136
    v_mfma_f32_16x16x32_bf16 v[128:131], v[32:35], v[48:51], v[128:131]
    ds_read_b128 v[68:71], v14 offset:22528
    v_mfma_f32_16x16x32_bf16 v[132:135], v[36:39], v[48:51], v[132:135]
    s_add_u32 m0, s44, 0
    s_nop 0
    buffer_load_dwordx4 v11, s[36:39], s47 offen lds
    v_mfma_f32_16x16x32_bf16 v[136:139], v[24:27], v[52:55], v[136:139]
    v_mfma_f32_16x16x32_bf16 v[140:143], v[28:31], v[52:55], v[140:143]
    s_add_u32 m0, s44, 1024
    s_nop 0
    buffer_load_dwordx4 v12, s[36:39], s47 offen lds
    s_add_u32 s47, s47, s48
    v_mfma_f32_16x16x32_bf16 v[144:147], v[32:35], v[52:55], v[144:147]
    v_mfma_f32_16x16x32_bf16 v[148:151], v[36:39], v[52:55], v[148:151]
    s_add_u32 m0, s45, 8192
    s_mov_b32 s46, 82688
    buffer_load_dwordx4 v10, s[32:35], s46 offen lds
    s_waitcnt lgkmcnt(0)
    v_mfma_f32_16x16x32_bf16 v[88:91], v[56:59], v[72:75], v[88:91]
    s_waitcnt vmcnt(6)
    s_barrier
    ds_read_b64_tr_b16 v[40:41], v19 offset:0
    ds_read_b64_tr_b16 v[42:43], v19 offset:2560
    v_mfma_f32_16x16x32_bf16 v[92:95], v[60:63], v[72:75], v[92:95]
    ds_read_b128 v[24:27], v13 offset:32768
    v_mfma_f32_16x16x32_bf16 v[96:99], v[64:67], v[72:75], v[96:99]
    ds_read_b64_tr_b16 v[44:45], v20 offset:0
    v_mfma_f32_16x16x32_bf16 v[100:103], v[68:71], v[72:75], v[100:103]
    ds_read_b64_tr_b16 v[46:47], v20 offset:2560
    v_mfma_f32_16x16x32_bf16 v[104:107], v[56:59], v[76:79], v[104:107]
    ds_read_b128 v[28:31], v13 offset:34816
    v_mfma_f32_16x16x32_bf16 v[108:111], v[60:63], v[76:79], v[108:111]
    ds_read_b64_tr_b16 v[48:49], v21 offset:0
    v_mfma_f32_16x16x32_bf16 v[112:115], v[64:67], v[76:79], v[112:115]
    ds_read_b64_tr_b16 v[50:51], v21 offset:2560
    v_mfma_f32_16x16x32_bf16 v[116:119], v[68:71], v[76:79], v[116:119]
    ds_read_b128 v[32:35], v13 offset:36864
    v_mfma_f32_16x16x32_bf16 v[120:123], v[56:59], v[80:83], v[120:123]
    ds_read_b64_tr_b16 v[52:53], v22 offset:0
    v_mfma_f32_16x16x32_bf16 v[124:127], v[60:63], v[80:83], v[124:127]
    ds_read_b64_tr_b16 v[54:55], v22 offset:2560
    v_mfma_f32_16x16x32_bf16 v[128:131], v[64:67], v[80:83], v[128:131]
    ds_read_b128 v[36:39], v13 offset:38912
    v_mfma_f32_16x16x32_bf16 v[132:135], v[68:71], v[80:83], v[132:135]
    s_add_u32 m0, s44, 24576
    s_nop 0
    buffer_load_dwordx4 v11, s[36:39], s47 offen lds
    v_mfma_f32_16x16x32_bf16 v[136:139], v[56:59], v[84:87], v[136:139]
    v_mfma_f32_16x16x32_bf16 v[140:143], v[60:63], v[84:87], v[140:143]
    s_add_u32 m0, s44, 25600
    s_nop 0
    buffer_load_dwordx4 v12, s[36:39], s47 offen lds
    s_add_u32 s47, s47, s48
    v_mfma_f32_16x16x32_bf16 v[144:147], v[64:67], v[84:87], v[144:147]
    v_mfma_f32_16x16x32_bf16 v[148:151], v[68:71], v[84:87], v[148:151]
    s_add_u32 m0, s45, 16384
    s_mov_b32 s46, 896
    buffer_load_dwordx4 v10, s[32:35], s46 offen lds
    s_waitcnt lgkmcnt(0)
    v_mfma_f32_16x16x32_bf16 v[88:91], v[24:27], v[40:43], v[88:91]
    s_waitcnt vmcnt(6)
    s_barrier
    ds_read_b64_tr_b16 v[72:73], v19 offset:24576
    ds_read_b64_tr_b16 v[74:75], v19 offset:27136
    v_mfma_f32_16x16x32_bf16 v[92:95], v[28:31], v[40:43], v[92:95]
    ds_read_b128 v[56:59], v14 offset:32768
    v_mfma_f32_16x16x32_bf16 v[96:99], v[32:35], v[40:43], v[96:99]
    ds_read_b64_tr_b16 v[76:77], v20 offset:24576
    v_mfma_f32_16x16x32_bf16 v[100:103], v[36:39], v[40:43], v[100:103]
    ds_read_b64_tr_b16 v[78:79], v20 offset:27136
    v_mfma_f32_16x16x32_bf16 v[104:107], v[24:27], v[44:47], v[104:107]
    ds_read_b128 v[60:63], v14 offset:34816
    v_mfma_f32_16x16x32_bf16 v[108:111], v[28:31], v[44:47], v[108:111]
    ds_read_b64_tr_b16 v[80:81], v21 offset:24576
    v_mfma_f32_16x16x32_bf16 v[112:115], v[32:35], v[44:47], v[112:115]
    ds_read_b64_tr_b16 v[82:83], v21 offset:27136
    v_mfma_f32_16x16x32_bf16 v[116:119], v[36:39], v[44:47], v[116:119]
    ds_read_b128 v[64:67], v14 offset:36864
    v_mfma_f32_16x16x32_bf16 v[120:123], v[24:27], v[48:51], v[120:123]
    ds_read_b64_tr_b16 v[84:85], v22 offset:24576
    v_mfma_f32_16x16x32_bf16 v[124:127], v[28:31], v[48:51], v[124:127]
    ds_read_b64_tr_b16 v[86:87], v22 offset:27136
    v_mfma_f32_16x16x32_bf16 v[128:131], v[32:35], v[48:51], v[128:131]
    ds_read_b128 v[68:71], v14 offset:38912
    v_mfma_f32_16x16x32_bf16 v[132:135], v[36:39], v[48:51], v[132:135]
    s_add_u32 m0, s44, 49152
    s_nop 0
    buffer_load_dwordx4 v11, s[36:39], s47 offen lds
    v_mfma_f32_16x16x32_bf16 v[136:139], v[24:27], v[52:55], v[136:139]
    v_mfma_f32_16x16x32_bf16 v[140:143], v[28:31], v[52:55], v[140:143]
    s_add_u32 m0, s44, 50176
    s_nop 0
    buffer_load_dwordx4 v12, s[36:39], s47 offen lds
    s_add_u32 s47, s47, s48
    v_mfma_f32_16x16x32_bf16 v[144:147], v[32:35], v[52:55], v[144:147]
    v_mfma_f32_16x16x32_bf16 v[148:151], v[36:39], v[52:55], v[148:151]
    s_add_u32 m0, s45, 24576
    s_mov_b32 s46, 82816
    buffer_load_dwordx4 v10, s[32:35], s46 offen lds
    s_waitcnt lgkmcnt(0)
    v_mfma_f32_16x16x32_bf16 v[88:91], v[56:59], v[72:75], v[88:91]
    s_waitcnt vmcnt(6)
    s_barrier
    ds_read_b64_tr_b16 v[40:41], v15 offset:0
    ds_read_b64_tr_b16 v[42:43], v15 offset:2560
    v_mfma_f32_16x16x32_bf16 v[92:95], v[60:63], v[72:75], v[92:95]
    ds_read_b128 v[24:27], v13 offset:0
    v_mfma_f32_16x16x32_bf16 v[96:99], v[64:67], v[72:75], v[96:99]
    ds_read_b64_tr_b16 v[44:45], v16 offset:0
    v_mfma_f32_16x16x32_bf16 v[100:103], v[68:71], v[72:75], v[100:103]
    ds_read_b64_tr_b16 v[46:47], v16 offset:2560
    v_mfma_f32_16x16x32_bf16 v[104:107], v[56:59], v[76:79], v[104:107]
    ds_read_b128 v[28:31], v13 offset:2048
    v_mfma_f32_16x16x32_bf16 v[108:111], v[60:63], v[76:79], v[108:111]
    ds_read_b64_tr_b16 v[48:49], v17 offset:0
    v_mfma_f32_16x16x32_bf16 v[112:115], v[64:67], v[76:79], v[112:115]
    ds_read_b64_tr_b16 v[50:51], v17 offset:2560
    v_mfma_f32_16x16x32_bf16 v[116:119], v[68:71], v[76:79], v[116:119]
    ds_read_b128 v[32:35], v13 offset:4096
    v_mfma_f32_16x16x32_bf16 v[120:123], v[56:59], v[80:83], v[120:123]
    ds_read_b64_tr_b16 v[52:53], v18 offset:0
    v_mfma_f32_16x16x32_bf16 v[124:127], v[60:63], v[80:83], v[124:127]
    ds_read_b64_tr_b16 v[54:55], v18 offset:2560
    v_mfma_f32_16x16x32_bf16 v[128:131], v[64:67], v[80:83], v[128:131]
    ds_read_b128 v[36:39], v13 offset:6144
    v_mfma_f32_16x16x32_bf16 v[132:135], v[68:71], v[80:83], v[132:135]
    s_add_u32 m0, s44, 73728
    s_nop 0
    buffer_load_dwordx4 v11, s[36:39], s47 offen lds
    v_mfma_f32_16x16x32_bf16 v[136:139], v[56:59], v[84:87], v[136:139]
    v_mfma_f32_16x16x32_bf16 v[140:143], v[60:63], v[84:87], v[140:143]
    s_add_u32 m0, s44, 74752
    s_nop 0
    buffer_load_dwordx4 v12, s[36:39], s47 offen lds
    s_add_u32 s47, s47, s48
    v_mfma_f32_16x16x32_bf16 v[144:147], v[64:67], v[84:87], v[144:147]
    v_mfma_f32_16x16x32_bf16 v[148:151], v[68:71], v[84:87], v[148:151]
    s_add_u32 m0, s45, 32768
    s_mov_b32 s46, 1024
    buffer_load_dwordx4 v10, s[32:35], s46 offen lds
    s_waitcnt lgkmcnt(0)
    v_mfma_f32_16x16x32_bf16 v[88:91], v[24:27], v[40:43], v[88:91]
    s_waitcnt vmcnt(6)
    s_barrier
    ds_read_b64_tr_b16 v[72:73], v15 offset:24576
    ds_read_b64_tr_b16 v[74:75], v15 offset:27136
    v_mfma_f32_16x16x32_bf16 v[92:95], v[28:31], v[40:43], v[92:95]
    ds_read_b128 v[56:59], v14 offset:0
    v_mfma_f32_16x16x32_bf16 v[96:99], v[32:35], v[40:43], v[96:99]
    ds_read_b64_tr_b16 v[76:77], v16 offset:24576
    v_mfma_f32_16x16x32_bf16 v[100:103], v[36:39], v[40:43], v[100:103]
    ds_read_b64_tr_b16 v[78:79], v16 offset:27136
    v_mfma_f32_16x16x32_bf16 v[104:107], v[24:27], v[44:47], v[104:107]
    ds_read_b128 v[60:63], v14 offset:2048
    v_mfma_f32_16x16x32_bf16 v[108:111], v[28:31], v[44:47], v[108:111]
    ds_read_b64_tr_b16 v[80:81], v17 offset:24576
    v_mfma_f32_16x16x32_bf16 v[112:115], v[32:35], v[44:47], v[112:115]
    ds_read_b64_tr_b16 v[82:83], v17 offset:27136
    v_mfma_f32_16x16x32_bf16 v[116:119], v[36:39], v[44:47], v[116:119]
    ds_read_b128 v[64:67], v14 offset:4096
    v_mfma_f32_16x16x32_bf16 v[120:123], v[24:27], v[48:51], v[120:123]
    ds_read_b64_tr_b16 v[84:85], v18 offset:24576
    v_mfma_f32_16x16x32_bf16 v[124:127], v[28:31], v[48:51], v[124:127]
    ds_read_b64_tr_b16 v[86:87], v18 offset:27136
    v_mfma_f32_16x16x32_bf16 v[128:131], v[32:35], v[48:51], v[128:131]
    ds_read_b128 v[68:71], v14 offset:6144
    v_mfma_f32_16x16x32_bf16 v[132:135], v[36:39], v[48:51], v[132:135]
    s_add_u32 m0, s44, 0
    s_nop 0
    buffer_load_dwordx4 v11, s[36:39], s47 offen lds
    v_mfma_f32_16x16x32_bf16 v[136:139], v[24:27], v[52:55], v[136:139]
    v_mfma_f32_16x16x32_bf16 v[140:143], v[28:31], v[52:55], v[140:143]
    s_add_u32 m0, s44, 1024
    s_nop 0
    buffer_load_dwordx4 v12, s[36:39], s47 offen lds
    s_add_u32 s47, s47, s48
    v_mfma_f32_16x16x32_bf16 v[144:147], v[32:35], v[52:55], v[144:147]
    v_mfma_f32_16x16x32_bf16 v[148:151], v[36:39], v[52:55], v[148:151]
    s_add_u32 m0, s45, 40960
    s_mov_b32 s46, 82944
    buffer_load_dwordx4 v10, s[32:35], s46 offen lds
    s_waitcnt lgkmcnt(0)
    v_mfma_f32_16x16x32_bf16 v[88:91], v[56:59], v[72:75], v[88:91]
    s_waitcnt vmcnt(6)
    s_barrier
    ds_read_b64_tr_b16 v[40:41], v19 offset:0
    ds_read_b64_tr_b16 v[42:43], v19 offset:2560
    v_mfma_f32_16x16x32_bf16 v[92:95], v[60:63], v[72:75], v[92:95]
    ds_read_b128 v[24:27], v13 offset:16384
    v_mfma_f32_16x16x32_bf16 v[96:99], v[64:67], v[72:75], v[96:99]
    ds_read_b64_tr_b16 v[44:45], v20 offset:0
    v_mfma_f32_16x16x32_bf16 v[100:103], v[68:71], v[72:75], v[100:103]
    ds_read_b64_tr_b16 v[46:47], v20 offset:2560
    v_mfma_f32_16x16x32_bf16 v[104:107], v[56:59], v[76:79], v[104:107]
    ds_read_b128 v[28:31], v13 offset:18432
    v_mfma_f32_16x16x32_bf16 v[108:111], v[60:63], v[76:79], v[108:111]
    ds_read_b64_tr_b16 v[48:49], v21 offset:0
    v_mfma_f32_16x16x32_bf16 v[112:115], v[64:67], v[76:79], v[112:115]
    ds_read_b64_tr_b16 v[50:51], v21 offset:2560
    v_mfma_f32_16x16x32_bf16 v[116:119], v[68:71], v[76:79], v[116:119]
    ds_read_b128 v[32:35], v13 offset:20480
    v_mfma_f32_16x16x32_bf16 v[120:123], v[56:59], v[80:83], v[120:123]
    ds_read_b64_tr_b16 v[52:53], v22 offset:0
    v_mfma_f32_16x16x32_bf16 v[124:127], v[60:63], v[80:83], v[124:127]
    ds_read_b64_tr_b16 v[54:55], v22 offset:2560
    v_mfma_f32_16x16x32_bf16 v[128:131], v[64:67], v[80:83], v[128:131]
    ds_read_b128 v[36:39], v13 offset:22528
    v_mfma_f32_16x16x32_bf16 v[132:135], v[68:71], v[80:83], v[132:135]
    s_add_u32 m0, s44, 24576
    s_nop 0
    buffer_load_dwordx4 v11, s[36:39], s47 offen lds
    v_mfma_f32_16x16x32_bf16 v[136:139], v[56:59], v[84:87], v[136:139]
    v_mfma_f32_16x16x32_bf16 v[140:143], v[60:63], v[84:87], v[140:143]
    s_add_u32 m0, s44, 25600
    s_nop 0
    buffer_load_dwordx4 v12, s[36:39], s47 offen lds
    s_add_u32 s47, s47, s48
    v_mfma_f32_16x16x32_bf16 v[144:147], v[64:67], v[84:87], v[144:147]
    v_mfma_f32_16x16x32_bf16 v[148:151], v[68:71], v[84:87], v[148:151]
    s_add_u32 m0, s45, 0
    s_mov_b32 s46, 1152
    buffer_load_dwordx4 v10, s[32:35], s46 offen lds
    s_waitcnt lgkmcnt(0)
    v_mfma_f32_16x16x32_bf16 v[88:91], v[24:27], v[40:43], v[88:91]
    s_waitcnt vmcnt(6)
    s_barrier
    ds_read_b64_tr_b16 v[72:73], v19 offset:24576
    ds_read_b64_tr_b16 v[74:75], v19 offset:27136
    v_mfma_f32_16x16x32_bf16 v[92:95], v[28:31], v[40:43], v[92:95]
    ds_read_b128 v[56:59], v14 offset:16384
    v_mfma_f32_16x16x32_bf16 v[96:99], v[32:35], v[40:43], v[96:99]
    ds_read_b64_tr_b16 v[76:77], v20 offset:24576
    v_mfma_f32_16x16x32_bf16 v[100:103], v[36:39], v[40:43], v[100:103]
    ds_read_b64_tr_b16 v[78:79], v20 offset:27136
    v_mfma_f32_16x16x32_bf16 v[104:107], v[24:27], v[44:47], v[104:107]
    ds_read_b128 v[60:63], v14 offset:18432
    v_mfma_f32_16x16x32_bf16 v[108:111], v[28:31], v[44:47], v[108:111]
    ds_read_b64_tr_b16 v[80:81], v21 offset:24576
    v_mfma_f32_16x16x32_bf16 v[112:115], v[32:35], v[44:47], v[112:115]
    ds_read_b64_tr_b16 v[82:83], v21 offset:27136
    v_mfma_f32_16x16x32_bf16 v[116:119], v[36:39], v[44:47], v[116:119]
    ds_read_b128 v[64:67], v14 offset:20480
    v_mfma_f32_16x16x32_bf16 v[120:123], v[24:27], v[48:51], v[120:123]
    ds_read_b64_tr_b16 v[84:85], v22 offset:24576
    v_mfma_f32_16x16x32_bf16 v[124:127], v[28:31], v[48:51], v[124:127]
    ds_read_b64_tr_b16 v[86:87], v22 offset:27136
    v_mfma_f32_16x16x32_bf16 v[128:131], v[32:35], v[48:51], v[128:131]
    ds_read_b128 v[68:71], v14 offset:22528
    v_mfma_f32_16x16x32_bf16 v[132:135], v[36:39], v[48:51], v[132:135]
    s_add_u32 m0, s44, 49152
    s_nop 0
    buffer_load_dwordx4 v11, s[36:39], s47 offen lds
    v_mfma_f32_16x16x32_bf16 v[136:139], v[24:27], v[52:55], v[136:139]
    v_mfma_f32_16x16x32_bf16 v[140:143], v[28:31], v[52:55], v[140:143]
    s_add_u32 m0, s44, 50176
    s_nop 0
    buffer_load_dwordx4 v12, s[36:39], s47 offen lds
    s_add_u32 s47, s47, s48
    v_mfma_f32_16x16x32_bf16 v[144:147], v[32:35], v[52:55], v[144:147]
    v_mfma_f32_16x16x32_bf16 v[148:151], v[36:39], v[52:55], v[148:151]
    s_add_u32 m0, s45, 8192
    s_mov_b32 s46, 83072
    buffer_load_dwordx4 v10, s[32:35], s46 offen lds
    s_waitcnt lgkmcnt(0)
    v_mfma_f32_16x16x32_bf16 v[88:91], v[56:59], v[72:75], v[88:91]
    s_waitcnt vmcnt(6)
    s_barrier
    ds_read_b64_tr_b16 v[40:41], v15 offset:0
    ds_read_b64_tr_b16 v[42:43], v15 offset:2560
    v_mfma_f32_16x16x32_bf16 v[92:95], v[60:63], v[72:75], v[92:95]
    ds_read_b128 v[24:27], v13 offset:32768
    v_mfma_f32_16x16x32_bf16 v[96:99], v[64:67], v[72:75], v[96:99]
    ds_read_b64_tr_b16 v[44:45], v16 offset:0
    v_mfma_f32_16x16x32_bf16 v[100:103], v[68:71], v[72:75], v[100:103]
    ds_read_b64_tr_b16 v[46:47], v16 offset:2560
    v_mfma_f32_16x16x32_bf16 v[104:107], v[56:59], v[76:79], v[104:107]
    ds_read_b128 v[28:31], v13 offset:34816
    v_mfma_f32_16x16x32_bf16 v[108:111], v[60:63], v[76:79], v[108:111]
    ds_read_b64_tr_b16 v[48:49], v17 offset:0
    v_mfma_f32_16x16x32_bf16 v[112:115], v[64:67], v[76:79], v[112:115]
    ds_read_b64_tr_b16 v[50:51], v17 offset:2560
    v_mfma_f32_16x16x32_bf16 v[116:119], v[68:71], v[76:79], v[116:119]
    ds_read_b128 v[32:35], v13 offset:36864
    v_mfma_f32_16x16x32_bf16 v[120:123], v[56:59], v[80:83], v[120:123]
    ds_read_b64_tr_b16 v[52:53], v18 offset:0
    v_mfma_f32_16x16x32_bf16 v[124:127], v[60:63], v[80:83], v[124:127]
    ds_read_b64_tr_b16 v[54:55], v18 offset:2560
    v_mfma_f32_16x16x32_bf16 v[128:131], v[64:67], v[80:83], v[128:131]
    ds_read_b128 v[36:39], v13 offset:38912
    v_mfma_f32_16x16x32_bf16 v[132:135], v[68:71], v[80:83], v[132:135]
    s_add_u32 m0, s44, 73728
    s_nop 0
    buffer_load_dwordx4 v11, s[36:39], s47 offen lds
    v_mfma_f32_16x16x32_bf16 v[136:139], v[56:59], v[84:87], v[136:139]
    v_mfma_f32_16x16x32_bf16 v[140:143], v[60:63], v[84:87], v[140:143]
    s_add_u32 m0, s44, 74752
    s_nop 0
    buffer_load_dwordx4 v12, s[36:39], s47 offen lds
    s_add_u32 s47, s47, s48
    v_mfma_f32_16x16x32_bf16 v[144:147], v[64:67], v[84:87], v[144:147]
    v_mfma_f32_16x16x32_bf16 v[148:151], v[68:71], v[84:87], v[148:151]
    s_waitcnt lgkmcnt(0)
    v_mfma_f32_16x16x32_bf16 v[88:91], v[24:27], v[40:43], v[88:91]
    s_waitcnt vmcnt(5)
    s_barrier
    ds_read_b64_tr_b16 v[72:73], v15 offset:24576
    ds_read_b64_tr_b16 v[74:75], v15 offset:27136
    v_mfma_f32_16x16x32_bf16 v[92:95], v[28:31], v[40:43], v[92:95]
    ds_read_b128 v[56:59], v14 offset:32768
    v_mfma_f32_16x16x32_bf16 v[96:99], v[32:35], v[40:43], v[96:99]
    ds_read_b64_tr_b16 v[76:77], v16 offset:24576
    v_mfma_f32_16x16x32_bf16 v[100:103], v[36:39], v[40:43], v[100:103]
    ds_read_b64_tr_b16 v[78:79], v16 offset:27136
    v_mfma_f32_16x16x32_bf16 v[104:107], v[24:27], v[44:47], v[104:107]
    ds_read_b128 v[60:63], v14 offset:34816
    v_mfma_f32_16x16x32_bf16 v[108:111], v[28:31], v[44:47], v[108:111]
    ds_read_b64_tr_b16 v[80:81], v17 offset:24576
    v_mfma_f32_16x16x32_bf16 v[112:115], v[32:35], v[44:47], v[112:115]
    ds_read_b64_tr_b16 v[82:83], v17 offset:27136
    v_mfma_f32_16x16x32_bf16 v[116:119], v[36:39], v[44:47], v[116:119]
    ds_read_b128 v[64:67], v14 offset:36864
    v_mfma_f32_16x16x32_bf16 v[120:123], v[24:27], v[48:51], v[120:123]
    ds_read_b64_tr_b16 v[84:85], v18 offset:24576
    v_mfma_f32_16x16x32_bf16 v[124:127], v[28:31], v[48:51], v[124:127]
    ds_read_b64_tr_b16 v[86:87], v18 offset:27136
    v_mfma_f32_16x16x32_bf16 v[128:131], v[32:35], v[48:51], v[128:131]
    ds_read_b128 v[68:71], v14 offset:38912
    v_mfma_f32_16x16x32_bf16 v[132:135], v[36:39], v[48:51], v[132:135]
    v_mfma_f32_16x16x32_bf16 v[136:139], v[24:27], v[52:55], v[136:139]
    v_mfma_f32_16x16x32_bf16 v[140:143], v[28:31], v[52:55], v[140:143]
    v_mfma_f32_16x16x32_bf16 v[144:147], v[32:35], v[52:55], v[144:147]
    v_mfma_f32_16x16x32_bf16 v[148:151], v[36:39], v[52:55], v[148:151]
    s_waitcnt lgkmcnt(0)
    v_mfma_f32_16x16x32_bf16 v[88:91], v[56:59], v[72:75], v[88:91]
    s_waitcnt vmcnt(2)
    s_barrier
    ds_read_b64_tr_b16 v[40:41], v19 offset:0
    ds_read_b64_tr_b16 v[42:43], v19 offset:2560
    v_mfma_f32_16x16x32_bf16 v[92:95], v[60:63], v[72:75], v[92:95]
    ds_read_b128 v[24:27], v13 offset:0
    v_mfma_f32_16x16x32_bf16 v[96:99], v[64:67], v[72:75], v[96:99]
    ds_read_b64_tr_b16 v[44:45], v20 offset:0
    v_mfma_f32_16x16x32_bf16 v[100:103], v[68:71], v[72:75], v[100:103]
    ds_read_b64_tr_b16 v[46:47], v20 offset:2560
    v_mfma_f32_16x16x32_bf16 v[104:107], v[56:59], v[76:79], v[104:107]
    ds_read_b128 v[28:31], v13 offset:2048
    v_mfma_f32_16x16x32_bf16 v[108:111], v[60:63], v[76:79], v[108:111]
    ds_read_b64_tr_b16 v[48:49], v21 offset:0
    v_mfma_f32_16x16x32_bf16 v[112:115], v[64:67], v[76:79], v[112:115]
    ds_read_b64_tr_b16 v[50:51], v21 offset:2560
    v_mfma_f32_16x16x32_bf16 v[116:119], v[68:71], v[76:79], v[116:119]
    ds_read_b128 v[32:35], v13 offset:4096
    v_mfma_f32_16x16x32_bf16 v[120:123], v[56:59], v[80:83], v[120:123]
    ds_read_b64_tr_b16 v[52:53], v22 offset:0
    v_mfma_f32_16x16x32_bf16 v[124:127], v[60:63], v[80:83], v[124:127]
    ds_read_b64_tr_b16 v[54:55], v22 offset:2560
    v_mfma_f32_16x16x32_bf16 v[128:131], v[64:67], v[80:83], v[128:131]
    ds_read_b128 v[36:39], v13 offset:6144
    v_mfma_f32_16x16x32_bf16 v[132:135], v[68:71], v[80:83], v[132:135]
    v_mfma_f32_16x16x32_bf16 v[136:139], v[56:59], v[84:87], v[136:139]
    v_mfma_f32_16x16x32_bf16 v[140:143], v[60:63], v[84:87], v[140:143]
    v_mfma_f32_16x16x32_bf16 v[144:147], v[64:67], v[84:87], v[144:147]
    v_mfma_f32_16x16x32_bf16 v[148:151], v[68:71], v[84:87], v[148:151]
    s_waitcnt lgkmcnt(0)
    v_mfma_f32_16x16x32_bf16 v[88:91], v[24:27], v[40:43], v[88:91]
    s_waitcnt vmcnt(0)
    s_barrier
    ds_read_b64_tr_b16 v[72:73], v19 offset:24576
    ds_read_b64_tr_b16 v[74:75], v19 offset:27136
    v_mfma_f32_16x16x32_bf16 v[92:95], v[28:31], v[40:43], v[92:95]
    ds_read_b128 v[56:59], v14 offset:0
    v_mfma_f32_16x16x32_bf16 v[96:99], v[32:35], v[40:43], v[96:99]
    ds_read_b64_tr_b16 v[76:77], v20 offset:24576
    v_mfma_f32_16x16x32_bf16 v[100:103], v[36:39], v[40:43], v[100:103]
    ds_read_b64_tr_b16 v[78:79], v20 offset:27136
    v_mfma_f32_16x16x32_bf16 v[104:107], v[24:27], v[44:47], v[104:107]
    ds_read_b128 v[60:63], v14 offset:2048
    v_mfma_f32_16x16x32_bf16 v[108:111], v[28:31], v[44:47], v[108:111]
    ds_read_b64_tr_b16 v[80:81], v21 offset:24576
    v_mfma_f32_16x16x32_bf16 v[112:115], v[32:35], v[44:47], v[112:115]
    ds_read_b64_tr_b16 v[82:83], v21 offset:27136
    v_mfma_f32_16x16x32_bf16 v[116:119], v[36:39], v[44:47], v[116:119]
    ds_read_b128 v[64:67], v14 offset:4096
    v_mfma_f32_16x16x32_bf16 v[120:123], v[24:27], v[48:51], v[120:123]
    ds_read_b64_tr_b16 v[84:85], v22 offset:24576
    v_mfma_f32_16x16x32_bf16 v[124:127], v[28:31], v[48:51], v[124:127]
    ds_read_b64_tr_b16 v[86:87], v22 offset:27136
    v_mfma_f32_16x16x32_bf16 v[128:131], v[32:35], v[48:51], v[128:131]
    ds_read_b128 v[68:71], v14 offset:6144
    v_mfma_f32_16x16x32_bf16 v[132:135], v[36:39], v[48:51], v[132:135]
    v_mfma_f32_16x16x32_bf16 v[136:139], v[24:27], v[52:55], v[136:139]
    v_mfma_f32_16x16x32_bf16 v[140:143], v[28:31], v[52:55], v[140:143]
    v_mfma_f32_16x16x32_bf16 v[144:147], v[32:35], v[52:55], v[144:147]
    v_mfma_f32_16x16x32_bf16 v[148:151], v[36:39], v[52:55], v[148:151]
    s_waitcnt lgkmcnt(0)
    v_mfma_f32_16x16x32_bf16 v[88:91], v[56:59], v[72:75], v[88:91]
    v_mfma_f32_16x16x32_bf16 v[92:95], v[60:63], v[72:75], v[92:95]
    v_mfma_f32_16x16x32_bf16 v[96:99], v[64:67], v[72:75], v[96:99]
    v_mfma_f32_16x16x32_bf16 v[100:103], v[68:71], v[72:75], v[100:103]
    v_mfma_f32_16x16x32_bf16 v[104:107], v[56:59], v[76:79], v[104:107]
    v_mfma_f32_16x16x32_bf16 v[108:111], v[60:63], v[76:79], v[108:111]
    v_mfma_f32_16x16x32_bf16 v[112:115], v[64:67], v[76:79], v[112:115]
    v_mfma_f32_16x16x32_bf16 v[116:119], v[68:71], v[76:79], v[116:119]
    v_mfma_f32_16x16x32_bf16 v[120:123], v[56:59], v[80:83], v[120:123]
    v_mfma_f32_16x16x32_bf16 v[124:127], v[60:63], v[80:83], v[124:127]
    v_mfma_f32_16x16x32_bf16 v[128:131], v[64:67], v[80:83], v[128:131]
    v_mfma_f32_16x16x32_bf16 v[132:135], v[68:71], v[80:83], v[132:135]
    v_mfma_f32_16x16x32_bf16 v[136:139], v[56:59], v[84:87], v[136:139]
    v_mfma_f32_16x16x32_bf16 v[140:143], v[60:63], v[84:87], v[140:143]
    v_mfma_f32_16x16x32_bf16 v[144:147], v[64:67], v[84:87], v[144:147]
    v_mfma_f32_16x16x32_bf16 v[148:151], v[68:71], v[84:87], v[148:151]
    s_branch k1_kernel_EPI_V
k1_kernel_VAR3:
    s_waitcnt vmcnt(2)
    s_barrier
    ds_read_b64_tr_b16 v[40:41], v15 offset:0
    ds_read_b64_tr_b16 v[42:43], v15 offset:2560
    ds_read_b128 v[24:27], v13 offset:0
    ds_read_b64_tr_b16 v[44:45], v16 offset:0
    ds_read_b64_tr_b16 v[46:47], v16 offset:2560
    ds_read_b128 v[28:31], v13 offset:2048
    ds_read_b64_tr_b16 v[48:49], v17 offset:0
    ds_read_b64_tr_b16 v[50:51], v17 offset:2560
    ds_read_b64_tr_b16 v[52:53], v18 offset:0
    ds_read_b64_tr_b16 v[54:55], v18 offset:2560
    s_add_u32 m0, s44, 73728
    s_nop 0
    buffer_load_dwordx4 v11, s[36:39], s47 offen lds
    s_add_u32 s47, s47, s48
    s_waitcnt lgkmcnt(0)
    v_mfma_f32_16x16x32_bf16 v[88:91], v[24:27], v[40:43], 0
    s_waitcnt vmcnt(2)
    s_barrier
    ds_read_b64_tr_b16 v[72:73], v15 offset:24576
    ds_read_b64_tr_b16 v[74:75], v15 offset:27136
    v_mfma_f32_16x16x32_bf16 v[92:95], v[28:31], v[40:43], 0
    ds_read_b128 v[56:59], v14 offset:0
    ds_read_b64_tr_b16 v[76:77], v16 offset:24576
    v_mfma_f32_16x16x32_bf16 v[104:107], v[24:27], v[44:47], 0
    ds_read_b64_tr_b16 v[78:79], v16 offset:27136
    ds_read_b128 v[60:63], v14 offset:2048
    v_mfma_f32_16x16x32_bf16 v[108:111], v[28:31], v[44:47], 0
    ds_read_b64_tr_b16 v[80:81], v17 offset:24576
    ds_read_b64_tr_b16 v[82:83], v17 offset:27136
    v_mfma_f32_16x16x32_bf16 v[120:123], v[24:27], v[48:51], 0
    ds_read_b64_tr_b16 v[84:85], v18 offset:24576
    ds_read_b64_tr_b16 v[86:87], v18 offset:27136
    v_mfma_f32_16x16x32_bf16 v[124:127], v[28:31], v[48:51], 0
    v_mfma_f32_16x16x32_bf16 v[136:139], v[24:27], v[52:55], 0
    s_add_u32 m0, s44, 0
    s_nop 0
    buffer_load_dwordx4 v11, s[36:39], s47 offen lds
    s_add_u32 s47, s47, s48
    v_mfma_f32_16x16x32_bf16 v[140:143], v[28:31], v[52:55], 0
    s_waitcnt lgkmcnt(0)
    v_mfma_f32_16x16x32_bf16 v[88:91], v[56:59], v[72:75], v[88:91]
    s_waitcnt vmcnt(2)
    s_barrier
    ds_read_b64_tr_b16 v[40:41], v19 offset:0
    ds_read_b64_tr_b16 v[42:43], v19 offset:2560
    v_mfma_f32_16x16x32_bf16 v[92:95], v[60:63], v[72:75], v[92:95]
    ds_read_b128 v[24:27], v13 offset:16384
    ds_read_b64_tr_b16 v[44:45], v20 offset:0
    v_mfma_f32_16x16x32_bf16 v[104:107], v[56:59], v[76:79], v[104:107]
    ds_read_b64_tr_b16 v[46:47], v20 offset:2560
    ds_read_b128 v[28:31], v13 offset:18432
    v_mfma_f32_16x16x32_bf16 v[108:111], v[60:63], v[76:79], v[108:111]
    ds_read_b64_tr_b16 v[48:49], v21 offset:0
    ds_read_b64_tr_b16 v[50:51], v21 offset:2560
    v_mfma_f32_16x16x32_bf16 v[120:123], v[56:59], v[80:83], v[120:123]
    ds_read_b64_tr_b16 v[52:53], v22 offset:0
    ds_read_b64_tr_b16 v[54:55], v22 offset:2560
    v_mfma_f32_16x16x32_bf16 v[124:127], v[60:63], v[80:83], v[124:127]
    v_mfma_f32_16x16x32_bf16 v[136:139], v[56:59], v[84:87], v[136:139]
    s_add_u32 m0, s44, 24576
    s_nop 0
    buffer_load_dwordx4 v11, s[36:39], s47 offen lds
    s_add_u32 s47, s47, s48
    v_mfma_f32_16x16x32_bf16 v[140:143], v[60:63], v[84:87], v[140:143]
    s_waitcnt lgkmcnt(0)
    v_mfma_f32_16x16x32_bf16 v[88:91], v[24:27], v[40:43], v[88:91]
    s_waitcnt vmcnt(2)
    s_barrier
    ds_read_b64_tr_b16 v[72:73], v19 offset:24576
    ds_read_b64_tr_b16 v[74:75], v19 offset:27136
    v_mfma_f32_16x16x32_bf16 v[92:95], v[28:31], v[40:43], v[92:95]
    ds_read_b128 v[56:59], v14 offset:16384
    ds_read_b64_tr_b16 v[76:77], v20 offset:24576
    v_mfma_f32_16x16x32_bf16 v[104:107], v[24:27], v[44:47], v[104:107]
    ds_read_b64_tr_b16 v[78:79], v20 offset:27136
    ds_read_b128 v[60:63], v14 offset:18432
    v_mfma_f32_16x16x32_bf16 v[108:111], v[28:31], v[44:47], v[108:111]
    ds_read_b64_tr_b16 v[80:81], v21 offset:24576
    ds_read_b64_tr_b16 v[82:83], v21 offset:27136
    v_mfma_f32_16x16x32_bf16 v[120:123], v[24:27], v[48:51], v[120:123]
    ds_read_b64_tr_b16 v[84:85], v22 offset:24576
    ds_read_b64_tr_b16 v[86:87], v22 offset:27136
    v_mfma_f32_16x16x32_bf16 v[124:127], v[28:31], v[48:51], v[124:127]
    v_mfma_f32_16x16x32_bf16 v[136:139], v[24:27], v[52:55], v[136:139]
    s_add_u32 m0, s44, 49152
    s_nop 0
    buffer_load_dwordx4 v11, s[36:39], s47 offen lds
    s_add_u32 s47, s47, s48
    v_mfma_f32_16x16x32_bf16 v[140:143], v[28:31], v[52:55], v[140:143]
    s_waitcnt lgkmcnt(0)
    v_mfma_f32_16x16x32_bf16 v[88:91], v[56:59], v[72:75], v[88:91]
    s_waitcnt vmcnt(2)
    s_barrier
    ds_read_b64_tr_b16 v[40:41], v15 offset:0
    ds_read_b64_tr_b16 v[42:43], v15 offset:2560
    v_mfma_f32_16x16x32_bf16 v[92:95], v[60:63], v[72:75], v[92:95]
    ds_read_b128 v[24:27], v13 offset:32768
    ds_read_b64_tr_b16 v[44:45], v16 offset:0
    v_mfma_f32_16x16x32_bf16 v[104:107], v[56:59], v[76:79], v[104:107]
    ds_read_b64_tr_b16 v[46:47], v16 offset:2560
    ds_read_b128 v[28:31], v13 offset:34816
    v_mfma_f32_16x16x32_bf16 v[108:111], v[60:63], v[76:79], v[108:111]
    ds_read_b64_tr_b16 v[48:49], v17 offset:0
    ds_read_b64_tr_b16 v[50:51], v17 offset:2560
    v_mfma_f32_16x16x32_bf16 v[120:123], v[56:59], v[80:83], v[120:123]
    ds_read_b64_tr_b16 v[52:53], v18 offset:0
    ds_read_b64_tr_b16 v[54:55], v18 offset:2560
    v_mfma_f32_16x16x32_bf16 v[124:127], v[60:63], v[80:83], v[124:127]
    v_mfma_f32_16x16x32_bf16 v[136:139], v[56:59], v[84:87], v[136:139]
    s_add_u32 m0, s44, 73728
    s_nop 0
    buffer_load_dwordx4 v11, s[36:39], s47 offen lds
    s_add_u32 s47, s47, s48
    v_mfma_f32_16x16x32_bf16 v[140:143], v[60:63], v[84:87], v[140:143]
    s_waitcnt lgkmcnt(0)
    v_mfma_f32_16x16x32_bf16 v[88:91], v[24:27], v[40:43], v[88:91]
    s_waitcnt vmcnt(2)
    s_barrier
    ds_read_b64_tr_b16 v[72:73], v15 offset:24576
    ds_read_b64_tr_b16 v[74:75], v15 offset:27136
    v_mfma_f32_16x16x32_bf16 v[92:95], v[28:31], v[40:43], v[92:95]
    ds_read_b128 v[56:59], v14 offset:32768
    ds_read_b64_tr_b16 v[76:77], v16 offset:24576
    v_mfma_f32_16x16x32_bf16 v[104:107], v[24:27], v[44:47], v[104:107]
    ds_read_b64_tr_b16 v[78:79], v16 offset:27136
    ds_read_b128 v[60:63], v14 offset:34816
    v_mfma_f32_16x16x32_bf16 v[108:111], v[28:31], v[44:47], v[108:111]
    ds_read_b64_tr_b16 v[80:81], v17 offset:24576
    ds_read_b64_tr_b16 v[82:83], v17 offset:27136
    v_mfma_f32_16x16x32_bf16 v[120:123], v[24:27], v[48:51], v[120:123]
    ds_read_b64_tr_b16 v[84:85], v18 offset:24576
    ds_read_b64_tr_b16 v[86:87], v18 offset:27136
    v_mfma_f32_16x16x32_bf16 v[124:127], v[28:31], v[48:51], v[124:127]
    v_mfma_f32_16x16x32_bf16 v[136:139], v[24:27], v[52:55], v[136:139]
    s_add_u32 m0, s44, 0
    s_nop 0
    buffer_load_dwordx4 v11, s[36:39], s47 offen lds
    s_add_u32 s47, s47, s48
    v_mfma_f32_16x16x32_bf16 v[140:143], v[28:31], v[52:55], v[140:143]
    s_waitcnt lgkmcnt(0)
    v_mfma_f32_16x16x32_bf16 v[88:91], v[56:59], v[72:75], v[88:91]
    s_waitcnt vmcnt(2)
    s_barrier
    ds_read_b64_tr_b16 v[40:41], v19 offset:0
    ds_read_b64_tr_b16 v[42:43], v19 offset:2560
    v_mfma_f32_16x16x32_bf16 v[92:95], v[60:63], v[72:75], v[92:95]
    ds_read_b128 v[24:27], v13 offset:0
    ds_read_b64_tr_b16 v[44:45], v20 offset:0
    v_mfma_f32_16x16x32_bf16 v[104:107], v[56:59], v[76:79], v[104:107]
    ds_read_b64_tr_b16 v[46:47], v20 offset:2560
    ds_read_b128 v[28:31], v13 offset:2048
    v_mfma_f32_16x16x32_bf16 v[108:111], v[60:63], v[76:79], v[108:111]
    ds_read_b64_tr_b16 v[48:49], v21 offset:0
    ds_read_b64_tr_b16 v[50:51], v21 offset:2560
    v_mfma_f32_16x16x32_bf16 v[120:123], v[56:59], v[80:83], v[120:123]
    ds_read_b64_tr_b16 v[52:53], v22 offset:0
    ds_read_b64_tr_b16 v[54:55], v22 offset:2560
    v_mfma_f32_16x16x32_bf16 v[124:127], v[60:63], v[80:83], v[124:127]
    v_mfma_f32_16x16x32_bf16 v[136:139], v[56:59], v[84:87], v[136:139]
    s_add_u32 m0, s44, 24576
    s_nop 0
    buffer_load_dwordx4 v11, s[36:39], s47 offen lds
    s_add_u32 s47, s47, s48
    v_mfma_f32_16x16x32_bf16 v[140:143], v[60:63], v[84:87], v[140:143]
    s_waitcnt lgkmcnt(0)
    v_mfma_f32_16x16x32_bf16 v[88:91], v[24:27], v[40:43], v[88:91]
    s_waitcnt vmcnt(2)
    s_barrier
    ds_read_b64_tr_b16 v[72:73], v19 offset:24576
    ds_read_b64_tr_b16 v[74:75], v19 offset:27136
    v_mfma_f32_16x16x32_bf16 v[92:95], v[28:31], v[40:43], v[92:95]
    ds_read_b128 v[56:59], v14 offset:0
    ds_read_b64_tr_b16 v[76:77], v20 offset:24576
    v_mfma_f32_16x16x32_bf16 v[104:107], v[24:27], v[44:47], v[104:107]
    ds_read_b64_tr_b16 v[78:79], v20 offset:27136
    ds_read_b128 v[60:63], v14 offset:2048
    v_mfma_f32_16x16x32_bf16 v[108:111], v[28:31], v[44:47], v[108:111]
    ds_read_b64_tr_b16 v[80:81], v21 offset:24576
    ds_read_b64_tr_b16 v[82:83], v21 offset:27136
    v_mfma_f32_16x16x32_bf16 v[120:123], v[24:27], v[48:51], v[120:123]
    ds_read_b64_tr_b16 v[84:85], v22 offset:24576
    ds_read_b64_tr_b16 v[86:87], v22 offset:27136
    v_mfma_f32_16x16x32_bf16 v[124:127], v[28:31], v[48:51], v[124:127]
    v_mfma_f32_16x16x32_bf16 v[136:139], v[24:27], v[52:55], v[136:139]
    s_add_u32 m0, s44, 49152
    s_nop 0
    buffer_load_dwordx4 v11, s[36:39], s47 offen lds
    s_add_u32 s47, s47, s48
    v_mfma_f32_16x16x32_bf16 v[140:143], v[28:31], v[52:55], v[140:143]
    s_waitcnt lgkmcnt(0)
    v_mfma_f32_16x16x32_bf16 v[88:91], v[56:59], v[72:75], v[88:91]
    s_waitcnt vmcnt(2)
    s_barrier
    ds_read_b64_tr_b16 v[40:41], v15 offset:0
    ds_read_b64_tr_b16 v[42:43], v15 offset:2560
    v_mfma_f32_16x16x32_bf16 v[92:95], v[60:63], v[72:75], v[92:95]
    ds_read_b128 v[24:27], v13 offset:16384
    ds_read_b64_tr_b16 v[44:45], v16 offset:0
    v_mfma_f32_16x16x32_bf16 v[104:107], v[56:59], v[76:79], v[104:107]
    ds_read_b64_tr_b16 v[46:47], v16 offset:2560
    ds_read_b128 v[28:31], v13 offset:18432
    v_mfma_f32_16x16x32_bf16 v[108:111], v[60:63], v[76:79], v[108:111]
    ds_read_b64_tr_b16 v[48:49], v17 offset:0
    ds_read_b64_tr_b16 v[50:51], v17 offset:2560
    v_mfma_f32_16x16x32_bf16 v[120:123], v[56:59], v[80:83], v[120:123]
    ds_read_b64_tr_b16 v[52:53], v18 offset:0
    ds_read_b64_tr_b16 v[54:55], v18 offset:2560
    v_mfma_f32_16x16x32_bf16 v[124:127], v[60:63], v[80:83], v[124:127]
    v_mfma_f32_16x16x32_bf16 v[136:139], v[56:59], v[84:87], v[136:139]
    s_add_u32 m0, s44, 73728
    s_nop 0
    buffer_load_dwordx4 v11, s[36:39], s47 offen lds
    s_add_u32 s47, s47, s48
    v_mfma_f32_16x16x32_bf16 v[140:143], v[60:63], v[84:87], v[140:143]
    s_waitcnt lgkmcnt(0)
    v_mfma_f32_16x16x32_bf16 v[88:91], v[24:27], v[40:43], v[88:91]
    s_waitcnt vmcnt(2)
    s_barrier
    ds_read_b64_tr_b16 v[72:73], v15 offset:24576
    ds_read_b64_tr_b16 v[74:75], v15 offset:27136
    v_mfma_f32_16x16x32_bf16 v[92:95], v[28:31], v[40:43], v[92:95]
    ds_read_b128 v[56:59], v14 offset:16384
    ds_read_b64_tr_b16 v[76:77], v16 offset:24576
    v_mfma_f32_16x16x32_bf16 v[104:107], v[24:27], v[44:47], v[104:107]
    ds_read_b64_tr_b16 v[78:79], v16 offset:27136
    ds_read_b128 v[60:63], v14 offset:18432
    v_mfma_f32_16x16x32_bf16 v[108:111], v[28:31], v[44:47], v[108:111]
    ds_read_b64_tr_b16 v[80:81], v17 offset:24576
    ds_read_b64_tr_b16 v[82:83], v17 offset:27136
    v_mfma_f32_16x16x32_bf16 v[120:123], v[24:27], v[48:51], v[120:123]
    ds_read_b64_tr_b16 v[84:85], v18 offset:24576
    ds_read_b64_tr_b16 v[86:87], v18 offset:27136
    v_mfma_f32_16x16x32_bf16 v[124:127], v[28:31], v[48:51], v[124:127]
    v_mfma_f32_16x16x32_bf16 v[136:139], v[24:27], v[52:55], v[136:139]
    s_add_u32 m0, s44, 0
    s_nop 0
    buffer_load_dwordx4 v11, s[36:39], s47 offen lds
    s_add_u32 s47, s47, s48
    v_mfma_f32_16x16x32_bf16 v[140:143], v[28:31], v[52:55], v[140:143]
    s_waitcnt lgkmcnt(0)
    v_mfma_f32_16x16x32_bf16 v[88:91], v[56:59], v[72:75], v[88:91]
    s_waitcnt vmcnt(2)
    s_barrier
    ds_read_b64_tr_b16 v[40:41], v19 offset:0
    ds_read_b64_tr_b16 v[42:43], v19 offset:2560
    v_mfma_f32_16x16x32_bf16 v[92:95], v[60:63], v[72:75], v[92:95]
    ds_read_b128 v[24:27], v13 offset:32768
    ds_read_b64_tr_b16 v[44:45], v20 offset:0
    v_mfma_f32_16x16x32_bf16 v[104:107], v[56:59], v[76:79], v[104:107]
    ds_read_b64_tr_b16 v[46:47], v20 offset:2560
    ds_read_b128 v[28:31], v13 offset:34816
    v_mfma_f32_16x16x32_bf16 v[108:111], v[60:63], v[76:79], v[108:111]
    ds_read_b64_tr_b16 v[48:49], v21 offset:0
    ds_read_b64_tr_b16 v[50:51], v21 offset:2560
    v_mfma_f32_16x16x32_bf16 v[120:123], v[56:59], v[80:83], v[120:123]
    ds_read_b64_tr_b16 v[52:53], v22 offset:0
    ds_read_b64_tr_b16 v[54:55], v22 offset:2560
    v_mfma_f32_16x16x32_bf16 v[124:127], v[60:63], v[80:83], v[124:127]
    v_mfma_f32_16x16x32_bf16 v[136:139], v[56:59], v[84:87], v[136:139]
    s_add_u32 m0, s44, 24576
    s_nop 0
    buffer_load_dwordx4 v11, s[36:39], s47 offen lds
    s_add_u32 s47, s47, s48
    v_mfma_f32_16x16x32_bf16 v[140:143], v[60:63], v[84:87], v[140:143]
    s_waitcnt lgkmcnt(0)
    v_mfma_f32_16x16x32_bf16 v[88:91], v[24:27], v[40:43], v[88:91]
    s_waitcnt vmcnt(2)
    s_barrier
    ds_read_b64_tr_b16 v[72:73], v19 offset:24576
    ds_read_b64_tr_b16 v[74:75], v19 offset:27136
    v_mfma_f32_16x16x32_bf16 v[92:95], v[28:31], v[40:43], v[92:95]
    ds_read_b128 v[56:59], v14 offset:32768
    ds_read_b64_tr_b16 v[76:77], v20 offset:24576
    v_mfma_f32_16x16x32_bf16 v[104:107], v[24:27], v[44:47], v[104:107]
    ds_read_b64_tr_b16 v[78:79], v20 offset:27136
    ds_read_b128 v[60:63], v14 offset:34816
    v_mfma_f32_16x16x32_bf16 v[108:111], v[28:31], v[44:47], v[108:111]
    ds_read_b64_tr_b16 v[80:81], v21 offset:24576
    ds_read_b64_tr_b16 v[82:83], v21 offset:27136
    v_mfma_f32_16x16x32_bf16 v[120:123], v[24:27], v[48:51], v[120:123]
    ds_read_b64_tr_b16 v[84:85], v22 offset:24576
    ds_read_b64_tr_b16 v[86:87], v22 offset:27136
    v_mfma_f32_16x16x32_bf16 v[124:127], v[28:31], v[48:51], v[124:127]
    v_mfma_f32_16x16x32_bf16 v[136:139], v[24:27], v[52:55], v[136:139]
    s_add_u32 m0, s44, 49152
    s_nop 0
    buffer_load_dwordx4 v11, s[36:39], s47 offen lds
    s_add_u32 s47, s47, s48
    v_mfma_f32_16x16x32_bf16 v[140:143], v[28:31], v[52:55], v[140:143]
    s_waitcnt lgkmcnt(0)
    v_mfma_f32_16x16x32_bf16 v[88:91], v[56:59], v[72:75], v[88:91]
    s_waitcnt vmcnt(2)
    s_barrier
    ds_read_b64_tr_b16 v[40:41], v15 offset:0
    ds_read_b64_tr_b16 v[42:43], v15 offset:2560
    v_mfma_f32_16x16x32_bf16 v[92:95], v[60:63], v[72:75], v[92:95]
    ds_read_b128 v[24:27], v13 offset:0
    ds_read_b64_tr_b16 v[44:45], v16 offset:0
    v_mfma_f32_16x16x32_bf16 v[104:107], v[56:59], v[76:79], v[104:107]
    ds_read_b64_tr_b16 v[46:47], v16 offset:2560
    ds_read_b128 v[28:31], v13 offset:2048
    v_mfma_f32_16x16x32_bf16 v[108:111], v[60:63], v[76:79], v[108:111]
    ds_read_b64_tr_b16 v[48:49], v17 offset:0
    ds_read_b64_tr_b16 v[50:51], v17 offset:2560
    v_mfma_f32_16x16x32_bf16 v[120:123], v[56:59], v[80:83], v[120:123]
    ds_read_b64_tr_b16 v[52:53], v18 offset:0
    ds_read_b64_tr_b16 v[54:55], v18 offset:2560
    v_mfma_f32_16x16x32_bf16 v[124:127], v[60:63], v[80:83], v[124:127]
    v_mfma_f32_16x16x32_bf16 v[136:139], v[56:59], v[84:87], v[136:139]
    s_add_u32 m0, s44, 73728
    s_nop 0
    buffer_load_dwordx4 v11, s[36:39], s47 offen lds
    s_add_u32 s47, s47, s48
    v_mfma_f32_16x16x32_bf16 v[140:143], v[60:63], v[84:87], v[140:143]
    s_waitcnt lgkmcnt(0)
    v_mfma_f32_16x16x32_bf16 v[88:91], v[24:27], v[40:43], v[88:91]
    s_waitcnt vmcnt(2)
    s_barrier
    ds_read_b64_tr_b16 v[72:73], v15 offset:24576
    ds_read_b64_tr_b16 v[74:75], v15 offset:27136
    v_mfma_f32_16x16x32_bf16 v[92:95], v[28:31], v[40:43], v[92:95]
    ds_read_b128 v[56:59], v14 offset:0
    ds_read_b64_tr_b16 v[76:77], v16 offset:24576
    v_mfma_f32_16x16x32_bf16 v[104:107], v[24:27], v[44:47], v[104:107]
    ds_read_b64_tr_b16 v[78:79], v16 offset:27136
    ds_read_b128 v[60:63], v14 offset:2048
    v_mfma_f32_16x16x32_bf16 v[108:111], v[28:31], v[44:47], v[108:111]
    ds_read_b64_tr_b16 v[80:81], v17 offset:24576
    ds_read_b64_tr_b16 v[82:83], v17 offset:27136
    v_mfma_f32_16x16x32_bf16 v[120:123], v[24:27], v[48:51], v[120:123]
    ds_read_b64_tr_b16 v[84:85], v18 offset:24576
    ds_read_b64_tr_b16 v[86:87], v18 offset:27136
    v_mfma_f32_16x16x32_bf16 v[124:127], v[28:31], v[48:51], v[124:127]
    v_mfma_f32_16x16x32_bf16 v[136:139], v[24:27], v[52:55], v[136:139]
    s_add_u32 m0, s44, 0
    s_nop 0
    buffer_load_dwordx4 v11, s[36:39], s47 offen lds
    s_add_u32 s47, s47, s48
    v_mfma_f32_16x16x32_bf16 v[140:143], v[28:31], v[52:55], v[140:143]
    s_waitcnt lgkmcnt(0)
    v_mfma_f32_16x16x32_bf16 v[88:91], v[56:59], v[72:75], v[88:91]
    s_waitcnt vmcnt(2)
    s_barrier
    ds_read_b64_tr_b16 v[40:41], v19 offset:0
    ds_read_b64_tr_b16 v[42:43], v19 offset:2560
    v_mfma_f32_16x16x32_bf16 v[92:95], v[60:63], v[72:75], v[92:95]
    ds_read_b128 v[24:27], v13 offset:16384
    ds_read_b64_tr_b16 v[44:45], v20 offset:0
    v_mfma_f32_16x16x32_bf16 v[104:107], v[56:59], v[76:79], v[104:107]
    ds_read_b64_tr_b16 v[46:47], v20 offset:2560
    ds_read_b128 v[28:31], v13 offset:18432
    v_mfma_f32_16x16x32_bf16 v[108:111], v[60:63], v[76:79], v[108:111]
    ds_read_b64_tr_b16 v[48:49], v21 offset:0
    ds_read_b64_tr_b16 v[50:51], v21 offset:2560
    v_mfma_f32_16x16x32_bf16 v[120:123], v[56:59], v[80:83], v[120:123]
    ds_read_b64_tr_b16 v[52:53], v22 offset:0
    ds_read_b64_tr_b16 v[54:55], v22 offset:2560
    v_mfma_f32_16x16x32_bf16 v[124:127], v[60:63], v[80:83], v[124:127]
    v_mfma_f32_16x16x32_bf16 v[136:139], v[56:59], v[84:87], v[136:139]
    s_add_u32 m0, s44, 24576
    s_nop 0
    buffer_load_dwordx4 v11, s[36:39], s47 offen lds
    s_add_u32 s47, s47, s48
    v_mfma_f32_16x16x32_bf16 v[140:143], v[60:63], v[84:87], v[140:143]
    s_waitcnt lgkmcnt(0)
    v_mfma_f32_16x16x32_bf16 v[88:91], v[24:27], v[40:43], v[88:91]
    s_waitcnt vmcnt(2)
    s_barrier
    ds_read_b64_tr_b16 v[72:73], v19 offset:24576
    ds_read_b64_tr_b16 v[74:75], v19 offset:27136
    v_mfma_f32_16x16x32_bf16 v[92:95], v[28:31], v[40:43], v[92:95]
    ds_read_b128 v[56:59], v14 offset:16384
    ds_read_b64_tr_b16 v[76:77], v20 offset:24576
    v_mfma_f32_16x16x32_bf16 v[104:107], v[24:27], v[44:47], v[104:107]
    ds_read_b64_tr_b16 v[78:79], v20 offset:27136
    ds_read_b128 v[60:63], v14 offset:18432
    v_mfma_f32_16x16x32_bf16 v[108:111], v[28:31], v[44:47], v[108:111]
    ds_read_b64_tr_b16 v[80:81], v21 offset:24576
    ds_read_b64_tr_b16 v[82:83], v21 offset:27136
    v_mfma_f32_16x16x32_bf16 v[120:123], v[24:27], v[48:51], v[120:123]
    ds_read_b64_tr_b16 v[84:85], v22 offset:24576
    ds_read_b64_tr_b16 v[86:87], v22 offset:27136
    v_mfma_f32_16x16x32_bf16 v[124:127], v[28:31], v[48:51], v[124:127]
    v_mfma_f32_16x16x32_bf16 v[136:139], v[24:27], v[52:55], v[136:139]
    s_add_u32 m0, s44, 49152
    s_nop 0
    buffer_load_dwordx4 v11, s[36:39], s47 offen lds
    s_add_u32 s47, s47, s48
    v_mfma_f32_16x16x32_bf16 v[140:143], v[28:31], v[52:55], v[140:143]
    s_waitcnt lgkmcnt(0)
    v_mfma_f32_16x16x32_bf16 v[88:91], v[56:59], v[72:75], v[88:91]
    s_waitcnt vmcnt(2)
    s_barrier
    ds_read_b64_tr_b16 v[40:41], v15 offset:0
    ds_read_b64_tr_b16 v[42:43], v15 offset:2560
    v_mfma_f32_16x16x32_bf16 v[92:95], v[60:63], v[72:75], v[92:95]
    ds_read_b128 v[24:27], v13 offset:32768
    ds_read_b64_tr_b16 v[44:45], v16 offset:0
    v_mfma_f32_16x16x32_bf16 v[104:107], v[56:59], v[76:79], v[104:107]
    ds_read_b64_tr_b16 v[46:47], v16 offset:2560
    ds_read_b128 v[28:31], v13 offset:34816
    v_mfma_f32_16x16x32_bf16 v[108:111], v[60:63], v[76:79], v[108:111]
    ds_read_b64_tr_b16 v[48:49], v17 offset:0
    ds_read_b64_tr_b16 v[50:51], v17 offset:2560
    v_mfma_f32_16x16x32_bf16 v[120:123], v[56:59], v[80:83], v[120:123]
    ds_read_b64_tr_b16 v[52:53], v18 offset:0
    ds_read_b64_tr_b16 v[54:55], v18 offset:2560
    v_mfma_f32_16x16x32_bf16 v[124:127], v[60:63], v[80:83], v[124:127]
    v_mfma_f32_16x16x32_bf16 v[136:139], v[56:59], v[84:87], v[136:139]
    s_add_u32 m0, s44, 73728
    s_nop 0
    buffer_load_dwordx4 v11, s[36:39], s47 offen lds
    s_add_u32 s47, s47, s48
    v_mfma_f32_16x16x32_bf16 v[140:143], v[60:63], v[84:87], v[140:143]
    s_waitcnt lgkmcnt(0)
    v_mfma_f32_16x16x32_bf16 v[88:91], v[24:27], v[40:43], v[88:91]
    s_waitcnt vmcnt(2)
    s_barrier
    ds_read_b64_tr_b16 v[72:73], v15 offset:24576
    ds_read_b64_tr_b16 v[74:75], v15 offset:27136
    v_mfma_f32_16x16x32_bf16 v[92:95], v[28:31], v[40:43], v[92:95]
    ds_read_b128 v[56:59], v14 offset:32768
    ds_read_b64_tr_b16 v[76:77], v16 offset:24576
    v_mfma_f32_16x16x32_bf16 v[104:107], v[24:27], v[44:47], v[104:107]
    ds_read_b64_tr_b16 v[78:79], v16 offset:27136
    ds_read_b128 v[60:63], v14 offset:34816
    v_mfma_f32_16x16x32_bf16 v[108:111], v[28:31], v[44:47], v[108:111]
    ds_read_b64_tr_b16 v[80:81], v17 offset:24576
    ds_read_b64_tr_b16 v[82:83], v17 offset:27136
    v_mfma_f32_16x16x32_bf16 v[120:123], v[24:27], v[48:51], v[120:123]
    ds_read_b64_tr_b16 v[84:85], v18 offset:24576
    ds_read_b64_tr_b16 v[86:87], v18 offset:27136
    v_mfma_f32_16x16x32_bf16 v[124:127], v[28:31], v[48:51], v[124:127]
    v_mfma_f32_16x16x32_bf16 v[136:139], v[24:27], v[52:55], v[136:139]
    v_mfma_f32_16x16x32_bf16 v[140:143], v[28:31], v[52:55], v[140:143]
    s_waitcnt lgkmcnt(0)
    v_mfma_f32_16x16x32_bf16 v[88:91], v[56:59], v[72:75], v[88:91]
    s_waitcnt vmcnt(1)
    s_barrier
    ds_read_b64_tr_b16 v[40:41], v19 offset:0
    ds_read_b64_tr_b16 v[42:43], v19 offset:2560
    v_mfma_f32_16x16x32_bf16 v[92:95], v[60:63], v[72:75], v[92:95]
    ds_read_b128 v[24:27], v13 offset:0
    ds_read_b64_tr_b16 v[44:45], v20 offset:0
    v_mfma_f32_16x16x32_bf16 v[104:107], v[56:59], v[76:79], v[104:107]
    ds_read_b64_tr_b16 v[46:47], v20 offset:2560
    ds_read_b128 v[28:31], v13 offset:2048
    v_mfma_f32_16x16x32_bf16 v[108:111], v[60:63], v[76:79], v[108:111]
    ds_read_b64_tr_b16 v[48:49], v21 offset:0
    ds_read_b64_tr_b16 v[50:51], v21 offset:2560
    v_mfma_f32_16x16x32_bf16 v[120:123], v[56:59], v[80:83], v[120:123]
    ds_read_b64_tr_b16 v[52:53], v22 offset:0
    ds_read_b64_tr_b16 v[54:55], v22 offset:2560
    v_mfma_f32_16x16x32_bf16 v[124:127], v[60:63], v[80:83], v[124:127]
    v_mfma_f32_16x16x32_bf16 v[136:139], v[56:59], v[84:87], v[136:139]
    v_mfma_f32_16x16x32_bf16 v[140:143], v[60:63], v[84:87], v[140:143]
    s_waitcnt lgkmcnt(0)
    v_mfma_f32_16x16x32_bf16 v[88:91], v[24:27], v[40:43], v[88:91]
    s_waitcnt vmcnt(0)
    s_barrier
    ds_read_b64_tr_b16 v[72:73], v19 offset:24576
    ds_read_b64_tr_b16 v[74:75], v19 offset:27136
    v_mfma_f32_16x16x32_bf16 v[92:95], v[28:31], v[40:43], v[92:95]
    ds_read_b128 v[56:59], v14 offset:0
    ds_read_b64_tr_b16 v[76:77], v20 offset:24576
    v_mfma_f32_16x16x32_bf16 v[104:107], v[24:27], v[44:47], v[104:107]
    ds_read_b64_tr_b16 v[78:79], v20 offset:27136
    ds_read_b128 v[60:63], v14 offset:2048
    v_mfma_f32_16x16x32_bf16 v[108:111], v[28:31], v[44:47], v[108:111]
    ds_read_b64_tr_b16 v[80:81], v21 offset:24576
    ds_read_b64_tr_b16 v[82:83], v21 offset:27136
    v_mfma_f32_16x16x32_bf16 v[120:123], v[24:27], v[48:51], v[120:123]
    ds_read_b64_tr_b16 v[84:85], v22 offset:24576
    ds_read_b64_tr_b16 v[86:87], v22 offset:27136
    v_mfma_f32_16x16x32_bf16 v[124:127], v[28:31], v[48:51], v[124:127]
    v_mfma_f32_16x16x32_bf16 v[136:139], v[24:27], v[52:55], v[136:139]
    v_mfma_f32_16x16x32_bf16 v[140:143], v[28:31], v[52:55], v[140:143]
    s_waitcnt lgkmcnt(0)
    v_mfma_f32_16x16x32_bf16 v[88:91], v[56:59], v[72:75], v[88:91]
    v_mfma_f32_16x16x32_bf16 v[92:95], v[60:63], v[72:75], v[92:95]
    v_mfma_f32_16x16x32_bf16 v[104:107], v[56:59], v[76:79], v[104:107]
    v_mfma_f32_16x16x32_bf16 v[108:111], v[60:63], v[76:79], v[108:111]
    v_mfma_f32_16x16x32_bf16 v[120:123], v[56:59], v[80:83], v[120:123]
    v_mfma_f32_16x16x32_bf16 v[124:127], v[60:63], v[80:83], v[124:127]
    v_mfma_f32_16x16x32_bf16 v[136:139], v[56:59], v[84:87], v[136:139]
    v_mfma_f32_16x16x32_bf16 v[140:143], v[60:63], v[84:87], v[140:143]
    s_branch k1_kernel_EPI_VH
k1_kernel_VAR4:
    s_waitcnt vmcnt(6)
    s_barrier
    ds_read_b64_tr_b16 v[40:41], v15 offset:0
    ds_read_b64_tr_b16 v[42:43], v15 offset:1536
    ds_read_b128 v[24:27], v13 offset:0
    ds_read_b64_tr_b16 v[44:45], v16 offset:0
    ds_read_b64_tr_b16 v[46:47], v16 offset:1536
    ds_read_b128 v[28:31], v13 offset:2048
    ds_read_b64_tr_b16 v[48:49], v17 offset:0
    ds_read_b64_tr_b16 v[50:51], v17 offset:1536
    ds_read_b128 v[32:35], v13 offset:4096
    ds_read_b64_tr_b16 v[52:53], v18 offset:0
    ds_read_b64_tr_b16 v[54:55], v18 offset:1536
    ds_read_b128 v[36:39], v13 offset:6144
    s_add_u32 m0, s44, 73728
    s_nop 0
    buffer_load_dwordx4 v11, s[36:39], s47 offen lds
    s_add_u32 m0, s44, 74752
    s_nop 0
    buffer_load_dwordx4 v12, s[36:39], s47 offen lds
    s_add_u32 s47, s47, s48
    s_add_u32 m0, s45, 32768
    s_mov_b32 s46, 256
    buffer_load_dwordx4 v10, s[32:35], s46 offen lds
    s_waitcnt lgkmcnt(0)
    v_mfma_f32_16x16x32_bf16 v[88:91], v[40:43], v[24:27], 0
    s_waitcnt vmcnt(6)
    s_barrier
    ds_read_b64_tr_b16 v[72:73], v15 offset:24576
    ds_read_b64_tr_b16 v[74:75], v15 offset:26112
    v_mfma_f32_16x16x32_bf16 v[92:95], v[40:43], v[28:31], 0
    ds_read_b128 v[56:59], v14 offset:0
    v_mfma_f32_16x16x32_bf16 v[96:99], v[40:43], v[32:35], 0
    ds_read_b64_tr_b16 v[76:77], v16 offset:24576
    v_mfma_f32_16x16x32_bf16 v[100:103], v[40:43], v[36:39], 0
    ds_read_b64_tr_b16 v[78:79], v16 offset:26112
    v_mfma_f32_16x16x32_bf16 v[104:107], v[44:47], v[24:27], 0
    ds_read_b128 v[60:63], v14 offset:2048
    v_mfma_f32_16x16x32_bf16 v[108:111], v[44:47], v[28:31], 0
    ds_read_b64_tr_b16 v[80:81], v17 offset:24576
    v_mfma_f32_16x16x32_bf16 v[112:115], v[44:47], v[32:35], 0
    ds_read_b64_tr_b16 v[82:83], v17 offset:26112
    v_mfma_f32_16x16x32_bf16 v[116:119], v[44:47], v[36:39], 0
    ds_read_b128 v[64:67], v14 offset:4096
    v_mfma_f32_16x16x32_bf16 v[120:123], v[48:51], v[24:27], 0
    ds_read_b64_tr_b16 v[84:85], v18 offset:24576
    v_mfma_f32_16x16x32_bf16 v[124:127], v[48:51], v[28:31], 0
    ds_read_b64_tr_b16 v[86:87], v18 offset:26112
    v_mfma_f32_16x16x32_bf16 v[128:131], v[48:51], v[32:35], 0
    ds_read_b128 v[68:71], v14 offset:6144
    v_mfma_f32_16x16x32_bf16 v[132:135], v[48:51], v[36:39], 0
    s_add_u32 m0, s44, 0
    s_nop 0
    buffer_load_dwordx4 v11, s[36:39], s47 offen lds
    v_mfma_f32_16x16x32_bf16 v[136:139], v[52:55], v[24:27], 0
    v_mfma_f32_16x16x32_bf16 v[140:143], v[52:55], v[28:31], 0
    s_add_u32 m0, s44, 1024
    s_nop 0
    buffer_load_dwordx4 v12, s[36:39], s47 offen lds
    s_add_u32 s47, s47, s48
    v_mfma_f32_16x16x32_bf16 v[144:147], v[52:55], v[32:35], 0
    v_mfma_f32_16x16x32_bf16 v[148:151], v[52:55], v[36:39], 0
    s_add_u32 m0, s45, 40960
    s_mov_b32 s46, 82176
    buffer_load_dwordx4 v10, s[32:35], s46 offen lds
    s_waitcnt lgkmcnt(0)
    v_mfma_f32_16x16x32_bf16 v[88:91], v[72:75], v[56:59], v[88:91]
    s_waitcnt vmcnt(6)
    s_barrier
    ds_read_b64_tr_b16 v[40:41], v19 offset:0
    ds_read_b64_tr_b16 v[42:43], v19 offset:1536
    v_mfma_f32_16x16x32_bf16 v[92:95], v[72:75], v[60:63], v[92:95]
    ds_read_b128 v[24:27], v13 offset:16384
    v_mfma_f32_16x16x32_bf16 v[96:99], v[72:75], v[64:67], v[96:99]
    ds_read_b64_tr_b16 v[44:45], v20 offset:0
    v_mfma_f32_16x16x32_bf16 v[100:103], v[72:75], v[68:71], v[100:103]
    ds_read_b64_tr_b16 v[46:47], v20 offset:1536
    v_mfma_f32_16x16x32_bf16 v[104:107], v[76:79], v[56:59], v[104:107]
    ds_read_b128 v[28:31], v13 offset:18432
    v_mfma_f32_16x16x32_bf16 v[108:111], v[76:79], v[60:63], v[108:111]
    ds_read_b64_tr_b16 v[48:49], v21 offset:0
    v_mfma_f32_16x16x32_bf16 v[112:115], v[76:79], v[64:67], v[112:115]
    ds_read_b64_tr_b16 v[50:51], v21 offset:1536
    v_mfma_f32_16x16x32_bf16 v[116:119], v[76:79], v[68:71], v[116:119]
    ds_read_b128 v[32:35], v13 offset:20480
    v_mfma_f32_16x16x32_bf16 v[120:123], v[80:83], v[56:59], v[120:123]
    ds_read_b64_tr_b16 v[52:53], v22 offset:0
    v_mfma_f32_16x16x32_bf16 v[124:127], v[80:83], v[60:63], v[124:127]
    ds_read_b64_tr_b16 v[54:55], v22 offset:1536
    v_mfma_f32_16x16x32_bf16 v[128:131], v[80:83], v[64:67], v[128:131]
    ds_read_b128 v[36:39], v13 offset:22528
    v_mfma_f32_16x16x32_bf16 v[132:135], v[80:83], v[68:71], v[132:135]
    s_add_u32 m0, s44, 24576
    s_nop 0
    buffer_load_dwordx4 v11, s[36:39], s47 offen lds
    v_mfma_f32_16x16x32_bf16 v[136:139], v[84:87], v[56:59], v[136:139]
    v_mfma_f32_16x16x32_bf16 v[140:143], v[84:87], v[60:63], v[140:143]
    s_add_u32 m0, s44, 25600
    s_nop 0
    buffer_load_dwordx4 v12, s[36:39], s47 offen lds
    s_add_u32 s47, s47, s48
    v_mfma_f32_16x16x32_bf16 v[144:147], v[84:87], v[64:67], v[144:147]
    v_mfma_f32_16x16x32_bf16 v[148:151], v[84:87], v[68:71], v[148:151]
    s_add_u32 m0, s45, 0
    s_mov_b32 s46, 384
    buffer_load_dwordx4 v10, s[32:35], s46 offen lds
    s_waitcnt lgkmcnt(0)
    v_mfma_f32_16x16x32_bf16 v[88:91], v[40:43], v[24:27], v[88:91]
    s_waitcnt vmcnt(6)
    s_barrier
    ds_read_b64_tr_b16 v[72:73], v19 offset:24576
    ds_read_b64_tr_b16 v[74:75], v19 offset:26112
    v_mfma_f32_16x16x32_bf16 v[92:95], v[40:43], v[28:31], v[92:95]
    ds_read_b128 v[56:59], v14 offset:16384
    v_mfma_f32_16x16x32_bf16 v[96:99], v[40:43], v[32:35], v[96:99]
    ds_read_b64_tr_b16 v[76:77], v20 offset:24576
    v_mfma_f32_16x16x32_bf16 v[100:103], v[40:43], v[36:39], v[100:103]
    ds_read_b64_tr_b16 v[78:79], v20 offset:26112
    v_mfma_f32_16x16x32_bf16 v[104:107], v[44:47], v[24:27], v[104:107]
    ds_read_b128 v[60:63], v14 offset:18432
    v_mfma_f32_16x16x32_bf16 v[108:111], v[44:47], v[28:31], v[108:111]
    ds_read_b64_tr_b16 v[80:81], v21 offset:24576
    v_mfma_f32_16x16x32_bf16 v[112:115], v[44:47], v[32:35], v[112:115]
    ds_read_b64_tr_b16 v[82:83], v21 offset:26112
    v_mfma_f32_16x16x32_bf16 v[116:119], v[44:47], v[36:39], v[116:119]
    ds_read_b128 v[64:67], v14 offset:20480
    v_mfma_f32_16x16x32_bf16 v[120:123], v[48:51], v[24:27], v[120:123]
    ds_read_b64_tr_b16 v[84:85], v22 offset:24576
    v_mfma_f32_16x16x32_bf16 v[124:127], v[48:51], v[28:31], v[124:127]
    ds_read_b64_tr_b16 v[86:87], v22 offset:26112
    v_mfma_f32_16x16x32_bf16 v[128:131], v[48:51], v[32:35], v[128:131]
    ds_read_b128 v[68:71], v14 offset:22528
    v_mfma_f32_16x16x32_bf16 v[132:135], v[48:51], v[36:39], v[132:135]
    s_add_u32 m0, s44, 49152
    s_nop 0
    buffer_load_dwordx4 v11, s[36:39], s47 offen lds
    v_mfma_f32_16x16x32_bf16 v[136:139], v[52:55], v[24:27], v[136:139]
    v_mfma_f32_16x16x32_bf16 v[140:143], v[52:55], v[28:31], v[140:143]
    s_add_u32 m0, s44, 50176
    s_nop 0
    buffer_load_dwordx4 v12, s[36:39], s47 offen lds
    s_add_u32 s47, s47, s48
    v_mfma_f32_16x16x32_bf16 v[144:147], v[52:55], v[32:35], v[144:147]
    v_mfma_f32_16x16x32_bf16 v[148:151], v[52:55], v[36:39], v[148:151]
    s_add_u32 m0, s45, 8192
    s_mov_b32 s46, 82304
    buffer_load_dwordx4 v10, s[32:35], s46 offen lds
    s_waitcnt lgkmcnt(0)
    v_mfma_f32_16x16x32_bf16 v[88:91], v[72:75], v[56:59], v[88:91]
    s_waitcnt vmcnt(6)
    s_barrier
    ds_read_b64_tr_b16 v[40:41], v15 offset:0
    ds_read_b64_tr_b16 v[42:43], v15 offset:1536
    v_mfma_f32_16x16x32_bf16 v[92:95], v[72:75], v[60:63], v[92:95]
    ds_read_b128 v[24:27], v13 offset:32768
    v_mfma_f32_16x16x32_bf16 v[96:99], v[72:75], v[64:67], v[96:99]
    ds_read_b64_tr_b16 v[44:45], v16 offset:0
    v_mfma_f32_16x16x32_bf16 v[100:103], v[72:75], v[68:71], v[100:103]
    ds_read_b64_tr_b16 v[46:47], v16 offset:1536
    v_mfma_f32_16x16x32_bf16 v[104:107], v[76:79], v[56:59], v[104:107]
    ds_read_b128 v[28:31], v13 offset:34816
    v_mfma_f32_16x16x32_bf16 v[108:111], v[76:79], v[60:63], v[108:111]
    ds_read_b64_tr_b16 v[48:49], v17 offset:0
    v_mfma_f32_16x16x32_bf16 v[112:115], v[76:79], v[64:67], v[112:115]
    ds_read_b64_tr_b16 v[50:51], v17 offset:1536
    v_mfma_f32_16x16x32_bf16 v[116:119], v[76:79], v[68:71], v[116:119]
    ds_read_b128 v[32:35], v13 offset:36864
    v_mfma_f32_16x16x32_bf16 v[120:123], v[80:83], v[56:59], v[120:123]
    ds_read_b64_tr_b16 v[52:53], v18 offset:0
    v_mfma_f32_16x16x32_bf16 v[124:127], v[80:83], v[60:63], v[124:127]
    ds_read_b64_tr_b16 v[54:55], v18 offset:1536
    v_mfma_f32_16x16x32_bf16 v[128:131], v[80:83], v[64:67], v[128:131]
    ds_read_b128 v[36:39], v13 offset:38912
    v_mfma_f32_16x16x32_bf16 v[132:135], v[80:83], v[68:71], v[132:135]
    s_add_u32 m0, s44, 73728
    s_nop 0
    buffer_load_dwordx4 v11, s[36:39], s47 offen lds
    v_mfma_f32_16x16x32_bf16 v[136:139], v[84:87], v[56:59], v[136:139]
    v_mfma_f32_16x16x32_bf16 v[140:143], v[84:87], v[60:63], v[140:143]
    s_add_u32 m0, s44, 74752
    s_nop 0
    buffer_load_dwordx4 v12, s[36:39], s47 offen lds
    s_add_u32 s47, s47, s48
    v_mfma_f32_16x16x32_bf16 v[144:147], v[84:87], v[64:67], v[144:147]
    v_mfma_f32_16x16x32_bf16 v[148:151], v[84:87], v[68:71], v[148:151]
    s_add_u32 m0, s45, 16384
    s_mov_b32 s46, 512
    buffer_load_dwordx4 v10, s[32:35], s46 offen lds
    s_waitcnt lgkmcnt(0)
    v_mfma_f32_16x16x32_bf16 v[88:91], v[40:43], v[24:27], v[88:91]
    s_waitcnt vmcnt(6)
    s_barrier
    ds_read_b64_tr_b16 v[72:73], v15 offset:24576
    ds_read_b64_tr_b16 v[74:75], v15 offset:26112
    v_mfma_f32_16x16x32_bf16 v[92:95], v[40:43], v[28:31], v[92:95]
    ds_read_b128 v[56:59], v14 offset:32768
    v_mfma_f32_16x16x32_bf16 v[96:99], v[40:43], v[32:35], v[96:99]
    ds_read_b64_tr_b16 v[76:77], v16 offset:24576
    v_mfma_f32_16x16x32_bf16 v[100:103], v[40:43], v[36:39], v[100:103]
    ds_read_b64_tr_b16 v[78:79], v16 offset:26112
    v_mfma_f32_16x16x32_bf16 v[104:107], v[44:47], v[24:27], v[104:107]
    ds_read_b128 v[60:63], v14 offset:34816
    v_mfma_f32_16x16x32_bf16 v[108:111], v[44:47], v[28:31], v[108:111]
    ds_read_b64_tr_b16 v[80:81], v17 offset:24576
    v_mfma_f32_16x16x32_bf16 v[112:115], v[44:47], v[32:35], v[112:115]
    ds_read_b64_tr_b16 v[82:83], v17 offset:26112
    v_mfma_f32_16x16x32_bf16 v[116:119], v[44:47], v[36:39], v[116:119]
    ds_read_b128 v[64:67], v14 offset:36864
    v_mfma_f32_16x16x32_bf16 v[120:123], v[48:51], v[24:27], v[120:123]
    ds_read_b64_tr_b16 v[84:85], v18 offset:24576
    v_mfma_f32_16x16x32_bf16 v[124:127], v[48:51], v[28:31], v[124:127]
    ds_read_b64_tr_b16 v[86:87], v18 offset:26112
    v_mfma_f32_16x16x32_bf16 v[128:131], v[48:51], v[32:35], v[128:131]
    ds_read_b128 v[68:71], v14 offset:38912
    v_mfma_f32_16x16x32_bf16 v[132:135], v[48:51], v[36:39], v[132:135]
    s_add_u32 m0, s44, 0
    s_nop 0
    buffer_load_dwordx4 v11, s[36:39], s47 offen lds
    v_mfma_f32_16x16x32_bf16 v[136:139], v[52:55], v[24:27], v[136:139]
    v_mfma_f32_16x16x32_bf16 v[140:143], v[52:55], v[28:31], v[140:143]
    s_add_u32 m0, s44, 1024
    s_nop 0
    buffer_load_dwordx4 v12, s[36:39], s47 offen lds
    s_add_u32 s47, s47, s48
    v_mfma_f32_16x16x32_bf16 v[144:147], v[52:55], v[32:35], v[144:147]
    v_mfma_f32_16x16x32_bf16 v[148:151], v[52:55], v[36:39], v[148:151]
    s_add_u32 m0, s45, 24576
    s_mov_b32 s46, 82432
    buffer_load_dwordx4 v10, s[32:35], s46 offen lds
    s_waitcnt lgkmcnt(0)
    v_mfma_f32_16x16x32_bf16 v[88:91], v[72:75], v[56:59], v[88:91]
    s_waitcnt vmcnt(6)
    s_barrier
    ds_read_b64_tr_b16 v[40:41], v19 offset:0
    ds_read_b64_tr_b16 v[42:43], v19 offset:1536
    v_mfma_f32_16x16x32_bf16 v[92:95], v[72:75], v[60:63], v[92:95]
    ds_read_b128 v[24:27], v13 offset:0
    v_mfma_f32_16x16x32_bf16 v[96:99], v[72:75], v[64:67], v[96:99]
    ds_read_b64_tr_b16 v[44:45], v20 offset:0
    v_mfma_f32_16x16x32_bf16 v[100:103], v[72:75], v[68:71], v[100:103]
    ds_read_b64_tr_b16 v[46:47], v20 offset:1536
    v_mfma_f32_16x16x32_bf16 v[104:107], v[76:79], v[56:59], v[104:107]
    ds_read_b128 v[28:31], v13 offset:2048
    v_mfma_f32_16x16x32_bf16 v[108:111], v[76:79], v[60:63], v[108:111]
    ds_read_b64_tr_b16 v[48:49], v21 offset:0
    v_mfma_f32_16x16x32_bf16 v[112:115], v[76:79], v[64:67], v[112:115]
    ds_read_b64_tr_b16 v[50:51], v21 offset:1536
    v_mfma_f32_16x16x32_bf16 v[116:119], v[76:79], v[68:71], v[116:119]
    ds_read_b128 v[32:35], v13 offset:4096
    v_mfma_f32_16x16x32_bf16 v[120:123], v[80:83], v[56:59], v[120:123]
    ds_read_b64_tr_b16 v[52:53], v22 offset:0
    v_mfma_f32_16x16x32_bf16 v[124:127], v[80:83], v[60:63], v[124:127]
    ds_read_b64_tr_b16 v[54:55], v22 offset:1536
    v_mfma_f32_16x16x32_bf16 v[128:131], v[80:83], v[64:67], v[128:131]
    ds_read_b128 v[36:39], v13 offset:6144
    v_mfma_f32_16x16x32_bf16 v[132:135], v[80:83], v[68:71], v[132:135]
    s_add_u32 m0, s44, 24576
    s_nop 0
    buffer_load_dwordx4 v11, s[36:39], s47 offen lds
    v_mfma_f32_16x16x32_bf16 v[136:139], v[84:87], v[56:59], v[136:139]
    v_mfma_f32_16x16x32_bf16 v[140:143], v[84:87], v[60:63], v[140:143]
    s_add_u32 m0, s44, 25600
    s_nop 0
    buffer_load_dwordx4 v12, s[36:39], s47 offen lds
    s_add_u32 s47, s47, s48
    v_mfma_f32_16x16x32_bf16 v[144:147], v[84:87], v[64:67], v[144:147]
    v_mfma_f32_16x16x32_bf16 v[148:151], v[84:87], v[68:71], v[148:151]
    s_add_u32 m0, s45, 32768
    s_mov_b32 s46, 640
    buffer_load_dwordx4 v10, s[32:35], s46 offen lds
    s_waitcnt lgkmcnt(0)
    v_mfma_f32_16x16x32_bf16 v[88:91], v[40:43], v[24:27], v[88:91]
    s_waitcnt vmcnt(6)
    s_barrier
    ds_read_b64_tr_b16 v[72:73], v19 offset:24576
    ds_read_b64_tr_b16 v[74:75], v19 offset:26112
    v_mfma_f32_16x16x32_bf16 v[92:95], v[40:43], v[28:31], v[92:95]
    ds_read_b128 v[56:59], v14 offset:0
    v_mfma_f32_16x16x32_bf16 v[96:99], v[40:43], v[32:35], v[96:99]
    ds_read_b64_tr_b16 v[76:77], v20 offset:24576
    v_mfma_f32_16x16x32_bf16 v[100:103], v[40:43], v[36:39], v[100:103]
    ds_read_b64_tr_b16 v[78:79], v20 offset:26112
    v_mfma_f32_16x16x32_bf16 v[104:107], v[44:47], v[24:27], v[104:107]
    ds_read_b128 v[60:63], v14 offset:2048
    v_mfma_f32_16x16x32_bf16 v[108:111], v[44:47], v[28:31], v[108:111]
    ds_read_b64_tr_b16 v[80:81], v21 offset:24576
    v_mfma_f32_16x16x32_bf16 v[112:115], v[44:47], v[32:35], v[112:115]
    ds_read_b64_tr_b16 v[82:83], v21 offset:26112
    v_mfma_f32_16x16x32_bf16 v[116:119], v[44:47], v[36:39], v[116:119]
    ds_read_b128 v[64:67], v14 offset:4096
    v_mfma_f32_16x16x32_bf16 v[120:123], v[48:51], v[24:27], v[120:123]
    ds_read_b64_tr_b16 v[84:85], v22 offset:24576
    v_mfma_f32_16x16x32_bf16 v[124:127], v[48:51], v[28:31], v[124:127]
    ds_read_b64_tr_b16 v[86:87], v22 offset:26112
    v_mfma_f32_16x16x32_bf16 v[128:131], v[48:51], v[32:35], v[128:131]
    ds_read_b128 v[68:71], v14 offset:6144
    v_mfma_f32_16x16x32_bf16 v[132:135], v[48:51], v[36:39], v[132:135]
    s_add_u32 m0, s44, 49152
    s_nop 0
    buffer_load_dwordx4 v11, s[36:39], s47 offen lds
    v_mfma_f32_16x16x32_bf16 v[136:139], v[52:55], v[24:27], v[136:139]
    v_mfma_f32_16x16x32_bf16 v[140:143], v[52:55], v[28:31], v[140:143]
    s_add_u32 m0, s44, 50176
    s_nop 0
    buffer_load_dwordx4 v12, s[36:39], s47 offen lds
    s_add_u32 s47, s47, s48
    v_mfma_f32_16x16x32_bf16 v[144:147], v[52:55], v[32:35], v[144:147]
    v_mfma_f32_16x16x32_bf16 v[148:151], v[52:55], v[36:39], v[148:151]
    s_add_u32 m0, s45, 40960
    s_mov_b32 s46, 82560
    buffer_load_dwordx4 v10, s[32:35], s46 offen lds
    s_waitcnt lgkmcnt(0)
    v_mfma_f32_16x16x32_bf16 v[88:91], v[72:75], v[56:59], v[88:91]
    s_waitcnt vmcnt(6)
    s_barrier
    ds_read_b64_tr_b16 v[40:41], v15 offset:0
    ds_read_b64_tr_b16 v[42:43], v15 offset:1536
    v_mfma_f32_16x16x32_bf16 v[92:95], v[72:75], v[60:63], v[92:95]
    ds_read_b128 v[24:27], v13 offset:16384
    v_mfma_f32_16x16x32_bf16 v[96:99], v[72:75], v[64:67], v[96:99]
    ds_read_b64_tr_b16 v[44:45], v16 offset:0
    v_mfma_f32_16x16x32_bf16 v[100:103], v[72:75], v[68:71], v[100:103]
    ds_read_b64_tr_b16 v[46:47], v16 offset:1536
    v_mfma_f32_16x16x32_bf16 v[104:107], v[76:79], v[56:59], v[104:107]
    ds_read_b128 v[28:31], v13 offset:18432
    v_mfma_f32_16x16x32_bf16 v[108:111], v[76:79], v[60:63], v[108:111]
    ds_read_b64_tr_b16 v[48:49], v17 offset:0
    v_mfma_f32_16x16x32_bf16 v[112:115], v[76:79], v[64:67], v[112:115]
    ds_read_b64_tr_b16 v[50:51], v17 offset:1536
    v_mfma_f32_16x16x32_bf16 v[116:119], v[76:79], v[68:71], v[116:119]
    ds_read_b128 v[32:35], v13 offset:20480
    v_mfma_f32_16x16x32_bf16 v[120:123], v[80:83], v[56:59], v[120:123]
    ds_read_b64_tr_b16 v[52:53], v18 offset:0
    v_mfma_f32_16x16x32_bf16 v[124:127], v[80:83], v[60:63], v[124:127]
    ds_read_b64_tr_b16 v[54:55], v18 offset:1536
    v_mfma_f32_16x16x32_bf16 v[128:131], v[80:83], v[64:67], v[128:131]
    ds_read_b128 v[36:39], v13 offset:22528
    v_mfma_f32_16x16x32_bf16 v[132:135], v[80:83], v[68:71], v[132:135]
    s_add_u32 m0, s44, 73728
    s_nop 0
    buffer_load_dwordx4 v11, s[36:39], s47 offen lds
    v_mfma_f32_16x16x32_bf16 v[136:139], v[84:87], v[56:59], v[136:139]
    v_mfma_f32_16x16x32_bf16 v[140:143], v[84:87], v[60:63], v[140:143]
    s_add_u32 m0, s44, 74752
    s_nop 0
    buffer_load_dwordx4 v12, s[36:39], s47 offen lds
    s_add_u32 s47, s47, s48
    v_mfma_f32_16x16x32_bf16 v[144:147], v[84:87], v[64:67], v[144:147]
    v_mfma_f32_16x16x32_bf16 v[148:151], v[84:87], v[68:71], v[148:151]
    s_add_u32 m0, s45, 0
    s_mov_b32 s46, 768
    buffer_load_dwordx4 v10, s[32:35], s46 offen lds
    s_waitcnt lgkmcnt(0)
    v_mfma_f32_16x16x32_bf16 v[88:91], v[40:43], v[24:27], v[88:91]
    s_waitcnt vmcnt(6)
    s_barrier
    ds_read_b64_tr_b16 v[72:73], v15 offset:24576
    ds_read_b64_tr_b16 v[74:75], v15 offset:26112
    v_mfma_f32_16x16x32_bf16 v[92:95], v[40:43], v[28:31], v[92:95]
    ds_read_b128 v[56:59], v14 offset:16384
    v_mfma_f32_16x16x32_bf16 v[96:99], v[40:43], v[32:35], v[96:99]
    ds_read_b64_tr_b16 v[76:77], v16 offset:24576
    v_mfma_f32_16x16x32_bf16 v[100:103], v[40:43], v[36:39], v[100:103]
    ds_read_b64_tr_b16 v[78:79], v16 offset:26112
    v_mfma_f32_16x16x32_bf16 v[104:107], v[44:47], v[24:27], v[104:107]
    ds_read_b128 v[60:63], v14 offset:18432
    v_mfma_f32_16x16x32_bf16 v[108:111], v[44:47], v[28:31], v[108:111]
    ds_read_b64_tr_b16 v[80:81], v17 offset:24576
    v_mfma_f32_16x16x32_bf16 v[112:115], v[44:47], v[32:35], v[112:115]
    ds_read_b64_tr_b16 v[82:83], v17 offset:26112
    v_mfma_f32_16x16x32_bf16 v[116:119], v[44:47], v[36:39], v[116:119]
    ds_read_b128 v[64:67], v14 offset:20480
    v_mfma_f32_16x16x32_bf16 v[120:123], v[48:51], v[24:27], v[120:123]
    ds_read_b64_tr_b16 v[84:85], v18 offset:24576
    v_mfma_f32_16x16x32_bf16 v[124:127], v[48:51], v[28:31], v[124:127]
    ds_read_b64_tr_b16 v[86:87], v18 offset:26112
    v_mfma_f32_16x16x32_bf16 v[128:131], v[48:51], v[32:35], v[128:131]
    ds_read_b128 v[68:71], v14 offset:22528
    v_mfma_f32_16x16x32_bf16 v[132:135], v[48:51], v[36:39], v[132:135]
    s_add_u32 m0, s44, 0
    s_nop 0
    buffer_load_dwordx4 v11, s[36:39], s47 offen lds
    v_mfma_f32_16x16x32_bf16 v[136:139], v[52:55], v[24:27], v[136:139]
    v_mfma_f32_16x16x32_bf16 v[140:143], v[52:55], v[28:31], v[140:143]
    s_add_u32 m0, s44, 1024
    s_nop 0
    buffer_load_dwordx4 v12, s[36:39], s47 offen lds
    s_add_u32 s47, s47, s48
    v_mfma_f32_16x16x32_bf16 v[144:147], v[52:55], v[32:35], v[144:147]
    v_mfma_f32_16x16x32_bf16 v[148:151], v[52:55], v[36:39], v[148:151]
    s_add_u32 m0, s45, 8192
    s_mov_b32 s46, 82688
    buffer_load_dwordx4 v10, s[32:35], s46 offen lds
    s_waitcnt lgkmcnt(0)
    v_mfma_f32_16x16x32_bf16 v[88:91], v[72:75], v[56:59], v[88:91]
    s_waitcnt vmcnt(6)
    s_barrier
    ds_read_b64_tr_b16 v[40:41], v19 offset:0
    ds_read_b64_tr_b16 v[42:43], v19 offset:1536
    v_mfma_f32_16x16x32_bf16 v[92:95], v[72:75], v[60:63], v[92:95]
    ds_read_b128 v[24:27], v13 offset:32768
    v_mfma_f32_16x16x32_bf16 v[96:99], v[72:75], v[64:67], v[96:99]
    ds_read_b64_tr_b16 v[44:45], v20 offset:0
    v_mfma_f32_16x16x32_bf16 v[100:103], v[72:75], v[68:71], v[100:103]
    ds_read_b64_tr_b16 v[46:47], v20 offset:1536
    v_mfma_f32_16x16x32_bf16 v[104:107], v[76:79], v[56:59], v[104:107]
    ds_read_b128 v[28:31], v13 offset:34816
    v_mfma_f32_16x16x32_bf16 v[108:111], v[76:79], v[60:63], v[108:111]
    ds_read_b64_tr_b16 v[48:49], v21 offset:0
    v_mfma_f32_16x16x32_bf16 v[112:115], v[76:79], v[64:67], v[112:115]
    ds_read_b64_tr_b16 v[50:51], v21 offset:1536
    v_mfma_f32_16x16x32_bf16 v[116:119], v[76:79], v[68:71], v[116:119]
    ds_read_b128 v[32:35], v13 offset:36864
    v_mfma_f32_16x16x32_bf16 v[120:123], v[80:83], v[56:59], v[120:123]
    ds_read_b64_tr_b16 v[52:53], v22 offset:0
    v_mfma_f32_16x16x32_bf16 v[124:127], v[80:83], v[60:63], v[124:127]
    ds_read_b64_tr_b16 v[54:55], v22 offset:1536
    v_mfma_f32_16x16x32_bf16 v[128:131], v[80:83], v[64:67], v[128:131]
    ds_read_b128 v[36:39], v13 offset:38912
    v_mfma_f32_16x16x32_bf16 v[132:135], v[80:83], v[68:71], v[132:135]
    s_add_u32 m0, s44, 24576
    s_nop 0
    buffer_load_dwordx4 v11, s[36:39], s47 offen lds
    v_mfma_f32_16x16x32_bf16 v[136:139], v[84:87], v[56:59], v[136:139]
    v_mfma_f32_16x16x32_bf16 v[140:143], v[84:87], v[60:63], v[140:143]
    s_add_u32 m0, s44, 25600
    s_nop 0
    buffer_load_dwordx4 v12, s[36:39], s47 offen lds
    s_add_u32 s47, s47, s48
    v_mfma_f32_16x16x32_bf16 v[144:147], v[84:87], v[64:67], v[144:147]
    v_mfma_f32_16x16x32_bf16 v[148:151], v[84:87], v[68:71], v[148:151]
    s_add_u32 m0, s45, 16384
    s_mov_b32 s46, 896
    buffer_load_dwordx4 v10, s[32:35], s46 offen lds
    s_waitcnt lgkmcnt(0)
    v_mfma_f32_16x16x32_bf16 v[88:91], v[40:43], v[24:27], v[88:91]
    s_waitcnt vmcnt(6)
    s_barrier
    ds_read_b64_tr_b16 v[72:73], v19 offset:24576
    ds_read_b64_tr_b16 v[74:75], v19 offset:26112
    v_mfma_f32_16x16x32_bf16 v[92:95], v[40:43], v[28:31], v[92:95]
    ds_read_b128 v[56:59], v14 offset:32768
    v_mfma_f32_16x16x32_bf16 v[96:99], v[40:43], v[32:35], v[96:99]
    ds_read_b64_tr_b16 v[76:77], v20 offset:24576
    v_mfma_f32_16x16x32_bf16 v[100:103], v[40:43], v[36:39], v[100:103]
    ds_read_b64_tr_b16 v[78:79], v20 offset:26112
    v_mfma_f32_16x16x32_bf16 v[104:107], v[44:47], v[24:27], v[104:107]
    ds_read_b128 v[60:63], v14 offset:34816
    v_mfma_f32_16x16x32_bf16 v[108:111], v[44:47], v[28:31], v[108:111]
    ds_read_b64_tr_b16 v[80:81], v21 offset:24576
    v_mfma_f32_16x16x32_bf16 v[112:115], v[44:47], v[32:35], v[112:115]
    ds_read_b64_tr_b16 v[82:83], v21 offset:26112
    v_mfma_f32_16x16x32_bf16 v[116:119], v[44:47], v[36:39], v[116:119]
    ds_read_b128 v[64:67], v14 offset:36864
    v_mfma_f32_16x16x32_bf16 v[120:123], v[48:51], v[24:27], v[120:123]
    ds_read_b64_tr_b16 v[84:85], v22 offset:24576
    v_mfma_f32_16x16x32_bf16 v[124:127], v[48:51], v[28:31], v[124:127]
    ds_read_b64_tr_b16 v[86:87], v22 offset:26112
    v_mfma_f32_16x16x32_bf16 v[128:131], v[48:51], v[32:35], v[128:131]
    ds_read_b128 v[68:71], v14 offset:38912
    v_mfma_f32_16x16x32_bf16 v[132:135], v[48:51], v[36:39], v[132:135]
    s_add_u32 m0, s44, 49152
    s_nop 0
    buffer_load_dwordx4 v11, s[36:39], s47 offen lds
    v_mfma_f32_16x16x32_bf16 v[136:139], v[52:55], v[24:27], v[136:139]
    v_mfma_f32_16x16x32_bf16 v[140:143], v[52:55], v[28:31], v[140:143]
    s_add_u32 m0, s44, 50176
    s_nop 0
    buffer_load_dwordx4 v12, s[36:39], s47 offen lds
    s_add_u32 s47, s47, s48
    v_mfma_f32_16x16x32_bf16 v[144:147], v[52:55], v[32:35], v[144:147]
    v_mfma_f32_16x16x32_bf16 v[148:151], v[52:55], v[36:39], v[148:151]
    s_add_u32 m0, s45, 24576
    s_mov_b32 s46, 82816
    buffer_load_dwordx4 v10, s[32:35], s46 offen lds
    s_waitcnt lgkmcnt(0)
    v_mfma_f32_16x16x32_bf16 v[88:91], v[72:75], v[56:59], v[88:91]
    s_waitcnt vmcnt(6)
    s_barrier
    ds_read_b64_tr_b16 v[40:41], v15 offset:0
    ds_read_b64_tr_b16 v[42:43], v15 offset:1536
    v_mfma_f32_16x16x32_bf16 v[92:95], v[72:75], v[60:63], v[92:95]
    ds_read_b128 v[24:27], v13 offset:0
    v_mfma_f32_16x16x32_bf16 v[96:99], v[72:75], v[64:67], v[96:99]
    ds_read_b64_tr_b16 v[44:45], v16 offset:0
    v_mfma_f32_16x16x32_bf16 v[100:103], v[72:75], v[68:71], v[100:103]
    ds_read_b64_tr_b16 v[46:47], v16 offset:1536
    v_mfma_f32_16x16x32_bf16 v[104:107], v[76:79], v[56:59], v[104:107]
    ds_read_b128 v[28:31], v13 offset:2048
    v_mfma_f32_16x16x32_bf16 v[108:111], v[76:79], v[60:63], v[108:111]
    ds_read_b64_tr_b16 v[48:49], v17 offset:0
    v_mfma_f32_16x16x32_bf16 v[112:115], v[76:79], v[64:67], v[112:115]
    ds_read_b64_tr_b16 v[50:51], v17 offset:1536
    v_mfma_f32_16x16x32_bf16 v[116:119], v[76:79], v[68:71], v[116:119]
    ds_read_b128 v[32:35], v13 offset:4096
    v_mfma_f32_16x16x32_bf16 v[120:123], v[80:83], v[56:59], v[120:123]
    ds_read_b64_tr_b16 v[52:53], v18 offset:0
    v_mfma_f32_16x16x32_bf16 v[124:127], v[80:83], v[60:63], v[124:127]
    ds_read_b64_tr_b16 v[54:55], v18 offset:1536
    v_mfma_f32_16x16x32_bf16 v[128:131], v[80:83], v[64:67], v[128:131]
    ds_read_b128 v[36:39], v13 offset:6144
    v_mfma_f32_16x16x32_bf16 v[132:135], v[80:83], v[68:71], v[132:135]
    s_add_u32 m0, s44, 73728
    s_nop 0
    buffer_load_dwordx4 v11, s[36:39], s47 offen lds
    v_mfma_f32_16x16x32_bf16 v[136:139], v[84:87], v[56:59], v[136:139]
    v_mfma_f32_16x16x32_bf16 v[140:143], v[84:87], v[60:63], v[140:143]
    s_add_u32 m0, s44, 74752
    s_nop 0
    buffer_load_dwordx4 v12, s[36:39], s47 offen lds
    s_add_u32 s47, s47, s48
    v_mfma_f32_16x16x32_bf16 v[144:147], v[84:87], v[64:67], v[144:147]
    v_mfma_f32_16x16x32_bf16 v[148:151], v[84:87], v[68:71], v[148:151]
    s_add_u32 m0, s45, 32768
    s_mov_b32 s46, 1024
    buffer_load_dwordx4 v10, s[32:35], s46 offen lds
    s_waitcnt lgkmcnt(0)
    v_mfma_f32_16x16x32_bf16 v[88:91], v[40:43], v[24:27], v[88:91]
    s_waitcnt vmcnt(6)
    s_barrier
    ds_read_b64_tr_b16 v[72:73], v15 offset:24576
    ds_read_b64_tr_b16 v[74:75], v15 offset:26112
    v_mfma_f32_16x16x32_bf16 v[92:95], v[40:43], v[28:31], v[92:95]
    ds_read_b128 v[56:59], v14 offset:0
    v_mfma_f32_16x16x32_bf16 v[96:99], v[40:43], v[32:35], v[96:99]
    ds_read_b64_tr_b16 v[76:77], v16 offset:24576
    v_mfma_f32_16x16x32_bf16 v[100:103], v[40:43], v[36:39], v[100:103]
    ds_read_b64_tr_b16 v[78:79], v16 offset:26112
    v_mfma_f32_16x16x32_bf16 v[104:107], v[44:47], v[24:27], v[104:107]
    ds_read_b128 v[60:63], v14 offset:2048
    v_mfma_f32_16x16x32_bf16 v[108:111], v[44:47], v[28:31], v[108:111]
    ds_read_b64_tr_b16 v[80:81], v17 offset:24576
    v_mfma_f32_16x16x32_bf16 v[112:115], v[44:47], v[32:35], v[112:115]
    ds_read_b64_tr_b16 v[82:83], v17 offset:26112
    v_mfma_f32_16x16x32_bf16 v[116:119], v[44:47], v[36:39], v[116:119]
    ds_read_b128 v[64:67], v14 offset:4096
    v_mfma_f32_16x16x32_bf16 v[120:123], v[48:51], v[24:27], v[120:123]
    ds_read_b64_tr_b16 v[84:85], v18 offset:24576
    v_mfma_f32_16x16x32_bf16 v[124:127], v[48:51], v[28:31], v[124:127]
    ds_read_b64_tr_b16 v[86:87], v18 offset:26112
    v_mfma_f32_16x16x32_bf16 v[128:131], v[48:51], v[32:35], v[128:131]
    ds_read_b128 v[68:71], v14 offset:6144
    v_mfma_f32_16x16x32_bf16 v[132:135], v[48:51], v[36:39], v[132:135]
    s_add_u32 m0, s44, 0
    s_nop 0
    buffer_load_dwordx4 v11, s[36:39], s47 offen lds
    v_mfma_f32_16x16x32_bf16 v[136:139], v[52:55], v[24:27], v[136:139]
    v_mfma_f32_16x16x32_bf16 v[140:143], v[52:55], v[28:31], v[140:143]
    s_add_u32 m0, s44, 1024
    s_nop 0
    buffer_load_dwordx4 v12, s[36:39], s47 offen lds
    s_add_u32 s47, s47, s48
    v_mfma_f32_16x16x32_bf16 v[144:147], v[52:55], v[32:35], v[144:147]
    v_mfma_f32_16x16x32_bf16 v[148:151], v[52:55], v[36:39], v[148:151]
    s_add_u32 m0, s45, 40960
    s_mov_b32 s46, 82944
    buffer_load_dwordx4 v10, s[32:35], s46 offen lds
    s_waitcnt lgkmcnt(0)
    v_mfma_f32_16x16x32_bf16 v[88:91], v[72:75], v[56:59], v[88:91]
    s_waitcnt vmcnt(6)
    s_barrier
    ds_read_b64_tr_b16 v[40:41], v19 offset:0
    ds_read_b64_tr_b16 v[42:43], v19 offset:1536
    v_mfma_f32_16x16x32_bf16 v[92:95], v[72:75], v[60:63], v[92:95]
    ds_read_b128 v[24:27], v13 offset:16384
    v_mfma_f32_16x16x32_bf16 v[96:99], v[72:75], v[64:67], v[96:99]
    ds_read_b64_tr_b16 v[44:45], v20 offset:0
    v_mfma_f32_16x16x32_bf16 v[100:103], v[72:75], v[68:71], v[100:103]
    ds_read_b64_tr_b16 v[46:47], v20 offset:1536
    v_mfma_f32_16x16x32_bf16 v[104:107], v[76:79], v[56:59], v[104:107]
    ds_read_b128 v[28:31], v13 offset:18432
    v_mfma_f32_16x16x32_bf16 v[108:111], v[76:79], v[60:63], v[108:111]
    ds_read_b64_tr_b16 v[48:49], v21 offset:0
    v_mfma_f32_16x16x32_bf16 v[112:115], v[76:79], v[64:67], v[112:115]
    ds_read_b64_tr_b16 v[50:51], v21 offset:1536
    v_mfma_f32_16x16x32_bf16 v[116:119], v[76:79], v[68:71], v[116:119]
    ds_read_b128 v[32:35], v13 offset:20480
    v_mfma_f32_16x16x32_bf16 v[120:123], v[80:83], v[56:59], v[120:123]
    ds_read_b64_tr_b16 v[52:53], v22 offset:0
    v_mfma_f32_16x16x32_bf16 v[124:127], v[80:83], v[60:63], v[124:127]
    ds_read_b64_tr_b16 v[54:55], v22 offset:1536
    v_mfma_f32_16x16x32_bf16 v[128:131], v[80:83], v[64:67], v[128:131]
    ds_read_b128 v[36:39], v13 offset:22528
    v_mfma_f32_16x16x32_bf16 v[132:135], v[80:83], v[68:71], v[132:135]
    s_add_u32 m0, s44, 24576
    s_nop 0
    buffer_load_dwordx4 v11, s[36:39], s47 offen lds
    v_mfma_f32_16x16x32_bf16 v[136:139], v[84:87], v[56:59], v[136:139]
    v_mfma_f32_16x16x32_bf16 v[140:143], v[84:87], v[60:63], v[140:143]
    s_add_u32 m0, s44, 25600
    s_nop 0
    buffer_load_dwordx4 v12, s[36:39], s47 offen lds
    s_add_u32 s47, s47, s48
    v_mfma_f32_16x16x32_bf16 v[144:147], v[84:87], v[64:67], v[144:147]
    v_mfma_f32_16x16x32_bf16 v[148:151], v[84:87], v[68:71], v[148:151]
    s_add_u32 m0, s45, 0
    s_mov_b32 s46, 1152
    buffer_load_dwordx4 v10, s[32:35], s46 offen lds
    s_waitcnt lgkmcnt(0)
    v_mfma_f32_16x16x32_bf16 v[88:91], v[40:43], v[24:27], v[88:91]
    s_waitcnt vmcnt(6)
    s_barrier
    ds_read_b64_tr_b16 v[72:73], v19 offset:24576
    ds_read_b64_tr_b16 v[74:75], v19 offset:26112
    v_mfma_f32_16x16x32_bf16 v[92:95], v[40:43], v[28:31], v[92:95]
    ds_read_b128 v[56:59], v14 offset:16384
    v_mfma_f32_16x16x32_bf16 v[96:99], v[40:43], v[32:35], v[96:99]
    ds_read_b64_tr_b16 v[76:77], v20 offset:24576
    v_mfma_f32_16x16x32_bf16 v[100:103], v[40:43], v[36:39], v[100:103]
    ds_read_b64_tr_b16 v[78:79], v20 offset:26112
    v_mfma_f32_16x16x32_bf16 v[104:107], v[44:47], v[24:27], v[104:107]
    ds_read_b128 v[60:63], v14 offset:18432
    v_mfma_f32_16x16x32_bf16 v[108:111], v[44:47], v[28:31], v[108:111]
    ds_read_b64_tr_b16 v[80:81], v21 offset:24576
    v_mfma_f32_16x16x32_bf16 v[112:115], v[44:47], v[32:35], v[112:115]
    ds_read_b64_tr_b16 v[82:83], v21 offset:26112
    v_mfma_f32_16x16x32_bf16 v[116:119], v[44:47], v[36:39], v[116:119]
    ds_read_b128 v[64:67], v14 offset:20480
    v_mfma_f32_16x16x32_bf16 v[120:123], v[48:51], v[24:27], v[120:123]
    ds_read_b64_tr_b16 v[84:85], v22 offset:24576
    v_mfma_f32_16x16x32_bf16 v[124:127], v[48:51], v[28:31], v[124:127]
    ds_read_b64_tr_b16 v[86:87], v22 offset:26112
    v_mfma_f32_16x16x32_bf16 v[128:131], v[48:51], v[32:35], v[128:131]
    ds_read_b128 v[68:71], v14 offset:22528
    v_mfma_f32_16x16x32_bf16 v[132:135], v[48:51], v[36:39], v[132:135]
    s_add_u32 m0, s44, 49152
    s_nop 0
    buffer_load_dwordx4 v11, s[36:39], s47 offen lds
    v_mfma_f32_16x16x32_bf16 v[136:139], v[52:55], v[24:27], v[136:139]
    v_mfma_f32_16x16x32_bf16 v[140:143], v[52:55], v[28:31], v[140:143]
    s_add_u32 m0, s44, 50176
    s_nop 0
    buffer_load_dwordx4 v12, s[36:39], s47 offen lds
    s_add_u32 s47, s47, s48
    v_mfma_f32_16x16x32_bf16 v[144:147], v[52:55], v[32:35], v[144:147]
    v_mfma_f32_16x16x32_bf16 v[148:151], v[52:55], v[36:39], v[148:151]
    s_add_u32 m0, s45, 8192
    s_mov_b32 s46, 83072
    buffer_load_dwordx4 v10, s[32:35], s46 offen lds
    s_waitcnt lgkmcnt(0)
    v_mfma_f32_16x16x32_bf16 v[88:91], v[72:75], v[56:59], v[88:91]
    s_waitcnt vmcnt(6)
    s_barrier
    ds_read_b64_tr_b16 v[40:41], v15 offset:0
    ds_read_b64_tr_b16 v[42:43], v15 offset:1536
    v_mfma_f32_16x16x32_bf16 v[92:95], v[72:75], v[60:63], v[92:95]
    ds_read_b128 v[24:27], v13 offset:32768
    v_mfma_f32_16x16x32_bf16 v[96:99], v[72:75], v[64:67], v[96:99]
    ds_read_b64_tr_b16 v[44:45], v16 offset:0
    v_mfma_f32_16x16x32_bf16 v[100:103], v[72:75], v[68:71], v[100:103]
    ds_read_b64_tr_b16 v[46:47], v16 offset:1536
    v_mfma_f32_16x16x32_bf16 v[104:107], v[76:79], v[56:59], v[104:107]
    ds_read_b128 v[28:31], v13 offset:34816
    v_mfma_f32_16x16x32_bf16 v[108:111], v[76:79], v[60:63], v[108:111]
    ds_read_b64_tr_b16 v[48:49], v17 offset:0
    v_mfma_f32_16x16x32_bf16 v[112:115], v[76:79], v[64:67], v[112:115]
    ds_read_b64_tr_b16 v[50:51], v17 offset:1536
    v_mfma_f32_16x16x32_bf16 v[116:119], v[76:79], v[68:71], v[116:119]
    ds_read_b128 v[32:35], v13 offset:36864
    v_mfma_f32_16x16x32_bf16 v[120:123], v[80:83], v[56:59], v[120:123]
    ds_read_b64_tr_b16 v[52:53], v18 offset:0
    v_mfma_f32_16x16x32_bf16 v[124:127], v[80:83], v[60:63], v[124:127]
    ds_read_b64_tr_b16 v[54:55], v18 offset:1536
    v_mfma_f32_16x16x32_bf16 v[128:131], v[80:83], v[64:67], v[128:131]
    ds_read_b128 v[36:39], v13 offset:38912
    v_mfma_f32_16x16x32_bf16 v[132:135], v[80:83], v[68:71], v[132:135]
    s_add_u32 m0, s44, 73728
    s_nop 0
    buffer_load_dwordx4 v11, s[36:39], s47 offen lds
    v_mfma_f32_16x16x32_bf16 v[136:139], v[84:87], v[56:59], v[136:139]
    v_mfma_f32_16x16x32_bf16 v[140:143], v[84:87], v[60:63], v[140:143]
    s_add_u32 m0, s44, 74752
    s_nop 0
    buffer_load_dwordx4 v12, s[36:39], s47 offen lds
    s_add_u32 s47, s47, s48
    v_mfma_f32_16x16x32_bf16 v[144:147], v[84:87], v[64:67], v[144:147]
    v_mfma_f32_16x16x32_bf16 v[148:151], v[84:87], v[68:71], v[148:151]
    s_waitcnt lgkmcnt(0)
    v_mfma_f32_16x16x32_bf16 v[88:91], v[40:43], v[24:27], v[88:91]
    s_waitcnt vmcnt(5)
    s_barrier
    ds_read_b64_tr_b16 v[72:73], v15 offset:24576
    ds_read_b64_tr_b16 v[74:75], v15 offset:26112
    v_mfma_f32_16x16x32_bf16 v[92:95], v[40:43], v[28:31], v[92:95]
    ds_read_b128 v[56:59], v14 offset:32768
    v_mfma_f32_16x16x32_bf16 v[96:99], v[40:43], v[32:35], v[96:99]
    ds_read_b64_tr_b16 v[76:77], v16 offset:24576
    v_mfma_f32_16x16x32_bf16 v[100:103], v[40:43], v[36:39], v[100:103]
    ds_read_b64_tr_b16 v[78:79], v16 offset:26112
    v_mfma_f32_16x16x32_bf16 v[104:107], v[44:47], v[24:27], v[104:107]
    ds_read_b128 v[60:63], v14 offset:34816
    v_mfma_f32_16x16x32_bf16 v[108:111], v[44:47], v[28:31], v[108:111]
    ds_read_b64_tr_b16 v[80:81], v17 offset:24576
    v_mfma_f32_16x16x32_bf16 v[112:115], v[44:47], v[32:35], v[112:115]
    ds_read_b64_tr_b16 v[82:83], v17 offset:26112
    v_mfma_f32_16x16x32_bf16 v[116:119], v[44:47], v[36:39], v[116:119]
    ds_read_b128 v[64:67], v14 offset:36864
    v_mfma_f32_16x16x32_bf16 v[120:123], v[48:51], v[24:27], v[120:123]
    ds_read_b64_tr_b16 v[84:85], v18 offset:24576
    v_mfma_f32_16x16x32_bf16 v[124:127], v[48:51], v[28:31], v[124:127]
    ds_read_b64_tr_b16 v[86:87], v18 offset:26112
    v_mfma_f32_16x16x32_bf16 v[128:131], v[48:51], v[32:35], v[128:131]
    ds_read_b128 v[68:71], v14 offset:38912
    v_mfma_f32_16x16x32_bf16 v[132:135], v[48:51], v[36:39], v[132:135]
    v_mfma_f32_16x16x32_bf16 v[136:139], v[52:55], v[24:27], v[136:139]
    v_mfma_f32_16x16x32_bf16 v[140:143], v[52:55], v[28:31], v[140:143]
    v_mfma_f32_16x16x32_bf16 v[144:147], v[52:55], v[32:35], v[144:147]
    v_mfma_f32_16x16x32_bf16 v[148:151], v[52:55], v[36:39], v[148:151]
    s_waitcnt lgkmcnt(0)
    v_mfma_f32_16x16x32_bf16 v[88:91], v[72:75], v[56:59], v[88:91]
    s_waitcnt vmcnt(2)
    s_barrier
    ds_read_b64_tr_b16 v[40:41], v19 offset:0
    ds_read_b64_tr_b16 v[42:43], v19 offset:1536
    v_mfma_f32_16x16x32_bf16 v[92:95], v[72:75], v[60:63], v[92:95]
    ds_read_b128 v[24:27], v13 offset:0
    v_mfma_f32_16x16x32_bf16 v[96:99], v[72:75], v[64:67], v[96:99]
    ds_read_b64_tr_b16 v[44:45], v20 offset:0
    v_mfma_f32_16x16x32_bf16 v[100:103], v[72:75], v[68:71], v[100:103]
    ds_read_b64_tr_b16 v[46:47], v20 offset:1536
    v_mfma_f32_16x16x32_bf16 v[104:107], v[76:79], v[56:59], v[104:107]
    ds_read_b128 v[28:31], v13 offset:2048
    v_mfma_f32_16x16x32_bf16 v[108:111], v[76:79], v[60:63], v[108:111]
    ds_read_b64_tr_b16 v[48:49], v21 offset:0
    v_mfma_f32_16x16x32_bf16 v[112:115], v[76:79], v[64:67], v[112:115]
    ds_read_b64_tr_b16 v[50:51], v21 offset:1536
    v_mfma_f32_16x16x32_bf16 v[116:119], v[76:79], v[68:71], v[116:119]
    ds_read_b128 v[32:35], v13 offset:4096
    v_mfma_f32_16x16x32_bf16 v[120:123], v[80:83], v[56:59], v[120:123]
    ds_read_b64_tr_b16 v[52:53], v22 offset:0
    v_mfma_f32_16x16x32_bf16 v[124:127], v[80:83], v[60:63], v[124:127]
    ds_read_b64_tr_b16 v[54:55], v22 offset:1536
    v_mfma_f32_16x16x32_bf16 v[128:131], v[80:83], v[64:67], v[128:131]
    ds_read_b128 v[36:39], v13 offset:6144
    v_mfma_f32_16x16x32_bf16 v[132:135], v[80:83], v[68:71], v[132:135]
    v_mfma_f32_16x16x32_bf16 v[136:139], v[84:87], v[56:59], v[136:139]
    v_mfma_f32_16x16x32_bf16 v[140:143], v[84:87], v[60:63], v[140:143]
    v_mfma_f32_16x16x32_bf16 v[144:147], v[84:87], v[64:67], v[144:147]
    v_mfma_f32_16x16x32_bf16 v[148:151], v[84:87], v[68:71], v[148:151]
    s_waitcnt lgkmcnt(0)
    v_mfma_f32_16x16x32_bf16 v[88:91], v[40:43], v[24:27], v[88:91]
    s_waitcnt vmcnt(0)
    s_barrier
    ds_read_b64_tr_b16 v[72:73], v19 offset:24576
    ds_read_b64_tr_b16 v[74:75], v19 offset:26112
    v_mfma_f32_16x16x32_bf16 v[92:95], v[40:43], v[28:31], v[92:95]
    ds_read_b128 v[56:59], v14 offset:0
    v_mfma_f32_16x16x32_bf16 v[96:99], v[40:43], v[32:35], v[96:99]
    ds_read_b64_tr_b16 v[76:77], v20 offset:24576
    v_mfma_f32_16x16x32_bf16 v[100:103], v[40:43], v[36:39], v[100:103]
    ds_read_b64_tr_b16 v[78:79], v20 offset:26112
    v_mfma_f32_16x16x32_bf16 v[104:107], v[44:47], v[24:27], v[104:107]
    ds_read_b128 v[60:63], v14 offset:2048
    v_mfma_f32_16x16x32_bf16 v[108:111], v[44:47], v[28:31], v[108:111]
    ds_read_b64_tr_b16 v[80:81], v21 offset:24576
    v_mfma_f32_16x16x32_bf16 v[112:115], v[44:47], v[32:35], v[112:115]
    ds_read_b64_tr_b16 v[82:83], v21 offset:26112
    v_mfma_f32_16x16x32_bf16 v[116:119], v[44:47], v[36:39], v[116:119]
    ds_read_b128 v[64:67], v14 offset:4096
    v_mfma_f32_16x16x32_bf16 v[120:123], v[48:51], v[24:27], v[120:123]
    ds_read_b64_tr_b16 v[84:85], v22 offset:24576
    v_mfma_f32_16x16x32_bf16 v[124:127], v[48:51], v[28:31], v[124:127]
    ds_read_b64_tr_b16 v[86:87], v22 offset:26112
    v_mfma_f32_16x16x32_bf16 v[128:131], v[48:51], v[32:35], v[128:131]
    ds_read_b128 v[68:71], v14 offset:6144
    v_mfma_f32_16x16x32_bf16 v[132:135], v[48:51], v[36:39], v[132:135]
    v_mfma_f32_16x16x32_bf16 v[136:139], v[52:55], v[24:27], v[136:139]
    v_mfma_f32_16x16x32_bf16 v[140:143], v[52:55], v[28:31], v[140:143]
    v_mfma_f32_16x16x32_bf16 v[144:147], v[52:55], v[32:35], v[144:147]
    v_mfma_f32_16x16x32_bf16 v[148:151], v[52:55], v[36:39], v[148:151]
    s_waitcnt lgkmcnt(0)
    v_mfma_f32_16x16x32_bf16 v[88:91], v[72:75], v[56:59], v[88:91]
    v_mfma_f32_16x16x32_bf16 v[92:95], v[72:75], v[60:63], v[92:95]
    v_mfma_f32_16x16x32_bf16 v[96:99], v[72:75], v[64:67], v[96:99]
    v_mfma_f32_16x16x32_bf16 v[100:103], v[72:75], v[68:71], v[100:103]
    v_mfma_f32_16x16x32_bf16 v[104:107], v[76:79], v[56:59], v[104:107]
    v_mfma_f32_16x16x32_bf16 v[108:111], v[76:79], v[60:63], v[108:111]
    v_mfma_f32_16x16x32_bf16 v[112:115], v[76:79], v[64:67], v[112:115]
    v_mfma_f32_16x16x32_bf16 v[116:119], v[76:79], v[68:71], v[116:119]
    v_mfma_f32_16x16x32_bf16 v[120:123], v[80:83], v[56:59], v[120:123]
    v_mfma_f32_16x16x32_bf16 v[124:127], v[80:83], v[60:63], v[124:127]
    v_mfma_f32_16x16x32_bf16 v[128:131], v[80:83], v[64:67], v[128:131]
    v_mfma_f32_16x16x32_bf16 v[132:135], v[80:83], v[68:71], v[132:135]
    v_mfma_f32_16x16x32_bf16 v[136:139], v[84:87], v[56:59], v[136:139]
    v_mfma_f32_16x16x32_bf16 v[140:143], v[84:87], v[60:63], v[140:143]
    v_mfma_f32_16x16x32_bf16 v[144:147], v[84:87], v[64:67], v[144:147]
    v_mfma_f32_16x16x32_bf16 v[148:151], v[84:87], v[68:71], v[148:151]
    s_branch k1_kernel_EPI_GLU
k1_kernel_VAR5:
    s_waitcnt vmcnt(4)
    s_barrier
    ds_read_b64_tr_b16 v[40:41], v15 offset:0
    ds_read_b64_tr_b16 v[42:43], v15 offset:1536
    ds_read_b128 v[24:27], v13 offset:0
    ds_read_b64_tr_b16 v[44:45], v16 offset:0
    ds_read_b64_tr_b16 v[46:47], v16 offset:1536
    ds_read_b128 v[28:31], v13 offset:2048
    ds_read_b64_tr_b16 v[48:49], v17 offset:0
    ds_read_b64_tr_b16 v[50:51], v17 offset:1536
    ds_read_b128 v[32:35], v13 offset:4096
    ds_read_b64_tr_b16 v[52:53], v18 offset:0
    ds_read_b64_tr_b16 v[54:55], v18 offset:1536
    ds_read_b128 v[36:39], v13 offset:6144
    s_add_u32 m0, s44, 73728
    s_nop 0
    buffer_load_dwordx4 v11, s[36:39], s47 offen lds
    s_add_u32 m0, s44, 74752
    s_nop 0
    buffer_load_dwordx4 v12, s[36:39], s47 offen lds
    s_add_u32 s47, s47, s48
    s_waitcnt lgkmcnt(0)
    v_mfma_f32_16x16x32_bf16 v[88:91], v[40:43], v[24:27], 0
    s_waitcnt vmcnt(4)
    s_barrier
    ds_read_b64_tr_b16 v[72:73], v15 offset:24576
    ds_read_b64_tr_b16 v[74:75], v15 offset:26112
    v_mfma_f32_16x16x32_bf16 v[92:95], v[40:43], v[28:31], 0
    ds_read_b128 v[56:59], v14 offset:0
    v_mfma_f32_16x16x32_bf16 v[96:99], v[40:43], v[32:35], 0
    ds_read_b64_tr_b16 v[76:77], v16 offset:24576
    v_mfma_f32_16x16x32_bf16 v[100:103], v[40:43], v[36:39], 0
    ds_read_b64_tr_b16 v[78:79], v16 offset:26112
    v_mfma_f32_16x16x32_bf16 v[104:107], v[44:47], v[24:27], 0
    ds_read_b128 v[60:63], v14 offset:2048
    v_mfma_f32_16x16x32_bf16 v[108:111], v[44:47], v[28:31], 0
    ds_read_b64_tr_b16 v[80:81], v17 offset:24576
    v_mfma_f32_16x16x32_bf16 v[112:115], v[44:47], v[32:35], 0
    ds_read_b64_tr_b16 v[82:83], v17 offset:26112
    v_mfma_f32_16x16x32_bf16 v[116:119], v[44:47], v[36:39], 0
    ds_read_b128 v[64:67], v14 offset:4096
    v_mfma_f32_16x16x32_bf16 v[120:123], v[48:51], v[24:27], 0
    ds_read_b64_tr_b16 v[84:85], v18 offset:24576
    v_mfma_f32_16x16x32_bf16 v[124:127], v[48:51], v[28:31], 0
    ds_read_b64_tr_b16 v[86:87], v18 offset:26112
    v_mfma_f32_16x16x32_bf16 v[128:131], v[48:51], v[32:35], 0
    ds_read_b128 v[68:71], v14 offset:6144
    v_mfma_f32_16x16x32_bf16 v[132:135], v[48:51], v[36:39], 0
    s_add_u32 m0, s44, 0
    s_nop 0
    buffer_load_dwordx4 v11, s[36:39], s47 offen lds
    v_mfma_f32_16x16x32_bf16 v[136:139], v[52:55], v[24:27], 0
    v_mfma_f32_16x16x32_bf16 v[140:143], v[52:55], v[28:31], 0
    s_add_u32 m0, s44, 1024
    s_nop 0
    buffer_load_dwordx4 v12, s[36:39], s47 offen lds
    s_add_u32 s47, s47, s48
    v_mfma_f32_16x16x32_bf16 v[144:147], v[52:55], v[32:35], 0
    v_mfma_f32_16x16x32_bf16 v[148:151], v[52:55], v[36:39], 0
    s_waitcnt lgkmcnt(0)
    v_mfma_f32_16x16x32_bf16 v[88:91], v[72:75], v[56:59], v[88:91]
    s_waitcnt vmcnt(4)
    s_barrier
    ds_read_b64_tr_b16 v[40:41], v19 offset:0
    ds_read_b64_tr_b16 v[42:43], v19 offset:1536
    v_mfma_f32_16x16x32_bf16 v[92:95], v[72:75], v[60:63], v[92:95]
    ds_read_b128 v[24:27], v13 offset:16384
    v_mfma_f32_16x16x32_bf16 v[96:99], v[72:75], v[64:67], v[96:99]
    ds_read_b64_tr_b16 v[44:45], v20 offset:0
    v_mfma_f32_16x16x32_bf16 v[100:103], v[72:75], v[68:71], v[100:103]
    ds_read_b64_tr_b16 v[46:47], v20 offset:1536
    v_mfma_f32_16x16x32_bf16 v[104:107], v[76:79], v[56:59], v[104:107]
    ds_read_b128 v[28:31], v13 offset:18432
    v_mfma_f32_16x16x32_bf16 v[108:111], v[76:79], v[60:63], v[108:111]
    ds_read_b64_tr_b16 v[48:49], v21 offset:0
    v_mfma_f32_16x16x32_bf16 v[112:115], v[76:79], v[64:67], v[112:115]
    ds_read_b64_tr_b16 v[50:51], v21 offset:1536
    v_mfma_f32_16x16x32_bf16 v[116:119], v[76:79], v[68:71], v[116:119]
    ds_read_b128 v[32:35], v13 offset:20480
    v_mfma_f32_16x16x32_bf16 v[120:123], v[80:83], v[56:59], v[120:123]
    ds_read_b64_tr_b16 v[52:53], v22 offset:0
    v_mfma_f32_16x16x32_bf16 v[124:127], v[80:83], v[60:63], v[124:127]
    ds_read_b64_tr_b16 v[54:55], v22 offset:1536
    v_mfma_f32_16x16x32_bf16 v[128:131], v[80:83], v[64:67], v[128:131]
    ds_read_b128 v[36:39], v13 offset:22528
    v_mfma_f32_16x16x32_bf16 v[132:135], v[80:83], v[68:71], v[132:135]
    s_add_u32 m0, s44, 24576
    s_nop 0
    buffer_load_dwordx4 v11, s[36:39], s47 offen lds
    v_mfma_f32_16x16x32_bf16 v[136:139], v[84:87], v[56:59], v[136:139]
    v_mfma_f32_16x16x32_bf16 v[140:143], v[84:87], v[60:63], v[140:143]
    s_add_u32 m0, s44, 25600
    s_nop 0
    buffer_load_dwordx4 v12, s[36:39], s47 offen lds
    s_add_u32 s47, s47, s48
    v_mfma_f32_16x16x32_bf16 v[144:147], v[84:87], v[64:67], v[144:147]
    v_mfma_f32_16x16x32_bf16 v[148:151], v[84:87], v[68:71], v[148:151]
    s_waitcnt lgkmcnt(0)
    v_mfma_f32_16x16x32_bf16 v[88:91], v[40:43], v[24:27], v[88:91]
    s_waitcnt vmcnt(4)
    s_barrier
    ds_read_b64_tr_b16 v[72:73], v19 offset:24576
    ds_read_b64_tr_b16 v[74:75], v19 offset:26112
    v_mfma_f32_16x16x32_bf16 v[92:95], v[40:43], v[28:31], v[92:95]
    ds_read_b128 v[56:59], v14 offset:16384
    v_mfma_f32_16x16x32_bf16 v[96:99], v[40:43], v[32:35], v[96:99]
    ds_read_b64_tr_b16 v[76:77], v20 offset:24576
    v_mfma_f32_16x16x32_bf16 v[100:103], v[40:43], v[36:39], v[100:103]
    ds_read_b64_tr_b16 v[78:79], v20 offset:26112
    v_mfma_f32_16x16x32_bf16 v[104:107], v[44:47], v[24:27], v[104:107]
    ds_read_b128 v[60:63], v14 offset:18432
    v_mfma_f32_16x16x32_bf16 v[108:111], v[44:47], v[28:31], v[108:111]
    ds_read_b64_tr_b16 v[80:81], v21 offset:24576
    v_mfma_f32_16x16x32_bf16 v[112:115], v[44:47], v[32:35], v[112:115]
    ds_read_b64_tr_b16 v[82:83], v21 offset:26112
    v_mfma_f32_16x16x32_bf16 v[116:119], v[44:47], v[36:39], v[116:119]
    ds_read_b128 v[64:67], v14 offset:20480
    v_mfma_f32_16x16x32_bf16 v[120:123], v[48:51], v[24:27], v[120:123]
    ds_read_b64_tr_b16 v[84:85], v22 offset:24576
    v_mfma_f32_16x16x32_bf16 v[124:127], v[48:51], v[28:31], v[124:127]
    ds_read_b64_tr_b16 v[86:87], v22 offset:26112
    v_mfma_f32_16x16x32_bf16 v[128:131], v[48:51], v[32:35], v[128:131]
    ds_read_b128 v[68:71], v14 offset:22528
    v_mfma_f32_16x16x32_bf16 v[132:135], v[48:51], v[36:39], v[132:135]
    s_add_u32 m0, s44, 49152
    s_nop 0
    buffer_load_dwordx4 v11, s[36:39], s47 offen lds
    v_mfma_f32_16x16x32_bf16 v[136:139], v[52:55], v[24:27], v[136:139]
    v_mfma_f32_16x16x32_bf16 v[140:143], v[52:55], v[28:31], v[140:143]
    s_add_u32 m0, s44, 50176
    s_nop 0
    buffer_load_dwordx4 v12, s[36:39], s47 offen lds
    s_add_u32 s47, s47, s48
    v_mfma_f32_16x16x32_bf16 v[144:147], v[52:55], v[32:35], v[144:147]
    v_mfma_f32_16x16x32_bf16 v[148:151], v[52:55], v[36:39], v[148:151]
    s_waitcnt lgkmcnt(0)
    v_mfma_f32_16x16x32_bf16 v[88:91], v[72:75], v[56:59], v[88:91]
    s_waitcnt vmcnt(4)
    s_barrier
    ds_read_b64_tr_b16 v[40:41], v15 offset:0
    ds_read_b64_tr_b16 v[42:43], v15 offset:1536
    v_mfma_f32_16x16x32_bf16 v[92:95], v[72:75], v[60:63], v[92:95]
    ds_read_b128 v[24:27], v13 offset:32768
    v_mfma_f32_16x16x32_bf16 v[96:99], v[72:75], v[64:67], v[96:99]
    ds_read_b64_tr_b16 v[44:45], v16 offset:0
    v_mfma_f32_16x16x32_bf16 v[100:103], v[72:75], v[68:71], v[100:103]
    ds_read_b64_tr_b16 v[46:47], v16 offset:1536
    v_mfma_f32_16x16x32_bf16 v[104:107], v[76:79], v[56:59], v[104:107]
    ds_read_b128 v[28:31], v13 offset:34816
    v_mfma_f32_16x16x32_bf16 v[108:111], v[76:79], v[60:63], v[108:111]
    ds_read_b64_tr_b16 v[48:49], v17 offset:0
    v_mfma_f32_16x16x32_bf16 v[112:115], v[76:79], v[64:67], v[112:115]
    ds_read_b64_tr_b16 v[50:51], v17 offset:1536
    v_mfma_f32_16x16x32_bf16 v[116:119], v[76:79], v[68:71], v[116:119]
    ds_read_b128 v[32:35], v13 offset:36864
    v_mfma_f32_16x16x32_bf16 v[120:123], v[80:83], v[56:59], v[120:123]
    ds_read_b64_tr_b16 v[52:53], v18 offset:0
    v_mfma_f32_16x16x32_bf16 v[124:127], v[80:83], v[60:63], v[124:127]
    ds_read_b64_tr_b16 v[54:55], v18 offset:1536
    v_mfma_f32_16x16x32_bf16 v[128:131], v[80:83], v[64:67], v[128:131]
    ds_read_b128 v[36:39], v13 offset:38912
    v_mfma_f32_16x16x32_bf16 v[132:135], v[80:83], v[68:71], v[132:135]
    s_add_u32 m0, s44, 73728
    s_nop 0
    buffer_load_dwordx4 v11, s[36:39], s47 offen lds
    v_mfma_f32_16x16x32_bf16 v[136:139], v[84:87], v[56:59], v[136:139]
    v_mfma_f32_16x16x32_bf16 v[140:143], v[84:87], v[60:63], v[140:143]
    s_add_u32 m0, s44, 74752
    s_nop 0
    buffer_load_dwordx4 v12, s[36:39], s47 offen lds
    s_add_u32 s47, s47, s48
    v_mfma_f32_16x16x32_bf16 v[144:147], v[84:87], v[64:67], v[144:147]
    v_mfma_f32_16x16x32_bf16 v[148:151], v[84:87], v[68:71], v[148:151]
    s_waitcnt lgkmcnt(0)
    v_mfma_f32_16x16x32_bf16 v[88:91], v[40:43], v[24:27], v[88:91]
    s_waitcnt vmcnt(4)
    s_barrier
    ds_read_b64_tr_b16 v[72:73], v15 offset:24576
    ds_read_b64_tr_b16 v[74:75], v15 offset:26112
    v_mfma_f32_16x16x32_bf16 v[92:95], v[40:43], v[28:31], v[92:95]
    ds_read_b128 v[56:59], v14 offset:32768
    v_mfma_f32_16x16x32_bf16 v[96:99], v[40:43], v[32:35], v[96:99]
    ds_read_b64_tr_b16 v[76:77], v16 offset:24576
    v_mfma_f32_16x16x32_bf16 v[100:103], v[40:43], v[36:39], v[100:103]
    ds_read_b64_tr_b16 v[78:79], v16 offset:26112
    v_mfma_f32_16x16x32_bf16 v[104:107], v[44:47], v[24:27], v[104:107]
    ds_read_b128 v[60:63], v14 offset:34816
    v_mfma_f32_16x16x32_bf16 v[108:111], v[44:47], v[28:31], v[108:111]
    ds_read_b64_tr_b16 v[80:81], v17 offset:24576
    v_mfma_f32_16x16x32_bf16 v[112:115], v[44:47], v[32:35], v[112:115]
    ds_read_b64_tr_b16 v[82:83], v17 offset:26112
    v_mfma_f32_16x16x32_bf16 v[116:119], v[44:47], v[36:39], v[116:119]
    ds_read_b128 v[64:67], v14 offset:36864
    v_mfma_f32_16x16x32_bf16 v[120:123], v[48:51], v[24:27], v[120:123]
    ds_read_b64_tr_b16 v[84:85], v18 offset:24576
    v_mfma_f32_16x16x32_bf16 v[124:127], v[48:51], v[28:31], v[124:127]
    ds_read_b64_tr_b16 v[86:87], v18 offset:26112
    v_mfma_f32_16x16x32_bf16 v[128:131], v[48:51], v[32:35], v[128:131]
    ds_read_b128 v[68:71], v14 offset:38912
    v_mfma_f32_16x16x32_bf16 v[132:135], v[48:51], v[36:39], v[132:135]
    s_add_u32 m0, s44, 0
    s_nop 0
    buffer_load_dwordx4 v11, s[36:39], s47 offen lds
    v_mfma_f32_16x16x32_bf16 v[136:139], v[52:55], v[24:27], v[136:139]
    v_mfma_f32_16x16x32_bf16 v[140:143], v[52:55], v[28:31], v[140:143]
    s_add_u32 m0, s44, 1024
    s_nop 0
    buffer_load_dwordx4 v12, s[36:39], s47 offen lds
    s_add_u32 s47, s47, s48
    v_mfma_f32_16x16x32_bf16 v[144:147], v[52:55], v[32:35], v[144:147]
    v_mfma_f32_16x16x32_bf16 v[148:151], v[52:55], v[36:39], v[148:151]
    s_waitcnt lgkmcnt(0)
    v_mfma_f32_16x16x32_bf16 v[88:91], v[72:75], v[56:59], v[88:91]
    s_waitcnt vmcnt(4)
    s_barrier
    ds_read_b64_tr_b16 v[40:41], v19 offset:0
    ds_read_b64_tr_b16 v[42:43], v19 offset:1536
    v_mfma_f32_16x16x32_bf16 v[92:95], v[72:75], v[60:63], v[92:95]
    ds_read_b128 v[24:27], v13 offset:0
    v_mfma_f32_16x16x32_bf16 v[96:99], v[72:75], v[64:67], v[96:99]
    ds_read_b64_tr_b16 v[44:45], v20 offset:0
    v_mfma_f32_16x16x32_bf16 v[100:103], v[72:75], v[68:71], v[100:103]
    ds_read_b64_tr_b16 v[46:47], v20 offset:1536
    v_mfma_f32_16x16x32_bf16 v[104:107], v[76:79], v[56:59], v[104:107]
    ds_read_b128 v[28:31], v13 offset:2048
    v_mfma_f32_16x16x32_bf16 v[108:111], v[76:79], v[60:63], v[108:111]
    ds_read_b64_tr_b16 v[48:49], v21 offset:0
    v_mfma_f32_16x16x32_bf16 v[112:115], v[76:79], v[64:67], v[112:115]
    ds_read_b64_tr_b16 v[50:51], v21 offset:1536
    v_mfma_f32_16x16x32_bf16 v[116:119], v[76:79], v[68:71], v[116:119]
    ds_read_b128 v[32:35], v13 offset:4096
    v_mfma_f32_16x16x32_bf16 v[120:123], v[80:83], v[56:59], v[120:123]
    ds_read_b64_tr_b16 v[52:53], v22 offset:0
    v_mfma_f32_16x16x32_bf16 v[124:127], v[80:83], v[60:63], v[124:127]
    ds_read_b64_tr_b16 v[54:55], v22 offset:1536
    v_mfma_f32_16x16x32_bf16 v[128:131], v[80:83], v[64:67], v[128:131]
    ds_read_b128 v[36:39], v13 offset:6144
    v_mfma_f32_16x16x32_bf16 v[132:135], v[80:83], v[68:71], v[132:135]
    s_add_u32 m0, s44, 24576
    s_nop 0
    buffer_load_dwordx4 v11, s[36:39], s47 offen lds
    v_mfma_f32_16x16x32_bf16 v[136:139], v[84:87], v[56:59], v[136:139]
    v_mfma_f32_16x16x32_bf16 v[140:143], v[84:87], v[60:63], v[140:143]
    s_add_u32 m0, s44, 25600
    s_nop 0
    buffer_load_dwordx4 v12, s[36:39], s47 offen lds
    s_add_u32 s47, s47, s48
    v_mfma_f32_16x16x32_bf16 v[144:147], v[84:87], v[64:67], v[144:147]
    v_mfma_f32_16x16x32_bf16 v[148:151], v[84:87], v[68:71], v[148:151]
    s_waitcnt lgkmcnt(0)
    v_mfma_f32_16x16x32_bf16 v[88:91], v[40:43], v[24:27], v[88:91]
    s_waitcnt vmcnt(4)
    s_barrier
    ds_read_b64_tr_b16 v[72:73], v19 offset:24576
    ds_read_b64_tr_b16 v[74:75], v19 offset:26112
    v_mfma_f32_16x16x32_bf16 v[92:95], v[40:43], v[28:31], v[92:95]
    ds_read_b128 v[56:59], v14 offset:0
    v_mfma_f32_16x16x32_bf16 v[96:99], v[40:43], v[32:35], v[96:99]
    ds_read_b64_tr_b16 v[76:77], v20 offset:24576
    v_mfma_f32_16x16x32_bf16 v[100:103], v[40:43], v[36:39], v[100:103]
    ds_read_b64_tr_b16 v[78:79], v20 offset:26112
    v_mfma_f32_16x16x32_bf16 v[104:107], v[44:47], v[24:27], v[104:107]
    ds_read_b128 v[60:63], v14 offset:2048
    v_mfma_f32_16x16x32_bf16 v[108:111], v[44:47], v[28:31], v[108:111]
    ds_read_b64_tr_b16 v[80:81], v21 offset:24576
    v_mfma_f32_16x16x32_bf16 v[112:115], v[44:47], v[32:35], v[112:115]
    ds_read_b64_tr_b16 v[82:83], v21 offset:26112
    v_mfma_f32_16x16x32_bf16 v[116:119], v[44:47], v[36:39], v[116:119]
    ds_read_b128 v[64:67], v14 offset:4096
    v_mfma_f32_16x16x32_bf16 v[120:123], v[48:51], v[24:27], v[120:123]
    ds_read_b64_tr_b16 v[84:85], v22 offset:24576
    v_mfma_f32_16x16x32_bf16 v[124:127], v[48:51], v[28:31], v[124:127]
    ds_read_b64_tr_b16 v[86:87], v22 offset:26112
    v_mfma_f32_16x16x32_bf16 v[128:131], v[48:51], v[32:35], v[128:131]
    ds_read_b128 v[68:71], v14 offset:6144
    v_mfma_f32_16x16x32_bf16 v[132:135], v[48:51], v[36:39], v[132:135]
    s_add_u32 m0, s44, 49152
    s_nop 0
    buffer_load_dwordx4 v11, s[36:39], s47 offen lds
    v_mfma_f32_16x16x32_bf16 v[136:139], v[52:55], v[24:27], v[136:139]
    v_mfma_f32_16x16x32_bf16 v[140:143], v[52:55], v[28:31], v[140:143]
    s_add_u32 m0, s44, 50176
    s_nop 0
    buffer_load_dwordx4 v12, s[36:39], s47 offen lds
    s_add_u32 s47, s47, s48
    v_mfma_f32_16x16x32_bf16 v[144:147], v[52:55], v[32:35], v[144:147]
    v_mfma_f32_16x16x32_bf16 v[148:151], v[52:55], v[36:39], v[148:151]
    s_waitcnt lgkmcnt(0)
    v_mfma_f32_16x16x32_bf16 v[88:91], v[72:75], v[56:59], v[88:91]
    s_waitcnt vmcnt(4)
    s_barrier
    ds_read_b64_tr_b16 v[40:41], v15 offset:0
    ds_read_b64_tr_b16 v[42:43], v15 offset:1536
    v_mfma_f32_16x16x32_bf16 v[92:95], v[72:75], v[60:63], v[92:95]
    ds_read_b128 v[24:27], v13 offset:16384
    v_mfma_f32_16x16x32_bf16 v[96:99], v[72:75], v[64:67], v[96:99]
    ds_read_b64_tr_b16 v[44:45], v16 offset:0
    v_mfma_f32_16x16x32_bf16 v[100:103], v[72:75], v[68:71], v[100:103]
    ds_read_b64_tr_b16 v[46:47], v16 offset:1536
    v_mfma_f32_16x16x32_bf16 v[104:107], v[76:79], v[56:59], v[104:107]
    ds_read_b128 v[28:31], v13 offset:18432
    v_mfma_f32_16x16x32_bf16 v[108:111], v[76:79], v[60:63], v[108:111]
    ds_read_b64_tr_b16 v[48:49], v17 offset:0
    v_mfma_f32_16x16x32_bf16 v[112:115], v[76:79], v[64:67], v[112:115]
    ds_read_b64_tr_b16 v[50:51], v17 offset:1536
    v_mfma_f32_16x16x32_bf16 v[116:119], v[76:79], v[68:71], v[116:119]
    ds_read_b128 v[32:35], v13 offset:20480
    v_mfma_f32_16x16x32_bf16 v[120:123], v[80:83], v[56:59], v[120:123]
    ds_read_b64_tr_b16 v[52:53], v18 offset:0
    v_mfma_f32_16x16x32_bf16 v[124:127], v[80:83], v[60:63], v[124:127]
    ds_read_b64_tr_b16 v[54:55], v18 offset:1536
    v_mfma_f32_16x16x32_bf16 v[128:131], v[80:83], v[64:67], v[128:131]
    ds_read_b128 v[36:39], v13 offset:22528
    v_mfma_f32_16x16x32_bf16 v[132:135], v[80:83], v[68:71], v[132:135]
    s_add_u32 m0, s44, 73728
    s_nop 0
    buffer_load_dwordx4 v11, s[36:39], s47 offen lds
    v_mfma_f32_16x16x32_bf16 v[136:139], v[84:87], v[56:59], v[136:139]
    v_mfma_f32_16x16x32_bf16 v[140:143], v[84:87], v[60:63], v[140:143]
    s_add_u32 m0, s44, 74752
    s_nop 0
    buffer_load_dwordx4 v12, s[36:39], s47 offen lds
    s_add_u32 s47, s47, s48
    v_mfma_f32_16x16x32_bf16 v[144:147], v[84:87], v[64:67], v[144:147]
    v_mfma_f32_16x16x32_bf16 v[148:151], v[84:87], v[68:71], v[148:151]
    s_waitcnt lgkmcnt(0)
    v_mfma_f32_16x16x32_bf16 v[88:91], v[40:43], v[24:27], v[88:91]
    s_waitcnt vmcnt(4)
    s_barrier
    ds_read_b64_tr_b16 v[72:73], v15 offset:24576
    ds_read_b64_tr_b16 v[74:75], v15 offset:26112
    v_mfma_f32_16x16x32_bf16 v[92:95], v[40:43], v[28:31], v[92:95]
    ds_read_b128 v[56:59], v14 offset:16384
    v_mfma_f32_16x16x32_bf16 v[96:99], v[40:43], v[32:35], v[96:99]
    ds_read_b64_tr_b16 v[76:77], v16 offset:24576
    v_mfma_f32_16x16x32_bf16 v[100:103], v[40:43], v[36:39], v[100:103]
    ds_read_b64_tr_b16 v[78:79], v16 offset:26112
    v_mfma_f32_16x16x32_bf16 v[104:107], v[44:47], v[24:27], v[104:107]
    ds_read_b128 v[60:63], v14 offset:18432
    v_mfma_f32_16x16x32_bf16 v[108:111], v[44:47], v[28:31], v[108:111]
    ds_read_b64_tr_b16 v[80:81], v17 offset:24576
    v_mfma_f32_16x16x32_bf16 v[112:115], v[44:47], v[32:35], v[112:115]
    ds_read_b64_tr_b16 v[82:83], v17 offset:26112
    v_mfma_f32_16x16x32_bf16 v[116:119], v[44:47], v[36:39], v[116:119]
    ds_read_b128 v[64:67], v14 offset:20480
    v_mfma_f32_16x16x32_bf16 v[120:123], v[48:51], v[24:27], v[120:123]
    ds_read_b64_tr_b16 v[84:85], v18 offset:24576
    v_mfma_f32_16x16x32_bf16 v[124:127], v[48:51], v[28:31], v[124:127]
    ds_read_b64_tr_b16 v[86:87], v18 offset:26112
    v_mfma_f32_16x16x32_bf16 v[128:131], v[48:51], v[32:35], v[128:131]
    ds_read_b128 v[68:71], v14 offset:22528
    v_mfma_f32_16x16x32_bf16 v[132:135], v[48:51], v[36:39], v[132:135]
    s_add_u32 m0, s44, 0
    s_nop 0
    buffer_load_dwordx4 v11, s[36:39], s47 offen lds
    v_mfma_f32_16x16x32_bf16 v[136:139], v[52:55], v[24:27], v[136:139]
    v_mfma_f32_16x16x32_bf16 v[140:143], v[52:55], v[28:31], v[140:143]
    s_add_u32 m0, s44, 1024
    s_nop 0
    buffer_load_dwordx4 v12, s[36:39], s47 offen lds
    s_add_u32 s47, s47, s48
    v_mfma_f32_16x16x32_bf16 v[144:147], v[52:55], v[32:35], v[144:147]
    v_mfma_f32_16x16x32_bf16 v[148:151], v[52:55], v[36:39], v[148:151]
    s_waitcnt lgkmcnt(0)
    v_mfma_f32_16x16x32_bf16 v[88:91], v[72:75], v[56:59], v[88:91]
    s_waitcnt vmcnt(4)
    s_barrier
    ds_read_b64_tr_b16 v[40:41], v19 offset:0
    ds_read_b64_tr_b16 v[42:43], v19 offset:1536
    v_mfma_f32_16x16x32_bf16 v[92:95], v[72:75], v[60:63], v[92:95]
    ds_read_b128 v[24:27], v13 offset:32768
    v_mfma_f32_16x16x32_bf16 v[96:99], v[72:75], v[64:67], v[96:99]
    ds_read_b64_tr_b16 v[44:45], v20 offset:0
    v_mfma_f32_16x16x32_bf16 v[100:103], v[72:75], v[68:71], v[100:103]
    ds_read_b64_tr_b16 v[46:47], v20 offset:1536
    v_mfma_f32_16x16x32_bf16 v[104:107], v[76:79], v[56:59], v[104:107]
    ds_read_b128 v[28:31], v13 offset:34816
    v_mfma_f32_16x16x32_bf16 v[108:111], v[76:79], v[60:63], v[108:111]
    ds_read_b64_tr_b16 v[48:49], v21 offset:0
    v_mfma_f32_16x16x32_bf16 v[112:115], v[76:79], v[64:67], v[112:115]
    ds_read_b64_tr_b16 v[50:51], v21 offset:1536
    v_mfma_f32_16x16x32_bf16 v[116:119], v[76:79], v[68:71], v[116:119]
    ds_read_b128 v[32:35], v13 offset:36864
    v_mfma_f32_16x16x32_bf16 v[120:123], v[80:83], v[56:59], v[120:123]
    ds_read_b64_tr_b16 v[52:53], v22 offset:0
    v_mfma_f32_16x16x32_bf16 v[124:127], v[80:83], v[60:63], v[124:127]
    ds_read_b64_tr_b16 v[54:55], v22 offset:1536
    v_mfma_f32_16x16x32_bf16 v[128:131], v[80:83], v[64:67], v[128:131]
    ds_read_b128 v[36:39], v13 offset:38912
    v_mfma_f32_16x16x32_bf16 v[132:135], v[80:83], v[68:71], v[132:135]
    s_add_u32 m0, s44, 24576
    s_nop 0
    buffer_load_dwordx4 v11, s[36:39], s47 offen lds
    v_mfma_f32_16x16x32_bf16 v[136:139], v[84:87], v[56:59], v[136:139]
    v_mfma_f32_16x16x32_bf16 v[140:143], v[84:87], v[60:63], v[140:143]
    s_add_u32 m0, s44, 25600
    s_nop 0
    buffer_load_dwordx4 v12, s[36:39], s47 offen lds
    s_add_u32 s47, s47, s48
    v_mfma_f32_16x16x32_bf16 v[144:147], v[84:87], v[64:67], v[144:147]
    v_mfma_f32_16x16x32_bf16 v[148:151], v[84:87], v[68:71], v[148:151]
    s_waitcnt lgkmcnt(0)
    v_mfma_f32_16x16x32_bf16 v[88:91], v[40:43], v[24:27], v[88:91]
    s_waitcnt vmcnt(4)
    s_barrier
    ds_read_b64_tr_b16 v[72:73], v19 offset:24576
    ds_read_b64_tr_b16 v[74:75], v19 offset:26112
    v_mfma_f32_16x16x32_bf16 v[92:95], v[40:43], v[28:31], v[92:95]
    ds_read_b128 v[56:59], v14 offset:32768
    v_mfma_f32_16x16x32_bf16 v[96:99], v[40:43], v[32:35], v[96:99]
    ds_read_b64_tr_b16 v[76:77], v20 offset:24576
    v_mfma_f32_16x16x32_bf16 v[100:103], v[40:43], v[36:39], v[100:103]
    ds_read_b64_tr_b16 v[78:79], v20 offset:26112
    v_mfma_f32_16x16x32_bf16 v[104:107], v[44:47], v[24:27], v[104:107]
    ds_read_b128 v[60:63], v14 offset:34816
    v_mfma_f32_16x16x32_bf16 v[108:111], v[44:47], v[28:31], v[108:111]
    ds_read_b64_tr_b16 v[80:81], v21 offset:24576
    v_mfma_f32_16x16x32_bf16 v[112:115], v[44:47], v[32:35], v[112:115]
    ds_read_b64_tr_b16 v[82:83], v21 offset:26112
    v_mfma_f32_16x16x32_bf16 v[116:119], v[44:47], v[36:39], v[116:119]
    ds_read_b128 v[64:67], v14 offset:36864
    v_mfma_f32_16x16x32_bf16 v[120:123], v[48:51], v[24:27], v[120:123]
    ds_read_b64_tr_b16 v[84:85], v22 offset:24576
    v_mfma_f32_16x16x32_bf16 v[124:127], v[48:51], v[28:31], v[124:127]
    ds_read_b64_tr_b16 v[86:87], v22 offset:26112
    v_mfma_f32_16x16x32_bf16 v[128:131], v[48:51], v[32:35], v[128:131]
    ds_read_b128 v[68:71], v14 offset:38912
    v_mfma_f32_16x16x32_bf16 v[132:135], v[48:51], v[36:39], v[132:135]
    s_add_u32 m0, s44, 49152
    s_nop 0
    buffer_load_dwordx4 v11, s[36:39], s47 offen lds
    v_mfma_f32_16x16x32_bf16 v[136:139], v[52:55], v[24:27], v[136:139]
    v_mfma_f32_16x16x32_bf16 v[140:143], v[52:55], v[28:31], v[140:143]
    s_add_u32 m0, s44, 50176
    s_nop 0
    buffer_load_dwordx4 v12, s[36:39], s47 offen lds
    s_add_u32 s47, s47, s48
    v_mfma_f32_16x16x32_bf16 v[144:147], v[52:55], v[32:35], v[144:147]
    v_mfma_f32_16x16x32_bf16 v[148:151], v[52:55], v[36:39], v[148:151]
    s_waitcnt lgkmcnt(0)
    v_mfma_f32_16x16x32_bf16 v[88:91], v[72:75], v[56:59], v[88:91]
    s_waitcnt vmcnt(4)
    s_barrier
    ds_read_b64_tr_b16 v[40:41], v15 offset:0
    ds_read_b64_tr_b16 v[42:43], v15 offset:1536
    v_mfma_f32_16x16x32_bf16 v[92:95], v[72:75], v[60:63], v[92:95]
    ds_read_b128 v[24:27], v13 offset:0
    v_mfma_f32_16x16x32_bf16 v[96:99], v[72:75], v[64:67], v[96:99]
    ds_read_b64_tr_b16 v[44:45], v16 offset:0
    v_mfma_f32_16x16x32_bf16 v[100:103], v[72:75], v[68:71], v[100:103]
    ds_read_b64_tr_b16 v[46:47], v16 offset:1536
    v_mfma_f32_16x16x32_bf16 v[104:107], v[76:79], v[56:59], v[104:107]
    ds_read_b128 v[28:31], v13 offset:2048
    v_mfma_f32_16x16x32_bf16 v[108:111], v[76:79], v[60:63], v[108:111]
    ds_read_b64_tr_b16 v[48:49], v17 offset:0
    v_mfma_f32_16x16x32_bf16 v[112:115], v[76:79], v[64:67], v[112:115]
    ds_read_b64_tr_b16 v[50:51], v17 offset:1536
    v_mfma_f32_16x16x32_bf16 v[116:119], v[76:79], v[68:71], v[116:119]
    ds_read_b128 v[32:35], v13 offset:4096
    v_mfma_f32_16x16x32_bf16 v[120:123], v[80:83], v[56:59], v[120:123]
    ds_read_b64_tr_b16 v[52:53], v18 offset:0
    v_mfma_f32_16x16x32_bf16 v[124:127], v[80:83], v[60:63], v[124:127]
    ds_read_b64_tr_b16 v[54:55], v18 offset:1536
    v_mfma_f32_16x16x32_bf16 v[128:131], v[80:83], v[64:67], v[128:131]
    ds_read_b128 v[36:39], v13 offset:6144
    v_mfma_f32_16x16x32_bf16 v[132:135], v[80:83], v[68:71], v[132:135]
    s_add_u32 m0, s44, 73728
    s_nop 0
    buffer_load_dwordx4 v11, s[36:39], s47 offen lds
    v_mfma_f32_16x16x32_bf16 v[136:139], v[84:87], v[56:59], v[136:139]
    v_mfma_f32_16x16x32_bf16 v[140:143], v[84:87], v[60:63], v[140:143]
    s_add_u32 m0, s44, 74752
    s_nop 0
    buffer_load_dwordx4 v12, s[36:39], s47 offen lds
    s_add_u32 s47, s47, s48
    v_mfma_f32_16x16x32_bf16 v[144:147], v[84:87], v[64:67], v[144:147]
    v_mfma_f32_16x16x32_bf16 v[148:151], v[84:87], v[68:71], v[148:151]
    s_waitcnt lgkmcnt(0)
    v_mfma_f32_16x16x32_bf16 v[88:91], v[40:43], v[24:27], v[88:91]
    s_waitcnt vmcnt(4)
    s_barrier
    ds_read_b64_tr_b16 v[72:73], v15 offset:24576
    ds_read_b64_tr_b16 v[74:75], v15 offset:26112
    v_mfma_f32_16x16x32_bf16 v[92:95], v[40:43], v[28:31], v[92:95]
    ds_read_b128 v[56:59], v14 offset:0
    v_mfma_f32_16x16x32_bf16 v[96:99], v[40:43], v[32:35], v[96:99]
    ds_read_b64_tr_b16 v[76:77], v16 offset:24576
    v_mfma_f32_16x16x32_bf16 v[100:103], v[40:43], v[36:39], v[100:103]
    ds_read_b64_tr_b16 v[78:79], v16 offset:26112
    v_mfma_f32_16x16x32_bf16 v[104:107], v[44:47], v[24:27], v[104:107]
    ds_read_b128 v[60:63], v14 offset:2048
    v_mfma_f32_16x16x32_bf16 v[108:111], v[44:47], v[28:31], v[108:111]
    ds_read_b64_tr_b16 v[80:81], v17 offset:24576
    v_mfma_f32_16x16x32_bf16 v[112:115], v[44:47], v[32:35], v[112:115]
    ds_read_b64_tr_b16 v[82:83], v17 offset:26112
    v_mfma_f32_16x16x32_bf16 v[116:119], v[44:47], v[36:39], v[116:119]
    ds_read_b128 v[64:67], v14 offset:4096
    v_mfma_f32_16x16x32_bf16 v[120:123], v[48:51], v[24:27], v[120:123]
    ds_read_b64_tr_b16 v[84:85], v18 offset:24576
    v_mfma_f32_16x16x32_bf16 v[124:127], v[48:51], v[28:31], v[124:127]
    ds_read_b64_tr_b16 v[86:87], v18 offset:26112
    v_mfma_f32_16x16x32_bf16 v[128:131], v[48:51], v[32:35], v[128:131]
    ds_read_b128 v[68:71], v14 offset:6144
    v_mfma_f32_16x16x32_bf16 v[132:135], v[48:51], v[36:39], v[132:135]
    s_add_u32 m0, s44, 0
    s_nop 0
    buffer_load_dwordx4 v11, s[36:39], s47 offen lds
    v_mfma_f32_16x16x32_bf16 v[136:139], v[52:55], v[24:27], v[136:139]
    v_mfma_f32_16x16x32_bf16 v[140:143], v[52:55], v[28:31], v[140:143]
    s_add_u32 m0, s44, 1024
    s_nop 0
    buffer_load_dwordx4 v12, s[36:39], s47 offen lds
    s_add_u32 s47, s47, s48
    v_mfma_f32_16x16x32_bf16 v[144:147], v[52:55], v[32:35], v[144:147]
    v_mfma_f32_16x16x32_bf16 v[148:151], v[52:55], v[36:39], v[148:151]
    s_waitcnt lgkmcnt(0)
    v_mfma_f32_16x16x32_bf16 v[88:91], v[72:75], v[56:59], v[88:91]
    s_waitcnt vmcnt(4)
    s_barrier
    ds_read_b64_tr_b16 v[40:41], v19 offset:0
    ds_read_b64_tr_b16 v[42:43], v19 offset:1536
    v_mfma_f32_16x16x32_bf16 v[92:95], v[72:75], v[60:63], v[92:95]
    ds_read_b128 v[24:27], v13 offset:16384
    v_mfma_f32_16x16x32_bf16 v[96:99], v[72:75], v[64:67], v[96:99]
    ds_read_b64_tr_b16 v[44:45], v20 offset:0
    v_mfma_f32_16x16x32_bf16 v[100:103], v[72:75], v[68:71], v[100:103]
    ds_read_b64_tr_b16 v[46:47], v20 offset:1536
    v_mfma_f32_16x16x32_bf16 v[104:107], v[76:79], v[56:59], v[104:107]
    ds_read_b128 v[28:31], v13 offset:18432
    v_mfma_f32_16x16x32_bf16 v[108:111], v[76:79], v[60:63], v[108:111]
    ds_read_b64_tr_b16 v[48:49], v21 offset:0
    v_mfma_f32_16x16x32_bf16 v[112:115], v[76:79], v[64:67], v[112:115]
    ds_read_b64_tr_b16 v[50:51], v21 offset:1536
    v_mfma_f32_16x16x32_bf16 v[116:119], v[76:79], v[68:71], v[116:119]
    ds_read_b128 v[32:35], v13 offset:20480
    v_mfma_f32_16x16x32_bf16 v[120:123], v[80:83], v[56:59], v[120:123]
    ds_read_b64_tr_b16 v[52:53], v22 offset:0
    v_mfma_f32_16x16x32_bf16 v[124:127], v[80:83], v[60:63], v[124:127]
    ds_read_b64_tr_b16 v[54:55], v22 offset:1536
    v_mfma_f32_16x16x32_bf16 v[128:131], v[80:83], v[64:67], v[128:131]
    ds_read_b128 v[36:39], v13 offset:22528
    v_mfma_f32_16x16x32_bf16 v[132:135], v[80:83], v[68:71], v[132:135]
    s_add_u32 m0, s44, 24576
    s_nop 0
    buffer_load_dwordx4 v11, s[36:39], s47 offen lds
    v_mfma_f32_16x16x32_bf16 v[136:139], v[84:87], v[56:59], v[136:139]
    v_mfma_f32_16x16x32_bf16 v[140:143], v[84:87], v[60:63], v[140:143]
    s_add_u32 m0, s44, 25600
    s_nop 0
    buffer_load_dwordx4 v12, s[36:39], s47 offen lds
    s_add_u32 s47, s47, s48
    v_mfma_f32_16x16x32_bf16 v[144:147], v[84:87], v[64:67], v[144:147]
    v_mfma_f32_16x16x32_bf16 v[148:151], v[84:87], v[68:71], v[148:151]
    s_waitcnt lgkmcnt(0)
    v_mfma_f32_16x16x32_bf16 v[88:91], v[40:43], v[24:27], v[88:91]
    s_waitcnt vmcnt(4)
    s_barrier
    ds_read_b64_tr_b16 v[72:73], v19 offset:24576
    ds_read_b64_tr_b16 v[74:75], v19 offset:26112
    v_mfma_f32_16x16x32_bf16 v[92:95], v[40:43], v[28:31], v[92:95]
    ds_read_b128 v[56:59], v14 offset:16384
    v_mfma_f32_16x16x32_bf16 v[96:99], v[40:43], v[32:35], v[96:99]
    ds_read_b64_tr_b16 v[76:77], v20 offset:24576
    v_mfma_f32_16x16x32_bf16 v[100:103], v[40:43], v[36:39], v[100:103]
    ds_read_b64_tr_b16 v[78:79], v20 offset:26112
    v_mfma_f32_16x16x32_bf16 v[104:107], v[44:47], v[24:27], v[104:107]
    ds_read_b128 v[60:63], v14 offset:18432
    v_mfma_f32_16x16x32_bf16 v[108:111], v[44:47], v[28:31], v[108:111]
    ds_read_b64_tr_b16 v[80:81], v21 offset:24576
    v_mfma_f32_16x16x32_bf16 v[112:115], v[44:47], v[32:35], v[112:115]
    ds_read_b64_tr_b16 v[82:83], v21 offset:26112
    v_mfma_f32_16x16x32_bf16 v[116:119], v[44:47], v[36:39], v[116:119]
    ds_read_b128 v[64:67], v14 offset:20480
    v_mfma_f32_16x16x32_bf16 v[120:123], v[48:51], v[24:27], v[120:123]
    ds_read_b64_tr_b16 v[84:85], v22 offset:24576
    v_mfma_f32_16x16x32_bf16 v[124:127], v[48:51], v[28:31], v[124:127]
    ds_read_b64_tr_b16 v[86:87], v22 offset:26112
    v_mfma_f32_16x16x32_bf16 v[128:131], v[48:51], v[32:35], v[128:131]
    ds_read_b128 v[68:71], v14 offset:22528
    v_mfma_f32_16x16x32_bf16 v[132:135], v[48:51], v[36:39], v[132:135]
    s_add_u32 m0, s44, 49152
    s_nop 0
    buffer_load_dwordx4 v11, s[36:39], s47 offen lds
    v_mfma_f32_16x16x32_bf16 v[136:139], v[52:55], v[24:27], v[136:139]
    v_mfma_f32_16x16x32_bf16 v[140:143], v[52:55], v[28:31], v[140:143]
    s_add_u32 m0, s44, 50176
    s_nop 0
    buffer_load_dwordx4 v12, s[36:39], s47 offen lds
    s_add_u32 s47, s47, s48
    v_mfma_f32_16x16x32_bf16 v[144:147], v[52:55], v[32:35], v[144:147]
    v_mfma_f32_16x16x32_bf16 v[148:151], v[52:55], v[36:39], v[148:151]
    s_waitcnt lgkmcnt(0)
    v_mfma_f32_16x16x32_bf16 v[88:91], v[72:75], v[56:59], v[88:91]
    s_waitcnt vmcnt(4)
    s_barrier
    ds_read_b64_tr_b16 v[40:41], v15 offset:0
    ds_read_b64_tr_b16 v[42:43], v15 offset:1536
    v_mfma_f32_16x16x32_bf16 v[92:95], v[72:75], v[60:63], v[92:95]
    ds_read_b128 v[24:27], v13 offset:32768
    v_mfma_f32_16x16x32_bf16 v[96:99], v[72:75], v[64:67], v[96:99]
    ds_read_b64_tr_b16 v[44:45], v16 offset:0
    v_mfma_f32_16x16x32_bf16 v[100:103], v[72:75], v[68:71], v[100:103]
    ds_read_b64_tr_b16 v[46:47], v16 offset:1536
    v_mfma_f32_16x16x32_bf16 v[104:107], v[76:79], v[56:59], v[104:107]
    ds_read_b128 v[28:31], v13 offset:34816
    v_mfma_f32_16x16x32_bf16 v[108:111], v[76:79], v[60:63], v[108:111]
    ds_read_b64_tr_b16 v[48:49], v17 offset:0
    v_mfma_f32_16x16x32_bf16 v[112:115], v[76:79], v[64:67], v[112:115]
    ds_read_b64_tr_b16 v[50:51], v17 offset:1536
    v_mfma_f32_16x16x32_bf16 v[116:119], v[76:79], v[68:71], v[116:119]
    ds_read_b128 v[32:35], v13 offset:36864
    v_mfma_f32_16x16x32_bf16 v[120:123], v[80:83], v[56:59], v[120:123]
    ds_read_b64_tr_b16 v[52:53], v18 offset:0
    v_mfma_f32_16x16x32_bf16 v[124:127], v[80:83], v[60:63], v[124:127]
    ds_read_b64_tr_b16 v[54:55], v18 offset:1536
    v_mfma_f32_16x16x32_bf16 v[128:131], v[80:83], v[64:67], v[128:131]
    ds_read_b128 v[36:39], v13 offset:38912
    v_mfma_f32_16x16x32_bf16 v[132:135], v[80:83], v[68:71], v[132:135]
    s_add_u32 m0, s44, 73728
    s_nop 0
    buffer_load_dwordx4 v11, s[36:39], s47 offen lds
    v_mfma_f32_16x16x32_bf16 v[136:139], v[84:87], v[56:59], v[136:139]
    v_mfma_f32_16x16x32_bf16 v[140:143], v[84:87], v[60:63], v[140:143]
    s_add_u32 m0, s44, 74752
    s_nop 0
    buffer_load_dwordx4 v12, s[36:39], s47 offen lds
    s_add_u32 s47, s47, s48
    v_mfma_f32_16x16x32_bf16 v[144:147], v[84:87], v[64:67], v[144:147]
    v_mfma_f32_16x16x32_bf16 v[148:151], v[84:87], v[68:71], v[148:151]
    s_waitcnt lgkmcnt(0)
    v_mfma_f32_16x16x32_bf16 v[88:91], v[40:43], v[24:27], v[88:91]
    s_waitcnt vmcnt(4)
    s_barrier
    ds_read_b64_tr_b16 v[72:73], v15 offset:24576
    ds_read_b64_tr_b16 v[74:75], v15 offset:26112
    v_mfma_f32_16x16x32_bf16 v[92:95], v[40:43], v[28:31], v[92:95]
    ds_read_b128 v[56:59], v14 offset:32768
    v_mfma_f32_16x16x32_bf16 v[96:99], v[40:43], v[32:35], v[96:99]
    ds_read_b64_tr_b16 v[76:77], v16 offset:24576
    v_mfma_f32_16x16x32_bf16 v[100:103], v[40:43], v[36:39], v[100:103]
    ds_read_b64_tr_b16 v[78:79], v16 offset:26112
    v_mfma_f32_16x16x32_bf16 v[104:107], v[44:47], v[24:27], v[104:107]
    ds_read_b128 v[60:63], v14 offset:34816
    v_mfma_f32_16x16x32_bf16 v[108:111], v[44:47], v[28:31], v[108:111]
    ds_read_b64_tr_b16 v[80:81], v17 offset:24576
    v_mfma_f32_16x16x32_bf16 v[112:115], v[44:47], v[32:35], v[112:115]
    ds_read_b64_tr_b16 v[82:83], v17 offset:26112
    v_mfma_f32_16x16x32_bf16 v[116:119], v[44:47], v[36:39], v[116:119]
    ds_read_b128 v[64:67], v14 offset:36864
    v_mfma_f32_16x16x32_bf16 v[120:123], v[48:51], v[24:27], v[120:123]
    ds_read_b64_tr_b16 v[84:85], v18 offset:24576
    v_mfma_f32_16x16x32_bf16 v[124:127], v[48:51], v[28:31], v[124:127]
    ds_read_b64_tr_b16 v[86:87], v18 offset:26112
    v_mfma_f32_16x16x32_bf16 v[128:131], v[48:51], v[32:35], v[128:131]
    ds_read_b128 v[68:71], v14 offset:38912
    v_mfma_f32_16x16x32_bf16 v[132:135], v[48:51], v[36:39], v[132:135]
    v_mfma_f32_16x16x32_bf16 v[136:139], v[52:55], v[24:27], v[136:139]
    v_mfma_f32_16x16x32_bf16 v[140:143], v[52:55], v[28:31], v[140:143]
    v_mfma_f32_16x16x32_bf16 v[144:147], v[52:55], v[32:35], v[144:147]
    v_mfma_f32_16x16x32_bf16 v[148:151], v[52:55], v[36:39], v[148:151]
    s_waitcnt lgkmcnt(0)
    v_mfma_f32_16x16x32_bf16 v[88:91], v[72:75], v[56:59], v[88:91]
    s_waitcnt vmcnt(2)
    s_barrier
    ds_read_b64_tr_b16 v[40:41], v19 offset:0
    ds_read_b64_tr_b16 v[42:43], v19 offset:1536
    v_mfma_f32_16x16x32_bf16 v[92:95], v[72:75], v[60:63], v[92:95]
    ds_read_b128 v[24:27], v13 offset:0
    v_mfma_f32_16x16x32_bf16 v[96:99], v[72:75], v[64:67], v[96:99]
    ds_read_b64_tr_b16 v[44:45], v20 offset:0
    v_mfma_f32_16x16x32_bf16 v[100:103], v[72:75], v[68:71], v[100:103]
    ds_read_b64_tr_b16 v[46:47], v20 offset:1536
    v_mfma_f32_16x16x32_bf16 v[104:107], v[76:79], v[56:59], v[104:107]
    ds_read_b128 v[28:31], v13 offset:2048
    v_mfma_f32_16x16x32_bf16 v[108:111], v[76:79], v[60:63], v[108:111]
    ds_read_b64_tr_b16 v[48:49], v21 offset:0
    v_mfma_f32_16x16x32_bf16 v[112:115], v[76:79], v[64:67], v[112:115]
    ds_read_b64_tr_b16 v[50:51], v21 offset:1536
    v_mfma_f32_16x16x32_bf16 v[116:119], v[76:79], v[68:71], v[116:119]
    ds_read_b128 v[32:35], v13 offset:4096
    v_mfma_f32_16x16x32_bf16 v[120:123], v[80:83], v[56:59], v[120:123]
    ds_read_b64_tr_b16 v[52:53], v22 offset:0
    v_mfma_f32_16x16x32_bf16 v[124:127], v[80:83], v[60:63], v[124:127]
    ds_read_b64_tr_b16 v[54:55], v22 offset:1536
    v_mfma_f32_16x16x32_bf16 v[128:131], v[80:83], v[64:67], v[128:131]
    ds_read_b128 v[36:39], v13 offset:6144
    v_mfma_f32_16x16x32_bf16 v[132:135], v[80:83], v[68:71], v[132:135]
    v_mfma_f32_16x16x32_bf16 v[136:139], v[84:87], v[56:59], v[136:139]
    v_mfma_f32_16x16x32_bf16 v[140:143], v[84:87], v[60:63], v[140:143]
    v_mfma_f32_16x16x32_bf16 v[144:147], v[84:87], v[64:67], v[144:147]
    v_mfma_f32_16x16x32_bf16 v[148:151], v[84:87], v[68:71], v[148:151]
    s_waitcnt lgkmcnt(0)
    v_mfma_f32_16x16x32_bf16 v[88:91], v[40:43], v[24:27], v[88:91]
    s_waitcnt vmcnt(0)
    s_barrier
    ds_read_b64_tr_b16 v[72:73], v19 offset:24576
    ds_read_b64_tr_b16 v[74:75], v19 offset:26112
    v_mfma_f32_16x16x32_bf16 v[92:95], v[40:43], v[28:31], v[92:95]
    ds_read_b128 v[56:59], v14 offset:0
    v_mfma_f32_16x16x32_bf16 v[96:99], v[40:43], v[32:35], v[96:99]
    ds_read_b64_tr_b16 v[76:77], v20 offset:24576
    v_mfma_f32_16x16x32_bf16 v[100:103], v[40:43], v[36:39], v[100:103]
    ds_read_b64_tr_b16 v[78:79], v20 offset:26112
    v_mfma_f32_16x16x32_bf16 v[104:107], v[44:47], v[24:27], v[104:107]
    ds_read_b128 v[60:63], v14 offset:2048
    v_mfma_f32_16x16x32_bf16 v[108:111], v[44:47], v[28:31], v[108:111]
    ds_read_b64_tr_b16 v[80:81], v21 offset:24576
    v_mfma_f32_16x16x32_bf16 v[112:115], v[44:47], v[32:35], v[112:115]
    ds_read_b64_tr_b16 v[82:83], v21 offset:26112
    v_mfma_f32_16x16x32_bf16 v[116:119], v[44:47], v[36:39], v[116:119]
    ds_read_b128 v[64:67], v14 offset:4096
    v_mfma_f32_16x16x32_bf16 v[120:123], v[48:51], v[24:27], v[120:123]
    ds_read_b64_tr_b16 v[84:85], v22 offset:24576
    v_mfma_f32_16x16x32_bf16 v[124:127], v[48:51], v[28:31], v[124:127]
    ds_read_b64_tr_b16 v[86:87], v22 offset:26112
    v_mfma_f32_16x16x32_bf16 v[128:131], v[48:51], v[32:35], v[128:131]
    ds_read_b128 v[68:71], v14 offset:6144
    v_mfma_f32_16x16x32_bf16 v[132:135], v[48:51], v[36:39], v[132:135]
    v_mfma_f32_16x16x32_bf16 v[136:139], v[52:55], v[24:27], v[136:139]
    v_mfma_f32_16x16x32_bf16 v[140:143], v[52:55], v[28:31], v[140:143]
    v_mfma_f32_16x16x32_bf16 v[144:147], v[52:55], v[32:35], v[144:147]
    v_mfma_f32_16x16x32_bf16 v[148:151], v[52:55], v[36:39], v[148:151]
    s_waitcnt lgkmcnt(0)
    v_mfma_f32_16x16x32_bf16 v[88:91], v[72:75], v[56:59], v[88:91]
    v_mfma_f32_16x16x32_bf16 v[92:95], v[72:75], v[60:63], v[92:95]
    v_mfma_f32_16x16x32_bf16 v[96:99], v[72:75], v[64:67], v[96:99]
    v_mfma_f32_16x16x32_bf16 v[100:103], v[72:75], v[68:71], v[100:103]
    v_mfma_f32_16x16x32_bf16 v[104:107], v[76:79], v[56:59], v[104:107]
    v_mfma_f32_16x16x32_bf16 v[108:111], v[76:79], v[60:63], v[108:111]
    v_mfma_f32_16x16x32_bf16 v[112:115], v[76:79], v[64:67], v[112:115]
    v_mfma_f32_16x16x32_bf16 v[116:119], v[76:79], v[68:71], v[116:119]
    v_mfma_f32_16x16x32_bf16 v[120:123], v[80:83], v[56:59], v[120:123]
    v_mfma_f32_16x16x32_bf16 v[124:127], v[80:83], v[60:63], v[124:127]
    v_mfma_f32_16x16x32_bf16 v[128:131], v[80:83], v[64:67], v[128:131]
    v_mfma_f32_16x16x32_bf16 v[132:135], v[80:83], v[68:71], v[132:135]
    v_mfma_f32_16x16x32_bf16 v[136:139], v[84:87], v[56:59], v[136:139]
    v_mfma_f32_16x16x32_bf16 v[140:143], v[84:87], v[60:63], v[140:143]
    v_mfma_f32_16x16x32_bf16 v[144:147], v[84:87], v[64:67], v[144:147]
    v_mfma_f32_16x16x32_bf16 v[148:151], v[84:87], v[68:71], v[148:151]
    s_branch k1_kernel_EPI_GLU
k1_kernel_EPI_GLU:
    s_lshl_b32 s26, s21, 2
    s_lshl_b32 s27, s23, 1
    s_add_u32 s26, s26, s27
    s_mul_i32 s49, s26, 108
    s_sub_u32 s27, s20, 6
    s_mul_i32 s27, s27, 12
    s_add_u32 s49, s49, s27
    s_lshl_b32 s27, s24, 1
    s_add_u32 s49, s49, s27
    s_lshl_b32 s49, s49, 10
    s_add_u32 s49, s49, 7864320
    v_and_b32 v3, 15, v1
    v_lshrrev_b32 v4, 4, v1
    v_and_b32 v5, 1, v4
    v_lshlrev_b32 v5, 9, v5
    v_lshl_add_u32 v5, v3, 4, v5
    v_lshrrev_b32 v4, 1, v4
    v_lshl_add_u32 v2, v4, 3, v5
    s_mov_b32 s27, 0xbfb8aa3b
    s_add_u32 s28, s49, 110592
    v_mul_f32 v88, s27, v88
    v_mul_f32 v89, s27, v89
    v_mul_f32 v90, s27, v90
    v_mul_f32 v91, s27, v91
    v_mul_f32 v104, s27, v104
    v_mul_f32 v105, s27, v105
    v_mul_f32 v106, s27, v106
    v_mul_f32 v107, s27, v107
    v_exp_f32 v88, v88
    v_exp_f32 v89, v89
    v_exp_f32 v90, v90
    v_exp_f32 v91, v91
    v_exp_f32 v104, v104
    v_exp_f32 v105, v105
    v_exp_f32 v106, v106
    v_exp_f32 v107, v107
    v_add_f32 v88, 1.0, v88
    v_add_f32 v89, 1.0, v89
    v_add_f32 v90, 1.0, v90
    v_add_f32 v91, 1.0, v91
    v_add_f32 v104, 1.0, v104
    v_add_f32 v105, 1.0, v105
    v_add_f32 v106, 1.0, v106
    v_add_f32 v107, 1.0, v107
    v_rcp_f32 v88, v88
    v_rcp_f32 v89, v89
    v_rcp_f32 v90, v90
    v_rcp_f32 v91, v91
    v_rcp_f32 v104, v104
    v_rcp_f32 v105, v105
    v_rcp_f32 v106, v106
    v_rcp_f32 v107, v107
    v_mul_f32 v88, v88, v120
    v_mul_f32 v89, v89, v121
    v_mul_f32 v90, v90, v122
    v_mul_f32 v91, v91, v123
    v_mul_f32 v104, v104, v136
    v_mul_f32 v105, v105, v137
    v_mul_f32 v106, v106, v138
    v_mul_f32 v107, v107, v139
    v_cvt_pk_bf16_f32 v24, v88, v89
    v_cvt_pk_bf16_f32 v25, v90, v91
    v_cvt_pk_bf16_f32 v26, v104, v105
    v_cvt_pk_bf16_f32 v27, v106, v107
    buffer_store_dwordx2 v[24:25], v2, s[40:43], s49 offen offset:0 sc1
    buffer_store_dwordx2 v[26:27], v2, s[40:43], s49 offen offset:1024 sc1
    v_mul_f32 v92, s27, v92
    v_mul_f32 v93, s27, v93
    v_mul_f32 v94, s27, v94
    v_mul_f32 v95, s27, v95
    v_mul_f32 v108, s27, v108
    v_mul_f32 v109, s27, v109
    v_mul_f32 v110, s27, v110
    v_mul_f32 v111, s27, v111
    v_exp_f32 v92, v92
    v_exp_f32 v93, v93
    v_exp_f32 v94, v94
    v_exp_f32 v95, v95
    v_exp_f32 v108, v108
    v_exp_f32 v109, v109
    v_exp_f32 v110, v110
    v_exp_f32 v111, v111
    v_add_f32 v92, 1.0, v92
    v_add_f32 v93, 1.0, v93
    v_add_f32 v94, 1.0, v94
    v_add_f32 v95, 1.0, v95
    v_add_f32 v108, 1.0, v108
    v_add_f32 v109, 1.0, v109
    v_add_f32 v110, 1.0, v110
    v_add_f32 v111, 1.0, v111
    v_rcp_f32 v92, v92
    v_rcp_f32 v93, v93
    v_rcp_f32 v94, v94
    v_rcp_f32 v95, v95
    v_rcp_f32 v108, v108
    v_rcp_f32 v109, v109
    v_rcp_f32 v110, v110
    v_rcp_f32 v111, v111
    v_mul_f32 v92, v92, v124
    v_mul_f32 v93, v93, v125
    v_mul_f32 v94, v94, v126
    v_mul_f32 v95, v95, v127
    v_mul_f32 v108, v108, v140
    v_mul_f32 v109, v109, v141
    v_mul_f32 v110, v110, v142
    v_mul_f32 v111, v111, v143
    v_cvt_pk_bf16_f32 v28, v92, v93
    v_cvt_pk_bf16_f32 v29, v94, v95
    v_cvt_pk_bf16_f32 v30, v108, v109
    v_cvt_pk_bf16_f32 v31, v110, v111
    buffer_store_dwordx2 v[28:29], v2, s[40:43], s49 offen offset:256 sc1
    buffer_store_dwordx2 v[30:31], v2, s[40:43], s49 offen offset:1280 sc1
    v_mul_f32 v96, s27, v96
    v_mul_f32 v97, s27, v97
    v_mul_f32 v98, s27, v98
    v_mul_f32 v99, s27, v99
    v_mul_f32 v112, s27, v112
    v_mul_f32 v113, s27, v113
    v_mul_f32 v114, s27, v114
    v_mul_f32 v115, s27, v115
    v_exp_f32 v96, v96
    v_exp_f32 v97, v97
    v_exp_f32 v98, v98
    v_exp_f32 v99, v99
    v_exp_f32 v112, v112
    v_exp_f32 v113, v113
    v_exp_f32 v114, v114
    v_exp_f32 v115, v115
    v_add_f32 v96, 1.0, v96
    v_add_f32 v97, 1.0, v97
    v_add_f32 v98, 1.0, v98
    v_add_f32 v99, 1.0, v99
    v_add_f32 v112, 1.0, v112
    v_add_f32 v113, 1.0, v113
    v_add_f32 v114, 1.0, v114
    v_add_f32 v115, 1.0, v115
    v_rcp_f32 v96, v96
    v_rcp_f32 v97, v97
    v_rcp_f32 v98, v98
    v_rcp_f32 v99, v99
    v_rcp_f32 v112, v112
    v_rcp_f32 v113, v113
    v_rcp_f32 v114, v114
    v_rcp_f32 v115, v115
    v_mul_f32 v96, v96, v128
    v_mul_f32 v97, v97, v129
    v_mul_f32 v98, v98, v130
    v_mul_f32 v99, v99, v131
    v_mul_f32 v112, v112, v144
    v_mul_f32 v113, v113, v145
    v_mul_f32 v114, v114, v146
    v_mul_f32 v115, v115, v147
    v_cvt_pk_bf16_f32 v32, v96, v97
    v_cvt_pk_bf16_f32 v33, v98, v99
    v_cvt_pk_bf16_f32 v34, v112, v113
    v_cvt_pk_bf16_f32 v35, v114, v115
    buffer_store_dwordx2 v[32:33], v2, s[40:43], s28 offen offset:0 sc1
    buffer_store_dwordx2 v[34:35], v2, s[40:43], s28 offen offset:1024 sc1
    v_mul_f32 v100, s27, v100
    v_mul_f32 v101, s27, v101
    v_mul_f32 v102, s27, v102
    v_mul_f32 v103, s27, v103
    v_mul_f32 v116, s27, v116
    v_mul_f32 v117, s27, v117
    v_mul_f32 v118, s27, v118
    v_mul_f32 v119, s27, v119
    v_exp_f32 v100, v100
    v_exp_f32 v101, v101
    v_exp_f32 v102, v102
    v_exp_f32 v103, v103
    v_exp_f32 v116, v116
    v_exp_f32 v117, v117
    v_exp_f32 v118, v118
    v_exp_f32 v119, v119
    v_add_f32 v100, 1.0, v100
    v_add_f32 v101, 1.0, v101
    v_add_f32 v102, 1.0, v102
    v_add_f32 v103, 1.0, v103
    v_add_f32 v116, 1.0, v116
    v_add_f32 v117, 1.0, v117
    v_add_f32 v118, 1.0, v118
    v_add_f32 v119, 1.0, v119
    v_rcp_f32 v100, v100
    v_rcp_f32 v101, v101
    v_rcp_f32 v102, v102
    v_rcp_f32 v103, v103
    v_rcp_f32 v116, v116
    v_rcp_f32 v117, v117
    v_rcp_f32 v118, v118
    v_rcp_f32 v119, v119
    v_mul_f32 v100, v100, v132
    v_mul_f32 v101, v101, v133
    v_mul_f32 v102, v102, v134
    v_mul_f32 v103, v103, v135
    v_mul_f32 v116, v116, v148
    v_mul_f32 v117, v117, v149
    v_mul_f32 v118, v118, v150
    v_mul_f32 v119, v119, v151
    v_cvt_pk_bf16_f32 v36, v100, v101
    v_cvt_pk_bf16_f32 v37, v102, v103
    v_cvt_pk_bf16_f32 v38, v116, v117
    v_cvt_pk_bf16_f32 v39, v118, v119
    buffer_store_dwordx2 v[36:37], v2, s[40:43], s28 offen offset:256 sc1
    buffer_store_dwordx2 v[38:39], v2, s[40:43], s28 offen offset:1280 sc1
    s_branch k1_kernel_FIN
k1_kernel_EPI_QK:
    s_barrier
    s_cmp_lt_u32 s20, 2
    s_cbranch_scc0 k1_kernel_NOSCL
    v_mul_f32 v88, s52, v88
    v_mul_f32 v89, s52, v89
    v_mul_f32 v90, s52, v90
    v_mul_f32 v91, s52, v91
    v_mul_f32 v92, s52, v92
    v_mul_f32 v93, s52, v93
    v_mul_f32 v94, s52, v94
    v_mul_f32 v95, s52, v95
    v_mul_f32 v96, s52, v96
    v_mul_f32 v97, s52, v97
    v_mul_f32 v98, s52, v98
    v_mul_f32 v99, s52, v99
    v_mul_f32 v100, s52, v100
    v_mul_f32 v101, s52, v101
    v_mul_f32 v102, s52, v102
    v_mul_f32 v103, s52, v103
    v_mul_f32 v104, s52, v104
    v_mul_f32 v105, s52, v105
    v_mul_f32 v106, s52, v106
    v_mul_f32 v107, s52, v107
    v_mul_f32 v108, s52, v108
    v_mul_f32 v109, s52, v109
    v_mul_f32 v110, s52, v110
    v_mul_f32 v111, s52, v111
    v_mul_f32 v112, s52, v112
    v_mul_f32 v113, s52, v113
    v_mul_f32 v114, s52, v114
    v_mul_f32 v115, s52, v115
    v_mul_f32 v116, s52, v116
    v_mul_f32 v117, s52, v117
    v_mul_f32 v118, s52, v118
    v_mul_f32 v119, s52, v119
    v_mul_f32 v120, s52, v120
    v_mul_f32 v121, s52, v121
    v_mul_f32 v122, s52, v122
    v_mul_f32 v123, s52, v123
    v_mul_f32 v124, s52, v124
    v_mul_f32 v125, s52, v125
    v_mul_f32 v126, s52, v126
    v_mul_f32 v127, s52, v127
    v_mul_f32 v128, s52, v128
    v_mul_f32 v129, s52, v129
    v_mul_f32 v130, s52, v130
    v_mul_f32 v131, s52, v131
    v_mul_f32 v132, s52, v132
    v_mul_f32 v133, s52, v133
    v_mul_f32 v134, s52, v134
    v_mul_f32 v135, s52, v135
    v_mul_f32 v136, s52, v136
    v_mul_f32 v137, s52, v137
    v_mul_f32 v138, s52, v138
    v_mul_f32 v139, s52, v139
    v_mul_f32 v140, s52, v140
    v_mul_f32 v141, s52, v141
    v_mul_f32 v142, s52, v142
    v_mul_f32 v143, s52, v143
    v_mul_f32 v144, s52, v144
    v_mul_f32 v145, s52, v145
    v_mul_f32 v146, s52, v146
    v_mul_f32 v147, s52, v147
    v_mul_f32 v148, s52, v148
    v_mul_f32 v149, s52, v149
    v_mul_f32 v150, s52, v150
    v_mul_f32 v151, s52, v151
k1_kernel_NOSCL:
    v_cvt_pk_bf16_f32 v32, v88, v89
    v_cvt_pk_bf16_f32 v33, v90, v91
    ds_write_b64 v155, v[32:33] offset:0
    v_cvt_pk_bf16_f32 v34, v92, v93
    v_cvt_pk_bf16_f32 v35, v94, v95
    ds_write_b64 v159, v[34:35] offset:0
    v_cvt_pk_bf16_f32 v36, v96, v97
    v_cvt_pk_bf16_f32 v37, v98, v99
    ds_write_b64 v155, v[36:37] offset:1280
    v_cvt_pk_bf16_f32 v38, v100, v101
    v_cvt_pk_bf16_f32 v39, v102, v103
    ds_write_b64 v159, v[38:39] offset:1280
    s_waitcnt lgkmcnt(4)
    v_cvt_pk_bf16_f32 v40, v104, v105
    v_cvt_pk_bf16_f32 v41, v106, v107
    ds_write_b64 v156, v[40:41] offset:0
    v_cvt_pk_bf16_f32 v42, v108, v109
    v_cvt_pk_bf16_f32 v43, v110, v111
    ds_write_b64 v160, v[42:43] offset:0
    v_cvt_pk_bf16_f32 v44, v112, v113
    v_cvt_pk_bf16_f32 v45, v114, v115
    ds_write_b64 v156, v[44:45] offset:1280
    v_cvt_pk_bf16_f32 v46, v116, v117
    v_cvt_pk_bf16_f32 v47, v118, v119
    ds_write_b64 v160, v[46:47] offset:1280
    s_waitcnt lgkmcnt(4)
    v_cvt_pk_bf16_f32 v32, v120, v121
    v_cvt_pk_bf16_f32 v33, v122, v123
    ds_write_b64 v157, v[32:33] offset:0
    v_cvt_pk_bf16_f32 v34, v124, v125
    v_cvt_pk_bf16_f32 v35, v126, v127
    ds_write_b64 v161, v[34:35] offset:0
    v_cvt_pk_bf16_f32 v36, v128, v129
    v_cvt_pk_bf16_f32 v37, v130, v131
    ds_write_b64 v157, v[36:37] offset:1280
    v_cvt_pk_bf16_f32 v38, v132, v133
    v_cvt_pk_bf16_f32 v39, v134, v135
    ds_write_b64 v161, v[38:39] offset:1280
    s_waitcnt lgkmcnt(4)
    v_cvt_pk_bf16_f32 v40, v136, v137
    v_cvt_pk_bf16_f32 v41, v138, v139
    ds_write_b64 v158, v[40:41] offset:0
    v_cvt_pk_bf16_f32 v42, v140, v141
    v_cvt_pk_bf16_f32 v43, v142, v143
    ds_write_b64 v162, v[42:43] offset:0
    v_cvt_pk_bf16_f32 v44, v144, v145
    v_cvt_pk_bf16_f32 v45, v146, v147
    ds_write_b64 v158, v[44:45] offset:1280
    v_cvt_pk_bf16_f32 v46, v148, v149
    v_cvt_pk_bf16_f32 v47, v150, v151
    ds_write_b64 v162, v[46:47] offset:1280
    s_waitcnt lgkmcnt(4)
    s_branch k1_kernel_COPY
k1_kernel_EPI_V:
    s_barrier
    v_cvt_pk_bf16_f32 v32, v88, v89
    v_cvt_pk_bf16_f32 v33, v90, v91
    ds_write_b64 v155, v[32:33] offset:0
    v_cvt_pk_bf16_f32 v34, v92, v93
    v_cvt_pk_bf16_f32 v35, v94, v95
    ds_write_b64 v155, v[34:35] offset:640
    v_cvt_pk_bf16_f32 v36, v96, v97
    v_cvt_pk_bf16_f32 v37, v98, v99
    ds_write_b64 v155, v[36:37] offset:1280
    v_cvt_pk_bf16_f32 v38, v100, v101
    v_cvt_pk_bf16_f32 v39, v102, v103
    ds_write_b64 v155, v[38:39] offset:1920
    s_waitcnt lgkmcnt(4)
    v_cvt_pk_bf16_f32 v40, v104, v105
    v_cvt_pk_bf16_f32 v41, v106, v107
    ds_write_b64 v156, v[40:41] offset:0
    v_cvt_pk_bf16_f32 v42, v108, v109
    v_cvt_pk_bf16_f32 v43, v110, v111
    ds_write_b64 v156, v[42:43] offset:640
    v_cvt_pk_bf16_f32 v44, v112, v113
    v_cvt_pk_bf16_f32 v45, v114, v115
    ds_write_b64 v156, v[44:45] offset:1280
    v_cvt_pk_bf16_f32 v46, v116, v117
    v_cvt_pk_bf16_f32 v47, v118, v119
    ds_write_b64 v156, v[46:47] offset:1920
    s_waitcnt lgkmcnt(4)
    v_cvt_pk_bf16_f32 v32, v120, v121
    v_cvt_pk_bf16_f32 v33, v122, v123
    ds_write_b64 v157, v[32:33] offset:0
    v_cvt_pk_bf16_f32 v34, v124, v125
    v_cvt_pk_bf16_f32 v35, v126, v127
    ds_write_b64 v157, v[34:35] offset:640
    v_cvt_pk_bf16_f32 v36, v128, v129
    v_cvt_pk_bf16_f32 v37, v130, v131
    ds_write_b64 v157, v[36:37] offset:1280
    v_cvt_pk_bf16_f32 v38, v132, v133
    v_cvt_pk_bf16_f32 v39, v134, v135
    ds_write_b64 v157, v[38:39] offset:1920
    s_waitcnt lgkmcnt(4)
    v_cvt_pk_bf16_f32 v40, v136, v137
    v_cvt_pk_bf16_f32 v41, v138, v139
    ds_write_b64 v158, v[40:41] offset:0
    v_cvt_pk_bf16_f32 v42, v140, v141
    v_cvt_pk_bf16_f32 v43, v142, v143
    ds_write_b64 v158, v[42:43] offset:640
    v_cvt_pk_bf16_f32 v44, v144, v145
    v_cvt_pk_bf16_f32 v45, v146, v147
    ds_write_b64 v158, v[44:45] offset:1280
    v_cvt_pk_bf16_f32 v46, v148, v149
    v_cvt_pk_bf16_f32 v47, v150, v151
    ds_write_b64 v158, v[46:47] offset:1920
    s_waitcnt lgkmcnt(4)
    s_branch k1_kernel_COPY
k1_kernel_EPI_QKH:
    s_barrier
    s_cmp_lt_u32 s20, 2
    s_cbranch_scc0 k1_kernel_NOSCLH
    s_nop 3
    v_mul_f32 v88, s52, v88
    v_mul_f32 v89, s52, v89
    v_mul_f32 v90, s52, v90
    v_mul_f32 v91, s52, v91
    v_mul_f32 v92, s52, v92
    v_mul_f32 v93, s52, v93
    v_mul_f32 v94, s52, v94
    v_mul_f32 v95, s52, v95
    v_mul_f32 v104, s52, v104
    v_mul_f32 v105, s52, v105
    v_mul_f32 v106, s52, v106
    v_mul_f32 v107, s52, v107
    v_mul_f32 v108, s52, v108
    v_mul_f32 v109, s52, v109
    v_mul_f32 v110, s52, v110
    v_mul_f32 v111, s52, v111
    v_mul_f32 v120, s52, v120
    v_mul_f32 v121, s52, v121
    v_mul_f32 v122, s52, v122
    v_mul_f32 v123, s52, v123
    v_mul_f32 v124, s52, v124
    v_mul_f32 v125, s52, v125
    v_mul_f32 v126, s52, v126
    v_mul_f32 v127, s52, v127
    v_mul_f32 v136, s52, v136
    v_mul_f32 v137, s52, v137
    v_mul_f32 v138, s52, v138
    v_mul_f32 v139, s52, v139
    v_mul_f32 v140, s52, v140
    v_mul_f32 v141, s52, v141
    v_mul_f32 v142, s52, v142
    v_mul_f32 v143, s52, v143
k1_kernel_NOSCLH:
    s_nop 3
    v_cvt_pk_bf16_f32 v32, v88, v89
    v_cvt_pk_bf16_f32 v33, v90, v91
    ds_write_b64 v155, v[32:33] offset:0
    v_cvt_pk_bf16_f32 v34, v92, v93
    v_cvt_pk_bf16_f32 v35, v94, v95
    ds_write_b64 v159, v[34:35] offset:0
    s_waitcnt lgkmcnt(4)
    v_cvt_pk_bf16_f32 v40, v104, v105
    v_cvt_pk_bf16_f32 v41, v106, v107
    ds_write_b64 v156, v[40:41] offset:0
    v_cvt_pk_bf16_f32 v42, v108, v109
    v_cvt_pk_bf16_f32 v43, v110, v111
    ds_write_b64 v160, v[42:43] offset:0
    s_waitcnt lgkmcnt(4)
    v_cvt_pk_bf16_f32 v32, v120, v121
    v_cvt_pk_bf16_f32 v33, v122, v123
    ds_write_b64 v157, v[32:33] offset:0
    v_cvt_pk_bf16_f32 v34, v124, v125
    v_cvt_pk_bf16_f32 v35, v126, v127
    ds_write_b64 v161, v[34:35] offset:0
    s_waitcnt lgkmcnt(4)
    v_cvt_pk_bf16_f32 v40, v136, v137
    v_cvt_pk_bf16_f32 v41, v138, v139
    ds_write_b64 v158, v[40:41] offset:0
    v_cvt_pk_bf16_f32 v42, v140, v141
    v_cvt_pk_bf16_f32 v43, v142, v143
    ds_write_b64 v162, v[42:43] offset:0
    s_waitcnt lgkmcnt(4)
    s_branch k1_kernel_COPY
k1_kernel_EPI_VH:
    s_barrier
    s_nop 5
    v_cvt_pk_bf16_f32 v32, v88, v89
    v_cvt_pk_bf16_f32 v33, v90, v91
    ds_write_b64 v155, v[32:33] offset:0
    v_cvt_pk_bf16_f32 v34, v92, v93
    v_cvt_pk_bf16_f32 v35, v94, v95
    ds_write_b64 v155, v[34:35] offset:640
    s_waitcnt lgkmcnt(4)
    v_cvt_pk_bf16_f32 v40, v104, v105
    v_cvt_pk_bf16_f32 v41, v106, v107
    ds_write_b64 v156, v[40:41] offset:0
    v_cvt_pk_bf16_f32 v42, v108, v109
    v_cvt_pk_bf16_f32 v43, v110, v111
    ds_write_b64 v156, v[42:43] offset:640
    s_waitcnt lgkmcnt(4)
    v_cvt_pk_bf16_f32 v32, v120, v121
    v_cvt_pk_bf16_f32 v33, v122, v123
    ds_write_b64 v157, v[32:33] offset:0
    v_cvt_pk_bf16_f32 v34, v124, v125
    v_cvt_pk_bf16_f32 v35, v126, v127
    ds_write_b64 v157, v[34:35] offset:640
    s_waitcnt lgkmcnt(4)
    v_cvt_pk_bf16_f32 v40, v136, v137
    v_cvt_pk_bf16_f32 v41, v138, v139
    ds_write_b64 v158, v[40:41] offset:0
    v_cvt_pk_bf16_f32 v42, v140, v141
    v_cvt_pk_bf16_f32 v43, v142, v143
    ds_write_b64 v158, v[42:43] offset:640
    s_waitcnt lgkmcnt(4)
    s_branch k1_kernel_COPY
k1_kernel_COPY:
    s_lshl_b32 s26, s21, 2
    s_mul_i32 s26, s26, s51
    s_add_u32 s49, s49, s26
    s_and_b32 s26, s20, 1
    s_lshl_b32 s26, s26, 4
    s_add_u32 s26, s26, s22
    s_mul_i32 s26, s26, s50
    s_add_u32 s49, s49, s26
    s_mul_i32 s27, s22, 5120
    v_lshl_add_u32 v2, v1, 4, s27
    s_waitcnt lgkmcnt(0)
    s_barrier
k1_kernel_CPL:
    ds_read_b128 v[88:91], v2 offset:0
    ds_read_b128 v[92:95], v2 offset:1024
    ds_read_b128 v[96:99], v2 offset:2048
    ds_read_b128 v[100:103], v2 offset:3072
    ds_read_b128 v[104:107], v2 offset:4096
    s_waitcnt lgkmcnt(4)
    buffer_store_dwordx4 v[88:91], v163, s[40:43], s49 offen sc1
    s_waitcnt lgkmcnt(3)
    buffer_store_dwordx4 v[92:95], v164, s[40:43], s49 offen sc1
    s_waitcnt lgkmcnt(2)
    buffer_store_dwordx4 v[96:99], v165, s[40:43], s49 offen sc1
    s_waitcnt lgkmcnt(1)
    buffer_store_dwordx4 v[100:103], v166, s[40:43], s49 offen sc1
    s_waitcnt lgkmcnt(0)
    buffer_store_dwordx4 v[104:107], v167, s[40:43], s49 offen sc1
    s_add_u32 s22, s22, 12
    s_cmp_lt_u32 s22, 16
    s_cbranch_scc0 k1_kernel_CPD
    s_mul_i32 s26, s50, 12
    s_add_u32 s49, s49, s26
    v_add_u32 v2, 61440, v2
    s_branch k1_kernel_CPL
k1_kernel_CPD:
    s_sub_u32 s22, s22, 12
    s_cmp_ge_u32 s22, 12
    s_cselect_b32 s26, 12, 0
    s_sub_u32 s22, s22, s26
    s_branch k1_kernel_FIN
k1_kernel_GATE:
    s_cmp_ge_u32 s22, 8
    s_cbranch_scc0 k1_kernel_GATE2
    s_waitcnt lgkmcnt(0)
    s_lshl_b32 s26, s21, 2
    s_add_u32 s26, s26, s22
    s_sub_u32 s26, s26, 8
    s_mov_b32 s56, s54
    s_and_b32 s57, s55, 0xffff
    s_mov_b32 s58, 2211840
    s_mov_b32 s59, 0x20000
    s_mul_i32 s27, s26, 34560
    v_min_u32 v3, 53, v1
    v_lshlrev_b32 v3, 7, v3
    buffer_load_dword v152, v3, s[56:59], s27 offen
    s_add_u32 s27, s27, 6912
    buffer_load_dword v152, v3, s[56:59], s27 offen
    s_add_u32 s27, s27, 6912
    buffer_load_dword v152, v3, s[56:59], s27 offen
    s_add_u32 s27, s27, 6912
    buffer_load_dword v152, v3, s[56:59], s27 offen
    s_add_u32 s27, s27, 6912
    buffer_load_dword v152, v3, s[56:59], s27 offen
    s_add_u32 s27, s27, 6912
    s_mov_b32 s56, s8
    s_and_b32 s57, s9, 0xffff
    s_mov_b32 s58, 819200
    s_mov_b32 s59, 0x20000
    s_mul_i32 s27, s26, 12800
    v_min_u32 v3, 49, v1
    v_lshlrev_b32 v3, 7, v3
    buffer_load_dword v152, v3, s[56:59], s27 offen
    s_add_u32 s27, s27, 6400
    buffer_load_dword v152, v3, s[56:59], s27 offen
    s_add_u32 s27, s27, 6400
    s_endpgm
k1_kernel_GATE2:
    s_waitcnt lgkmcnt(0)
    s_mov_b32 s32, s4
    s_and_b32 s33, s5, 0xffff
    s_mov_b32 s34, 2621440
    s_mov_b32 s35, 0x20000
    s_mov_b32 s36, s10
    s_and_b32 s37, s11, 0xffff
    s_mov_b32 s38, 1280
    s_mov_b32 s39, 0x20000
    s_mov_b32 s40, s16
    s_and_b32 s41, s17, 0xffff
    s_mov_b32 s42, 268435456
    s_mov_b32 s43, 0x20000
    s_or_b32 s26, s21, s22
    s_cmp_eq_u32 s26, 0
    s_cbranch_scc0 k1_kernel_NOZ
    v_lshlrev_b32 v7, 7, v1
    v_mov_b32 v6, 0
    s_mov_b32 s26, 20201472
    s_mov_b64 exec, 0xff
    buffer_store_dword v6, v7, s[40:43], s26 offen
    s_mov_b64 exec, -1
k1_kernel_NOZ:
    v_lshlrev_b32 v7, 2, v1
    s_lshl_b32 s26, s21, 7
    s_lshl_b32 s27, s22, 4
    s_add_u32 s49, s26, s27
    s_mul_i32 s27, s49, 1280
    buffer_load_dword v24, v7, s[36:39], 0 offen offset:0
    buffer_load_dword v25, v7, s[36:39], 0 offen offset:256
    buffer_load_dword v26, v7, s[36:39], 0 offen offset:512
    buffer_load_dword v27, v7, s[36:39], 0 offen offset:768
    buffer_load_dword v28, v7, s[36:39], 0 offen offset:1024
    buffer_load_dword v32, v7, s[32:35], s27 offen offset:0
    buffer_load_dword v33, v7, s[32:35], s27 offen offset:256
    buffer_load_dword v34, v7, s[32:35], s27 offen offset:512
    buffer_load_dword v35, v7, s[32:35], s27 offen offset:768
    buffer_load_dword v36, v7, s[32:35], s27 offen offset:1024
    s_add_u32 s27, s27, 1280
    buffer_load_dword v37, v7, s[32:35], s27 offen offset:0
    buffer_load_dword v38, v7, s[32:35], s27 offen offset:256
    buffer_load_dword v39, v7, s[32:35], s27 offen offset:512
    buffer_load_dword v40, v7, s[32:35], s27 offen offset:768
    buffer_load_dword v41, v7, s[32:35], s27 offen offset:1024
    s_add_u32 s27, s27, 1280
    buffer_load_dword v42, v7, s[32:35], s27 offen offset:0
    buffer_load_dword v43, v7, s[32:35], s27 offen offset:256
    buffer_load_dword v44, v7, s[32:35], s27 offen offset:512
    buffer_load_dword v45, v7, s[32:35], s27 offen offset:768
    buffer_load_dword v46, v7, s[32:35], s27 offen offset:1024
    s_add_u32 s27, s27, 1280
    buffer_load_dword v47, v7, s[32:35], s27 offen offset:0
    buffer_load_dword v48, v7, s[32:35], s27 offen offset:256
    buffer_load_dword v49, v7, s[32:35], s27 offen offset:512
    buffer_load_dword v50, v7, s[32:35], s27 offen offset:768
    buffer_load_dword v51, v7, s[32:35], s27 offen offset:1024
    s_add_u32 s27, s27, 1280
    buffer_load_dword v52, v7, s[32:35], s27 offen offset:0
    buffer_load_dword v53, v7, s[32:35], s27 offen offset:256
    buffer_load_dword v54, v7, s[32:35], s27 offen offset:512
    buffer_load_dword v55, v7, s[32:35], s27 offen offset:768
    buffer_load_dword v56, v7, s[32:35], s27 offen offset:1024
    s_add_u32 s27, s27, 1280
    buffer_load_dword v57, v7, s[32:35], s27 offen offset:0
    buffer_load_dword v58, v7, s[32:35], s27 offen offset:256
    buffer_load_dword v59, v7, s[32:35], s27 offen offset:512
    buffer_load_dword v60, v7, s[32:35], s27 offen offset:768
    buffer_load_dword v61, v7, s[32:35], s27 offen offset:1024
    s_add_u32 s27, s27, 1280
    buffer_load_dword v62, v7, s[32:35], s27 offen offset:0
    buffer_load_dword v63, v7, s[32:35], s27 offen offset:256
    buffer_load_dword v64, v7, s[32:35], s27 offen offset:512
    buffer_load_dword v65, v7, s[32:35], s27 offen offset:768
    buffer_load_dword v66, v7, s[32:35], s27 offen offset:1024
    s_add_u32 s27, s27, 1280
    buffer_load_dword v67, v7, s[32:35], s27 offen offset:0
    buffer_load_dword v68, v7, s[32:35], s27 offen offset:256
    buffer_load_dword v69, v7, s[32:35], s27 offen offset:512
    buffer_load_dword v70, v7, s[32:35], s27 offen offset:768
    buffer_load_dword v71, v7, s[32:35], s27 offen offset:1024
    s_add_u32 s27, s27, 1280
    s_waitcnt vmcnt(35)
    v_lshlrev_b32 v2, 16, v32
    v_and_b32 v3, 0xffff0000, v32
    v_lshlrev_b32 v4, 16, v24
    v_and_b32 v5, 0xffff0000, v24
    v_mul_f32 v2, v2, v4
    v_mul_f32 v3, v3, v5
    v_cvt_pk_bf16_f32 v2, v2, v3
    v_lshlrev_b32 v4, 16, v2
    v_and_b32 v5, 0xffff0000, v2
    v_add_f32 v6, v4, v5
    v_lshlrev_b32 v2, 16, v33
    v_and_b32 v3, 0xffff0000, v33
    v_lshlrev_b32 v4, 16, v25
    v_and_b32 v5, 0xffff0000, v25
    v_mul_f32 v2, v2, v4
    v_mul_f32 v3, v3, v5
    v_cvt_pk_bf16_f32 v2, v2, v3
    v_lshlrev_b32 v4, 16, v2
    v_and_b32 v5, 0xffff0000, v2
    v_add_f32 v4, v4, v5
    v_add_f32 v6, v6, v4
    v_lshlrev_b32 v2, 16, v34
    v_and_b32 v3, 0xffff0000, v34
    v_lshlrev_b32 v4, 16, v26
    v_and_b32 v5, 0xffff0000, v26
    v_mul_f32 v2, v2, v4
    v_mul_f32 v3, v3, v5
    v_cvt_pk_bf16_f32 v2, v2, v3
    v_lshlrev_b32 v4, 16, v2
    v_and_b32 v5, 0xffff0000, v2
    v_add_f32 v4, v4, v5
    v_add_f32 v6, v6, v4
    v_lshlrev_b32 v2, 16, v35
    v_and_b32 v3, 0xffff0000, v35
    v_lshlrev_b32 v4, 16, v27
    v_and_b32 v5, 0xffff0000, v27
    v_mul_f32 v2, v2, v4
    v_mul_f32 v3, v3, v5
    v_cvt_pk_bf16_f32 v2, v2, v3
    v_lshlrev_b32 v4, 16, v2
    v_and_b32 v5, 0xffff0000, v2
    v_add_f32 v4, v4, v5
    v_add_f32 v6, v6, v4
    v_lshlrev_b32 v2, 16, v36
    v_and_b32 v3, 0xffff0000, v36
    v_lshlrev_b32 v4, 16, v28
    v_and_b32 v5, 0xffff0000, v28
    v_mul_f32 v2, v2, v4
    v_mul_f32 v3, v3, v5
    v_cvt_pk_bf16_f32 v2, v2, v3
    v_lshlrev_b32 v4, 16, v2
    v_and_b32 v5, 0xffff0000, v2
    v_add_f32 v4, v4, v5
    v_add_f32 v6, v6, v4
    s_nop 1
    v_add_f32_dpp v6, v6, v6 row_shr:1 row_mask:0xf bank_mask:0xf bound_ctrl:0
    s_nop 1
    v_add_f32_dpp v6, v6, v6 row_shr:2 row_mask:0xf bank_mask:0xf bound_ctrl:0
    s_nop 1
    v_add_f32_dpp v6, v6, v6 row_shr:4 row_mask:0xf bank_mask:0xf bound_ctrl:0
    s_nop 1
    v_add_f32_dpp v6, v6, v6 row_shr:8 row_mask:0xf bank_mask:0xf bound_ctrl:0
    s_nop 1
    v_readlane_b32 s26, v6, 15
    v_readlane_b32 s28, v6, 31
    v_readlane_b32 s29, v6, 47
    v_readlane_b32 s50, v6, 63
    s_nop 1
    v_mov_b32 v2, s26
    v_add_f32 v2, s28, v2
    v_add_f32 v2, s29, v2
    v_add_f32 v2, s50, v2
    v_cvt_pk_bf16_f32 v2, v2, v2
    v_lshlrev_b32 v2, 16, v2
    v_mul_f32 v2, 0xbfb8aa3b, v2
    v_exp_f32 v2, v2
    s_nop 0
    v_add_f32 v2, 1.0, v2
    v_rcp_f32 v2, v2
    s_nop 0
    v_cvt_pk_bf16_f32 v2, v2, v2
    v_lshlrev_b32 v8, 16, v2
    v_sub_f32 v3, 1.0, v8
    v_cvt_pk_bf16_f32 v3, v3, v3
    v_lshlrev_b32 v9, 16, v3
    s_lshl_b32 s26, s49, 3
    s_add_u32 s26, s26, 17563648
    v_mov_b32 v4, 0
    s_mov_b64 exec, 1
    buffer_store_dwordx2 v[8:9], v4, s[40:43], s26 offen
    s_mov_b64 exec, -1
    s_add_u32 s49, s49, 1
    s_waitcnt vmcnt(31)
    v_lshlrev_b32 v2, 16, v37
    v_and_b32 v3, 0xffff0000, v37
    v_lshlrev_b32 v4, 16, v24
    v_and_b32 v5, 0xffff0000, v24
    v_mul_f32 v2, v2, v4
    v_mul_f32 v3, v3, v5
    v_cvt_pk_bf16_f32 v2, v2, v3
    v_lshlrev_b32 v4, 16, v2
    v_and_b32 v5, 0xffff0000, v2
    v_add_f32 v6, v4, v5
    v_lshlrev_b32 v2, 16, v38
    v_and_b32 v3, 0xffff0000, v38
    v_lshlrev_b32 v4, 16, v25
    v_and_b32 v5, 0xffff0000, v25
    v_mul_f32 v2, v2, v4
    v_mul_f32 v3, v3, v5
    v_cvt_pk_bf16_f32 v2, v2, v3
    v_lshlrev_b32 v4, 16, v2
    v_and_b32 v5, 0xffff0000, v2
    v_add_f32 v4, v4, v5
    v_add_f32 v6, v6, v4
    v_lshlrev_b32 v2, 16, v39
    v_and_b32 v3, 0xffff0000, v39
    v_lshlrev_b32 v4, 16, v26
    v_and_b32 v5, 0xffff0000, v26
    v_mul_f32 v2, v2, v4
    v_mul_f32 v3, v3, v5
    v_cvt_pk_bf16_f32 v2, v2, v3
    v_lshlrev_b32 v4, 16, v2
    v_and_b32 v5, 0xffff0000, v2
    v_add_f32 v4, v4, v5
    v_add_f32 v6, v6, v4
    v_lshlrev_b32 v2, 16, v40
    v_and_b32 v3, 0xffff0000, v40
    v_lshlrev_b32 v4, 16, v27
    v_and_b32 v5, 0xffff0000, v27
    v_mul_f32 v2, v2, v4
    v_mul_f32 v3, v3, v5
    v_cvt_pk_bf16_f32 v2, v2, v3
    v_lshlrev_b32 v4, 16, v2
    v_and_b32 v5, 0xffff0000, v2
    v_add_f32 v4, v4, v5
    v_add_f32 v6, v6, v4
    v_lshlrev_b32 v2, 16, v41
    v_and_b32 v3, 0xffff0000, v41
    v_lshlrev_b32 v4, 16, v28
    v_and_b32 v5, 0xffff0000, v28
    v_mul_f32 v2, v2, v4
    v_mul_f32 v3, v3, v5
    v_cvt_pk_bf16_f32 v2, v2, v3
    v_lshlrev_b32 v4, 16, v2
    v_and_b32 v5, 0xffff0000, v2
    v_add_f32 v4, v4, v5
    v_add_f32 v6, v6, v4
    s_nop 1
    v_add_f32_dpp v6, v6, v6 row_shr:1 row_mask:0xf bank_mask:0xf bound_ctrl:0
    s_nop 1
    v_add_f32_dpp v6, v6, v6 row_shr:2 row_mask:0xf bank_mask:0xf bound_ctrl:0
    s_nop 1
    v_add_f32_dpp v6, v6, v6 row_shr:4 row_mask:0xf bank_mask:0xf bound_ctrl:0
    s_nop 1
    v_add_f32_dpp v6, v6, v6 row_shr:8 row_mask:0xf bank_mask:0xf bound_ctrl:0
    s_nop 1
    v_readlane_b32 s26, v6, 15
    v_readlane_b32 s28, v6, 31
    v_readlane_b32 s29, v6, 47
    v_readlane_b32 s50, v6, 63
    s_nop 1
    v_mov_b32 v2, s26
    v_add_f32 v2, s28, v2
    v_add_f32 v2, s29, v2
    v_add_f32 v2, s50, v2
    v_cvt_pk_bf16_f32 v2, v2, v2
    v_lshlrev_b32 v2, 16, v2
    v_mul_f32 v2, 0xbfb8aa3b, v2
    v_exp_f32 v2, v2
    s_nop 0
    v_add_f32 v2, 1.0, v2
    v_rcp_f32 v2, v2
    s_nop 0
    v_cvt_pk_bf16_f32 v2, v2, v2
    v_lshlrev_b32 v8, 16, v2
    v_sub_f32 v3, 1.0, v8
    v_cvt_pk_bf16_f32 v3, v3, v3
    v_lshlrev_b32 v9, 16, v3
    s_lshl_b32 s26, s49, 3
    s_add_u32 s26, s26, 17563648
    v_mov_b32 v4, 0
    s_mov_b64 exec, 1
    buffer_store_dwordx2 v[8:9], v4, s[40:43], s26 offen
    s_mov_b64 exec, -1
    s_add_u32 s49, s49, 1
    s_waitcnt vmcnt(27)
    v_lshlrev_b32 v2, 16, v42
    v_and_b32 v3, 0xffff0000, v42
    v_lshlrev_b32 v4, 16, v24
    v_and_b32 v5, 0xffff0000, v24
    v_mul_f32 v2, v2, v4
    v_mul_f32 v3, v3, v5
    v_cvt_pk_bf16_f32 v2, v2, v3
    v_lshlrev_b32 v4, 16, v2
    v_and_b32 v5, 0xffff0000, v2
    v_add_f32 v6, v4, v5
    v_lshlrev_b32 v2, 16, v43
    v_and_b32 v3, 0xffff0000, v43
    v_lshlrev_b32 v4, 16, v25
    v_and_b32 v5, 0xffff0000, v25
    v_mul_f32 v2, v2, v4
    v_mul_f32 v3, v3, v5
    v_cvt_pk_bf16_f32 v2, v2, v3
    v_lshlrev_b32 v4, 16, v2
    v_and_b32 v5, 0xffff0000, v2
    v_add_f32 v4, v4, v5
    v_add_f32 v6, v6, v4
    v_lshlrev_b32 v2, 16, v44
    v_and_b32 v3, 0xffff0000, v44
    v_lshlrev_b32 v4, 16, v26
    v_and_b32 v5, 0xffff0000, v26
    v_mul_f32 v2, v2, v4
    v_mul_f32 v3, v3, v5
    v_cvt_pk_bf16_f32 v2, v2, v3
    v_lshlrev_b32 v4, 16, v2
    v_and_b32 v5, 0xffff0000, v2
    v_add_f32 v4, v4, v5
    v_add_f32 v6, v6, v4
    v_lshlrev_b32 v2, 16, v45
    v_and_b32 v3, 0xffff0000, v45
    v_lshlrev_b32 v4, 16, v27
    v_and_b32 v5, 0xffff0000, v27
    v_mul_f32 v2, v2, v4
    v_mul_f32 v3, v3, v5
    v_cvt_pk_bf16_f32 v2, v2, v3
    v_lshlrev_b32 v4, 16, v2
    v_and_b32 v5, 0xffff0000, v2
    v_add_f32 v4, v4, v5
    v_add_f32 v6, v6, v4
    v_lshlrev_b32 v2, 16, v46
    v_and_b32 v3, 0xffff0000, v46
    v_lshlrev_b32 v4, 16, v28
    v_and_b32 v5, 0xffff0000, v28
    v_mul_f32 v2, v2, v4
    v_mul_f32 v3, v3, v5
    v_cvt_pk_bf16_f32 v2, v2, v3
    v_lshlrev_b32 v4, 16, v2
    v_and_b32 v5, 0xffff0000, v2
    v_add_f32 v4, v4, v5
    v_add_f32 v6, v6, v4
    s_nop 1
    v_add_f32_dpp v6, v6, v6 row_shr:1 row_mask:0xf bank_mask:0xf bound_ctrl:0
    s_nop 1
    v_add_f32_dpp v6, v6, v6 row_shr:2 row_mask:0xf bank_mask:0xf bound_ctrl:0
    s_nop 1
    v_add_f32_dpp v6, v6, v6 row_shr:4 row_mask:0xf bank_mask:0xf bound_ctrl:0
    s_nop 1
    v_add_f32_dpp v6, v6, v6 row_shr:8 row_mask:0xf bank_mask:0xf bound_ctrl:0
    s_nop 1
    v_readlane_b32 s26, v6, 15
    v_readlane_b32 s28, v6, 31
    v_readlane_b32 s29, v6, 47
    v_readlane_b32 s50, v6, 63
    s_nop 1
    v_mov_b32 v2, s26
    v_add_f32 v2, s28, v2
    v_add_f32 v2, s29, v2
    v_add_f32 v2, s50, v2
    v_cvt_pk_bf16_f32 v2, v2, v2
    v_lshlrev_b32 v2, 16, v2
    v_mul_f32 v2, 0xbfb8aa3b, v2
    v_exp_f32 v2, v2
    s_nop 0
    v_add_f32 v2, 1.0, v2
    v_rcp_f32 v2, v2
    s_nop 0
    v_cvt_pk_bf16_f32 v2, v2, v2
    v_lshlrev_b32 v8, 16, v2
    v_sub_f32 v3, 1.0, v8
    v_cvt_pk_bf16_f32 v3, v3, v3
    v_lshlrev_b32 v9, 16, v3
    s_lshl_b32 s26, s49, 3
    s_add_u32 s26, s26, 17563648
    v_mov_b32 v4, 0
    s_mov_b64 exec, 1
    buffer_store_dwordx2 v[8:9], v4, s[40:43], s26 offen
    s_mov_b64 exec, -1
    s_add_u32 s49, s49, 1
    s_waitcnt vmcnt(23)
    v_lshlrev_b32 v2, 16, v47
    v_and_b32 v3, 0xffff0000, v47
    v_lshlrev_b32 v4, 16, v24
    v_and_b32 v5, 0xffff0000, v24
    v_mul_f32 v2, v2, v4
    v_mul_f32 v3, v3, v5
    v_cvt_pk_bf16_f32 v2, v2, v3
    v_lshlrev_b32 v4, 16, v2
    v_and_b32 v5, 0xffff0000, v2
    v_add_f32 v6, v4, v5
    v_lshlrev_b32 v2, 16, v48
    v_and_b32 v3, 0xffff0000, v48
    v_lshlrev_b32 v4, 16, v25
    v_and_b32 v5, 0xffff0000, v25
    v_mul_f32 v2, v2, v4
    v_mul_f32 v3, v3, v5
    v_cvt_pk_bf16_f32 v2, v2, v3
    v_lshlrev_b32 v4, 16, v2
    v_and_b32 v5, 0xffff0000, v2
    v_add_f32 v4, v4, v5
    v_add_f32 v6, v6, v4
    v_lshlrev_b32 v2, 16, v49
    v_and_b32 v3, 0xffff0000, v49
    v_lshlrev_b32 v4, 16, v26
    v_and_b32 v5, 0xffff0000, v26
    v_mul_f32 v2, v2, v4
    v_mul_f32 v3, v3, v5
    v_cvt_pk_bf16_f32 v2, v2, v3
    v_lshlrev_b32 v4, 16, v2
    v_and_b32 v5, 0xffff0000, v2
    v_add_f32 v4, v4, v5
    v_add_f32 v6, v6, v4
    v_lshlrev_b32 v2, 16, v50
    v_and_b32 v3, 0xffff0000, v50
    v_lshlrev_b32 v4, 16, v27
    v_and_b32 v5, 0xffff0000, v27
    v_mul_f32 v2, v2, v4
    v_mul_f32 v3, v3, v5
    v_cvt_pk_bf16_f32 v2, v2, v3
    v_lshlrev_b32 v4, 16, v2
    v_and_b32 v5, 0xffff0000, v2
    v_add_f32 v4, v4, v5
    v_add_f32 v6, v6, v4
    v_lshlrev_b32 v2, 16, v51
    v_and_b32 v3, 0xffff0000, v51
    v_lshlrev_b32 v4, 16, v28
    v_and_b32 v5, 0xffff0000, v28
    v_mul_f32 v2, v2, v4
    v_mul_f32 v3, v3, v5
    v_cvt_pk_bf16_f32 v2, v2, v3
    v_lshlrev_b32 v4, 16, v2
    v_and_b32 v5, 0xffff0000, v2
    v_add_f32 v4, v4, v5
    v_add_f32 v6, v6, v4
    s_nop 1
    v_add_f32_dpp v6, v6, v6 row_shr:1 row_mask:0xf bank_mask:0xf bound_ctrl:0
    s_nop 1
    v_add_f32_dpp v6, v6, v6 row_shr:2 row_mask:0xf bank_mask:0xf bound_ctrl:0
    s_nop 1
    v_add_f32_dpp v6, v6, v6 row_shr:4 row_mask:0xf bank_mask:0xf bound_ctrl:0
    s_nop 1
    v_add_f32_dpp v6, v6, v6 row_shr:8 row_mask:0xf bank_mask:0xf bound_ctrl:0
    s_nop 1
    v_readlane_b32 s26, v6, 15
    v_readlane_b32 s28, v6, 31
    v_readlane_b32 s29, v6, 47
    v_readlane_b32 s50, v6, 63
    s_nop 1
    v_mov_b32 v2, s26
    v_add_f32 v2, s28, v2
    v_add_f32 v2, s29, v2
    v_add_f32 v2, s50, v2
    v_cvt_pk_bf16_f32 v2, v2, v2
    v_lshlrev_b32 v2, 16, v2
    v_mul_f32 v2, 0xbfb8aa3b, v2
    v_exp_f32 v2, v2
    s_nop 0
    v_add_f32 v2, 1.0, v2
    v_rcp_f32 v2, v2
    s_nop 0
    v_cvt_pk_bf16_f32 v2, v2, v2
    v_lshlrev_b32 v8, 16, v2
    v_sub_f32 v3, 1.0, v8
    v_cvt_pk_bf16_f32 v3, v3, v3
    v_lshlrev_b32 v9, 16, v3
    s_lshl_b32 s26, s49, 3
    s_add_u32 s26, s26, 17563648
    v_mov_b32 v4, 0
    s_mov_b64 exec, 1
    buffer_store_dwordx2 v[8:9], v4, s[40:43], s26 offen
    s_mov_b64 exec, -1
    s_add_u32 s49, s49, 1
    s_waitcnt vmcnt(19)
    v_lshlrev_b32 v2, 16, v52
    v_and_b32 v3, 0xffff0000, v52
    v_lshlrev_b32 v4, 16, v24
    v_and_b32 v5, 0xffff0000, v24
    v_mul_f32 v2, v2, v4
    v_mul_f32 v3, v3, v5
    v_cvt_pk_bf16_f32 v2, v2, v3
    v_lshlrev_b32 v4, 16, v2
    v_and_b32 v5, 0xffff0000, v2
    v_add_f32 v6, v4, v5
    v_lshlrev_b32 v2, 16, v53
    v_and_b32 v3, 0xffff0000, v53
    v_lshlrev_b32 v4, 16, v25
    v_and_b32 v5, 0xffff0000, v25
    v_mul_f32 v2, v2, v4
    v_mul_f32 v3, v3, v5
    v_cvt_pk_bf16_f32 v2, v2, v3
    v_lshlrev_b32 v4, 16, v2
    v_and_b32 v5, 0xffff0000, v2
    v_add_f32 v4, v4, v5
    v_add_f32 v6, v6, v4
    v_lshlrev_b32 v2, 16, v54
    v_and_b32 v3, 0xffff0000, v54
    v_lshlrev_b32 v4, 16, v26
    v_and_b32 v5, 0xffff0000, v26
    v_mul_f32 v2, v2, v4
    v_mul_f32 v3, v3, v5
    v_cvt_pk_bf16_f32 v2, v2, v3
    v_lshlrev_b32 v4, 16, v2
    v_and_b32 v5, 0xffff0000, v2
    v_add_f32 v4, v4, v5
    v_add_f32 v6, v6, v4
    v_lshlrev_b32 v2, 16, v55
    v_and_b32 v3, 0xffff0000, v55
    v_lshlrev_b32 v4, 16, v27
    v_and_b32 v5, 0xffff0000, v27
    v_mul_f32 v2, v2, v4
    v_mul_f32 v3, v3, v5
    v_cvt_pk_bf16_f32 v2, v2, v3
    v_lshlrev_b32 v4, 16, v2
    v_and_b32 v5, 0xffff0000, v2
    v_add_f32 v4, v4, v5
    v_add_f32 v6, v6, v4
    v_lshlrev_b32 v2, 16, v56
    v_and_b32 v3, 0xffff0000, v56
    v_lshlrev_b32 v4, 16, v28
    v_and_b32 v5, 0xffff0000, v28
    v_mul_f32 v2, v2, v4
    v_mul_f32 v3, v3, v5
    v_cvt_pk_bf16_f32 v2, v2, v3
    v_lshlrev_b32 v4, 16, v2
    v_and_b32 v5, 0xffff0000, v2
    v_add_f32 v4, v4, v5
    v_add_f32 v6, v6, v4
    s_nop 1
    v_add_f32_dpp v6, v6, v6 row_shr:1 row_mask:0xf bank_mask:0xf bound_ctrl:0
    s_nop 1
    v_add_f32_dpp v6, v6, v6 row_shr:2 row_mask:0xf bank_mask:0xf bound_ctrl:0
    s_nop 1
    v_add_f32_dpp v6, v6, v6 row_shr:4 row_mask:0xf bank_mask:0xf bound_ctrl:0
    s_nop 1
    v_add_f32_dpp v6, v6, v6 row_shr:8 row_mask:0xf bank_mask:0xf bound_ctrl:0
    s_nop 1
    v_readlane_b32 s26, v6, 15
    v_readlane_b32 s28, v6, 31
    v_readlane_b32 s29, v6, 47
    v_readlane_b32 s50, v6, 63
    s_nop 1
    v_mov_b32 v2, s26
    v_add_f32 v2, s28, v2
    v_add_f32 v2, s29, v2
    v_add_f32 v2, s50, v2
    v_cvt_pk_bf16_f32 v2, v2, v2
    v_lshlrev_b32 v2, 16, v2
    v_mul_f32 v2, 0xbfb8aa3b, v2
    v_exp_f32 v2, v2
    s_nop 0
    v_add_f32 v2, 1.0, v2
    v_rcp_f32 v2, v2
    s_nop 0
    v_cvt_pk_bf16_f32 v2, v2, v2
    v_lshlrev_b32 v8, 16, v2
    v_sub_f32 v3, 1.0, v8
    v_cvt_pk_bf16_f32 v3, v3, v3
    v_lshlrev_b32 v9, 16, v3
    s_lshl_b32 s26, s49, 3
    s_add_u32 s26, s26, 17563648
    v_mov_b32 v4, 0
    s_mov_b64 exec, 1
    buffer_store_dwordx2 v[8:9], v4, s[40:43], s26 offen
    s_mov_b64 exec, -1
    s_add_u32 s49, s49, 1
    s_waitcnt vmcnt(15)
    v_lshlrev_b32 v2, 16, v57
    v_and_b32 v3, 0xffff0000, v57
    v_lshlrev_b32 v4, 16, v24
    v_and_b32 v5, 0xffff0000, v24
    v_mul_f32 v2, v2, v4
    v_mul_f32 v3, v3, v5
    v_cvt_pk_bf16_f32 v2, v2, v3
    v_lshlrev_b32 v4, 16, v2
    v_and_b32 v5, 0xffff0000, v2
    v_add_f32 v6, v4, v5
    v_lshlrev_b32 v2, 16, v58
    v_and_b32 v3, 0xffff0000, v58
    v_lshlrev_b32 v4, 16, v25
    v_and_b32 v5, 0xffff0000, v25
    v_mul_f32 v2, v2, v4
    v_mul_f32 v3, v3, v5
    v_cvt_pk_bf16_f32 v2, v2, v3
    v_lshlrev_b32 v4, 16, v2
    v_and_b32 v5, 0xffff0000, v2
    v_add_f32 v4, v4, v5
    v_add_f32 v6, v6, v4
    v_lshlrev_b32 v2, 16, v59
    v_and_b32 v3, 0xffff0000, v59
    v_lshlrev_b32 v4, 16, v26
    v_and_b32 v5, 0xffff0000, v26
    v_mul_f32 v2, v2, v4
    v_mul_f32 v3, v3, v5
    v_cvt_pk_bf16_f32 v2, v2, v3
    v_lshlrev_b32 v4, 16, v2
    v_and_b32 v5, 0xffff0000, v2
    v_add_f32 v4, v4, v5
    v_add_f32 v6, v6, v4
    v_lshlrev_b32 v2, 16, v60
    v_and_b32 v3, 0xffff0000, v60
    v_lshlrev_b32 v4, 16, v27
    v_and_b32 v5, 0xffff0000, v27
    v_mul_f32 v2, v2, v4
    v_mul_f32 v3, v3, v5
    v_cvt_pk_bf16_f32 v2, v2, v3
    v_lshlrev_b32 v4, 16, v2
    v_and_b32 v5, 0xffff0000, v2
    v_add_f32 v4, v4, v5
    v_add_f32 v6, v6, v4
    v_lshlrev_b32 v2, 16, v61
    v_and_b32 v3, 0xffff0000, v61
    v_lshlrev_b32 v4, 16, v28
    v_and_b32 v5, 0xffff0000, v28
    v_mul_f32 v2, v2, v4
    v_mul_f32 v3, v3, v5
    v_cvt_pk_bf16_f32 v2, v2, v3
    v_lshlrev_b32 v4, 16, v2
    v_and_b32 v5, 0xffff0000, v2
    v_add_f32 v4, v4, v5
    v_add_f32 v6, v6, v4
    s_nop 1
    v_add_f32_dpp v6, v6, v6 row_shr:1 row_mask:0xf bank_mask:0xf bound_ctrl:0
    s_nop 1
    v_add_f32_dpp v6, v6, v6 row_shr:2 row_mask:0xf bank_mask:0xf bound_ctrl:0
    s_nop 1
    v_add_f32_dpp v6, v6, v6 row_shr:4 row_mask:0xf bank_mask:0xf bound_ctrl:0
    s_nop 1
    v_add_f32_dpp v6, v6, v6 row_shr:8 row_mask:0xf bank_mask:0xf bound_ctrl:0
    s_nop 1
    v_readlane_b32 s26, v6, 15
    v_readlane_b32 s28, v6, 31
    v_readlane_b32 s29, v6, 47
    v_readlane_b32 s50, v6, 63
    s_nop 1
    v_mov_b32 v2, s26
    v_add_f32 v2, s28, v2
    v_add_f32 v2, s29, v2
    v_add_f32 v2, s50, v2
    v_cvt_pk_bf16_f32 v2, v2, v2
    v_lshlrev_b32 v2, 16, v2
    v_mul_f32 v2, 0xbfb8aa3b, v2
    v_exp_f32 v2, v2
    s_nop 0
    v_add_f32 v2, 1.0, v2
    v_rcp_f32 v2, v2
    s_nop 0
    v_cvt_pk_bf16_f32 v2, v2, v2
    v_lshlrev_b32 v8, 16, v2
    v_sub_f32 v3, 1.0, v8
    v_cvt_pk_bf16_f32 v3, v3, v3
    v_lshlrev_b32 v9, 16, v3
    s_lshl_b32 s26, s49, 3
    s_add_u32 s26, s26, 17563648
    v_mov_b32 v4, 0
    s_mov_b64 exec, 1
    buffer_store_dwordx2 v[8:9], v4, s[40:43], s26 offen
    s_mov_b64 exec, -1
    s_add_u32 s49, s49, 1
    s_waitcnt vmcnt(11)
    v_lshlrev_b32 v2, 16, v62
    v_and_b32 v3, 0xffff0000, v62
    v_lshlrev_b32 v4, 16, v24
    v_and_b32 v5, 0xffff0000, v24
    v_mul_f32 v2, v2, v4
    v_mul_f32 v3, v3, v5
    v_cvt_pk_bf16_f32 v2, v2, v3
    v_lshlrev_b32 v4, 16, v2
    v_and_b32 v5, 0xffff0000, v2
    v_add_f32 v6, v4, v5
    v_lshlrev_b32 v2, 16, v63
    v_and_b32 v3, 0xffff0000, v63
    v_lshlrev_b32 v4, 16, v25
    v_and_b32 v5, 0xffff0000, v25
    v_mul_f32 v2, v2, v4
    v_mul_f32 v3, v3, v5
    v_cvt_pk_bf16_f32 v2, v2, v3
    v_lshlrev_b32 v4, 16, v2
    v_and_b32 v5, 0xffff0000, v2
    v_add_f32 v4, v4, v5
    v_add_f32 v6, v6, v4
    v_lshlrev_b32 v2, 16, v64
    v_and_b32 v3, 0xffff0000, v64
    v_lshlrev_b32 v4, 16, v26
    v_and_b32 v5, 0xffff0000, v26
    v_mul_f32 v2, v2, v4
    v_mul_f32 v3, v3, v5
    v_cvt_pk_bf16_f32 v2, v2, v3
    v_lshlrev_b32 v4, 16, v2
    v_and_b32 v5, 0xffff0000, v2
    v_add_f32 v4, v4, v5
    v_add_f32 v6, v6, v4
    v_lshlrev_b32 v2, 16, v65
    v_and_b32 v3, 0xffff0000, v65
    v_lshlrev_b32 v4, 16, v27
    v_and_b32 v5, 0xffff0000, v27
    v_mul_f32 v2, v2, v4
    v_mul_f32 v3, v3, v5
    v_cvt_pk_bf16_f32 v2, v2, v3
    v_lshlrev_b32 v4, 16, v2
    v_and_b32 v5, 0xffff0000, v2
    v_add_f32 v4, v4, v5
    v_add_f32 v6, v6, v4
    v_lshlrev_b32 v2, 16, v66
    v_and_b32 v3, 0xffff0000, v66
    v_lshlrev_b32 v4, 16, v28
    v_and_b32 v5, 0xffff0000, v28
    v_mul_f32 v2, v2, v4
    v_mul_f32 v3, v3, v5
    v_cvt_pk_bf16_f32 v2, v2, v3
    v_lshlrev_b32 v4, 16, v2
    v_and_b32 v5, 0xffff0000, v2
    v_add_f32 v4, v4, v5
    v_add_f32 v6, v6, v4
    s_nop 1
    v_add_f32_dpp v6, v6, v6 row_shr:1 row_mask:0xf bank_mask:0xf bound_ctrl:0
    s_nop 1
    v_add_f32_dpp v6, v6, v6 row_shr:2 row_mask:0xf bank_mask:0xf bound_ctrl:0
    s_nop 1
    v_add_f32_dpp v6, v6, v6 row_shr:4 row_mask:0xf bank_mask:0xf bound_ctrl:0
    s_nop 1
    v_add_f32_dpp v6, v6, v6 row_shr:8 row_mask:0xf bank_mask:0xf bound_ctrl:0
    s_nop 1
    v_readlane_b32 s26, v6, 15
    v_readlane_b32 s28, v6, 31
    v_readlane_b32 s29, v6, 47
    v_readlane_b32 s50, v6, 63
    s_nop 1
    v_mov_b32 v2, s26
    v_add_f32 v2, s28, v2
    v_add_f32 v2, s29, v2
    v_add_f32 v2, s50, v2
    v_cvt_pk_bf16_f32 v2, v2, v2
    v_lshlrev_b32 v2, 16, v2
    v_mul_f32 v2, 0xbfb8aa3b, v2
    v_exp_f32 v2, v2
    s_nop 0
    v_add_f32 v2, 1.0, v2
    v_rcp_f32 v2, v2
    s_nop 0
    v_cvt_pk_bf16_f32 v2, v2, v2
    v_lshlrev_b32 v8, 16, v2
    v_sub_f32 v3, 1.0, v8
    v_cvt_pk_bf16_f32 v3, v3, v3
    v_lshlrev_b32 v9, 16, v3
    s_lshl_b32 s26, s49, 3
    s_add_u32 s26, s26, 17563648
    v_mov_b32 v4, 0
    s_mov_b64 exec, 1
    buffer_store_dwordx2 v[8:9], v4, s[40:43], s26 offen
    s_mov_b64 exec, -1
    s_add_u32 s49, s49, 1
    s_waitcnt vmcnt(7)
    v_lshlrev_b32 v2, 16, v67
    v_and_b32 v3, 0xffff0000, v67
    v_lshlrev_b32 v4, 16, v24
    v_and_b32 v5, 0xffff0000, v24
    v_mul_f32 v2, v2, v4
    v_mul_f32 v3, v3, v5
    v_cvt_pk_bf16_f32 v2, v2, v3
    v_lshlrev_b32 v4, 16, v2
    v_and_b32 v5, 0xffff0000, v2
    v_add_f32 v6, v4, v5
    v_lshlrev_b32 v2, 16, v68
    v_and_b32 v3, 0xffff0000, v68
    v_lshlrev_b32 v4, 16, v25
    v_and_b32 v5, 0xffff0000, v25
    v_mul_f32 v2, v2, v4
    v_mul_f32 v3, v3, v5
    v_cvt_pk_bf16_f32 v2, v2, v3
    v_lshlrev_b32 v4, 16, v2
    v_and_b32 v5, 0xffff0000, v2
    v_add_f32 v4, v4, v5
    v_add_f32 v6, v6, v4
    v_lshlrev_b32 v2, 16, v69
    v_and_b32 v3, 0xffff0000, v69
    v_lshlrev_b32 v4, 16, v26
    v_and_b32 v5, 0xffff0000, v26
    v_mul_f32 v2, v2, v4
    v_mul_f32 v3, v3, v5
    v_cvt_pk_bf16_f32 v2, v2, v3
    v_lshlrev_b32 v4, 16, v2
    v_and_b32 v5, 0xffff0000, v2
    v_add_f32 v4, v4, v5
    v_add_f32 v6, v6, v4
    v_lshlrev_b32 v2, 16, v70
    v_and_b32 v3, 0xffff0000, v70
    v_lshlrev_b32 v4, 16, v27
    v_and_b32 v5, 0xffff0000, v27
    v_mul_f32 v2, v2, v4
    v_mul_f32 v3, v3, v5
    v_cvt_pk_bf16_f32 v2, v2, v3
    v_lshlrev_b32 v4, 16, v2
    v_and_b32 v5, 0xffff0000, v2
    v_add_f32 v4, v4, v5
    v_add_f32 v6, v6, v4
    v_lshlrev_b32 v2, 16, v71
    v_and_b32 v3, 0xffff0000, v71
    v_lshlrev_b32 v4, 16, v28
    v_and_b32 v5, 0xffff0000, v28
    v_mul_f32 v2, v2, v4
    v_mul_f32 v3, v3, v5
    v_cvt_pk_bf16_f32 v2, v2, v3
    v_lshlrev_b32 v4, 16, v2
    v_and_b32 v5, 0xffff0000, v2
    v_add_f32 v4, v4, v5
    v_add_f32 v6, v6, v4
    s_nop 1
    v_add_f32_dpp v6, v6, v6 row_shr:1 row_mask:0xf bank_mask:0xf bound_ctrl:0
    s_nop 1
    v_add_f32_dpp v6, v6, v6 row_shr:2 row_mask:0xf bank_mask:0xf bound_ctrl:0
    s_nop 1
    v_add_f32_dpp v6, v6, v6 row_shr:4 row_mask:0xf bank_mask:0xf bound_ctrl:0
    s_nop 1
    v_add_f32_dpp v6, v6, v6 row_shr:8 row_mask:0xf bank_mask:0xf bound_ctrl:0
    s_nop 1
    v_readlane_b32 s26, v6, 15
    v_readlane_b32 s28, v6, 31
    v_readlane_b32 s29, v6, 47
    v_readlane_b32 s50, v6, 63
    s_nop 1
    v_mov_b32 v2, s26
    v_add_f32 v2, s28, v2
    v_add_f32 v2, s29, v2
    v_add_f32 v2, s50, v2
    v_cvt_pk_bf16_f32 v2, v2, v2
    v_lshlrev_b32 v2, 16, v2
    v_mul_f32 v2, 0xbfb8aa3b, v2
    v_exp_f32 v2, v2
    s_nop 0
    v_add_f32 v2, 1.0, v2
    v_rcp_f32 v2, v2
    s_nop 0
    v_cvt_pk_bf16_f32 v2, v2, v2
    v_lshlrev_b32 v8, 16, v2
    v_sub_f32 v3, 1.0, v8
    v_cvt_pk_bf16_f32 v3, v3, v3
    v_lshlrev_b32 v9, 16, v3
    s_lshl_b32 s26, s49, 3
    s_add_u32 s26, s26, 17563648
    v_mov_b32 v4, 0
    s_mov_b64 exec, 1
    buffer_store_dwordx2 v[8:9], v4, s[40:43], s26 offen
    s_mov_b64 exec, -1
    s_add_u32 s49, s49, 1
    buffer_load_dword v32, v7, s[32:35], s27 offen offset:0
    buffer_load_dword v33, v7, s[32:35], s27 offen offset:256
    buffer_load_dword v34, v7, s[32:35], s27 offen offset:512
    buffer_load_dword v35, v7, s[32:35], s27 offen offset:768
    buffer_load_dword v36, v7, s[32:35], s27 offen offset:1024
    s_add_u32 s27, s27, 1280
    buffer_load_dword v37, v7, s[32:35], s27 offen offset:0
    buffer_load_dword v38, v7, s[32:35], s27 offen offset:256
    buffer_load_dword v39, v7, s[32:35], s27 offen offset:512
    buffer_load_dword v40, v7, s[32:35], s27 offen offset:768
    buffer_load_dword v41, v7, s[32:35], s27 offen offset:1024
    s_add_u32 s27, s27, 1280
    buffer_load_dword v42, v7, s[32:35], s27 offen offset:0
    buffer_load_dword v43, v7, s[32:35], s27 offen offset:256
    buffer_load_dword v44, v7, s[32:35], s27 offen offset:512
    buffer_load_dword v45, v7, s[32:35], s27 offen offset:768
    buffer_load_dword v46, v7, s[32:35], s27 offen offset:1024
    s_add_u32 s27, s27, 1280
    buffer_load_dword v47, v7, s[32:35], s27 offen offset:0
    buffer_load_dword v48, v7, s[32:35], s27 offen offset:256
    buffer_load_dword v49, v7, s[32:35], s27 offen offset:512
    buffer_load_dword v50, v7, s[32:35], s27 offen offset:768
    buffer_load_dword v51, v7, s[32:35], s27 offen offset:1024
    s_add_u32 s27, s27, 1280
    buffer_load_dword v52, v7, s[32:35], s27 offen offset:0
    buffer_load_dword v53, v7, s[32:35], s27 offen offset:256
    buffer_load_dword v54, v7, s[32:35], s27 offen offset:512
    buffer_load_dword v55, v7, s[32:35], s27 offen offset:768
    buffer_load_dword v56, v7, s[32:35], s27 offen offset:1024
    s_add_u32 s27, s27, 1280
    buffer_load_dword v57, v7, s[32:35], s27 offen offset:0
    buffer_load_dword v58, v7, s[32:35], s27 offen offset:256
    buffer_load_dword v59, v7, s[32:35], s27 offen offset:512
    buffer_load_dword v60, v7, s[32:35], s27 offen offset:768
    buffer_load_dword v61, v7, s[32:35], s27 offen offset:1024
    s_add_u32 s27, s27, 1280
    buffer_load_dword v62, v7, s[32:35], s27 offen offset:0
    buffer_load_dword v63, v7, s[32:35], s27 offen offset:256
    buffer_load_dword v64, v7, s[32:35], s27 offen offset:512
    buffer_load_dword v65, v7, s[32:35], s27 offen offset:768
    buffer_load_dword v66, v7, s[32:35], s27 offen offset:1024
    s_add_u32 s27, s27, 1280
    buffer_load_dword v67, v7, s[32:35], s27 offen offset:0
    buffer_load_dword v68, v7, s[32:35], s27 offen offset:256
    buffer_load_dword v69, v7, s[32:35], s27 offen offset:512
    buffer_load_dword v70, v7, s[32:35], s27 offen offset:768
    buffer_load_dword v71, v7, s[32:35], s27 offen offset:1024
    s_add_u32 s27, s27, 1280
    s_waitcnt vmcnt(35)
    v_lshlrev_b32 v2, 16, v32
    v_and_b32 v3, 0xffff0000, v32
    v_lshlrev_b32 v4, 16, v24
    v_and_b32 v5, 0xffff0000, v24
    v_mul_f32 v2, v2, v4
    v_mul_f32 v3, v3, v5
    v_cvt_pk_bf16_f32 v2, v2, v3
    v_lshlrev_b32 v4, 16, v2
    v_and_b32 v5, 0xffff0000, v2
    v_add_f32 v6, v4, v5
    v_lshlrev_b32 v2, 16, v33
    v_and_b32 v3, 0xffff0000, v33
    v_lshlrev_b32 v4, 16, v25
    v_and_b32 v5, 0xffff0000, v25
    v_mul_f32 v2, v2, v4
    v_mul_f32 v3, v3, v5
    v_cvt_pk_bf16_f32 v2, v2, v3
    v_lshlrev_b32 v4, 16, v2
    v_and_b32 v5, 0xffff0000, v2
    v_add_f32 v4, v4, v5
    v_add_f32 v6, v6, v4
    v_lshlrev_b32 v2, 16, v34
    v_and_b32 v3, 0xffff0000, v34
    v_lshlrev_b32 v4, 16, v26
    v_and_b32 v5, 0xffff0000, v26
    v_mul_f32 v2, v2, v4
    v_mul_f32 v3, v3, v5
    v_cvt_pk_bf16_f32 v2, v2, v3
    v_lshlrev_b32 v4, 16, v2
    v_and_b32 v5, 0xffff0000, v2
    v_add_f32 v4, v4, v5
    v_add_f32 v6, v6, v4
    v_lshlrev_b32 v2, 16, v35
    v_and_b32 v3, 0xffff0000, v35
    v_lshlrev_b32 v4, 16, v27
    v_and_b32 v5, 0xffff0000, v27
    v_mul_f32 v2, v2, v4
    v_mul_f32 v3, v3, v5
    v_cvt_pk_bf16_f32 v2, v2, v3
    v_lshlrev_b32 v4, 16, v2
    v_and_b32 v5, 0xffff0000, v2
    v_add_f32 v4, v4, v5
    v_add_f32 v6, v6, v4
    v_lshlrev_b32 v2, 16, v36
    v_and_b32 v3, 0xffff0000, v36
    v_lshlrev_b32 v4, 16, v28
    v_and_b32 v5, 0xffff0000, v28
    v_mul_f32 v2, v2, v4
    v_mul_f32 v3, v3, v5
    v_cvt_pk_bf16_f32 v2, v2, v3
    v_lshlrev_b32 v4, 16, v2
    v_and_b32 v5, 0xffff0000, v2
    v_add_f32 v4, v4, v5
    v_add_f32 v6, v6, v4
    s_nop 1
    v_add_f32_dpp v6, v6, v6 row_shr:1 row_mask:0xf bank_mask:0xf bound_ctrl:0
    s_nop 1
    v_add_f32_dpp v6, v6, v6 row_shr:2 row_mask:0xf bank_mask:0xf bound_ctrl:0
    s_nop 1
    v_add_f32_dpp v6, v6, v6 row_shr:4 row_mask:0xf bank_mask:0xf bound_ctrl:0
    s_nop 1
    v_add_f32_dpp v6, v6, v6 row_shr:8 row_mask:0xf bank_mask:0xf bound_ctrl:0
    s_nop 1
    v_readlane_b32 s26, v6, 15
    v_readlane_b32 s28, v6, 31
    v_readlane_b32 s29, v6, 47
    v_readlane_b32 s50, v6, 63
    s_nop 1
    v_mov_b32 v2, s26
    v_add_f32 v2, s28, v2
    v_add_f32 v2, s29, v2
    v_add_f32 v2, s50, v2
    v_cvt_pk_bf16_f32 v2, v2, v2
    v_lshlrev_b32 v2, 16, v2
    v_mul_f32 v2, 0xbfb8aa3b, v2
    v_exp_f32 v2, v2
    s_nop 0
    v_add_f32 v2, 1.0, v2
    v_rcp_f32 v2, v2
    s_nop 0
    v_cvt_pk_bf16_f32 v2, v2, v2
    v_lshlrev_b32 v8, 16, v2
    v_sub_f32 v3, 1.0, v8
    v_cvt_pk_bf16_f32 v3, v3, v3
    v_lshlrev_b32 v9, 16, v3
    s_lshl_b32 s26, s49, 3
    s_add_u32 s26, s26, 17563648
    v_mov_b32 v4, 0
    s_mov_b64 exec, 1
    buffer_store_dwordx2 v[8:9], v4, s[40:43], s26 offen
    s_mov_b64 exec, -1
    s_add_u32 s49, s49, 1
    s_waitcnt vmcnt(31)
    v_lshlrev_b32 v2, 16, v37
    v_and_b32 v3, 0xffff0000, v37
    v_lshlrev_b32 v4, 16, v24
    v_and_b32 v5, 0xffff0000, v24
    v_mul_f32 v2, v2, v4
    v_mul_f32 v3, v3, v5
    v_cvt_pk_bf16_f32 v2, v2, v3
    v_lshlrev_b32 v4, 16, v2
    v_and_b32 v5, 0xffff0000, v2
    v_add_f32 v6, v4, v5
    v_lshlrev_b32 v2, 16, v38
    v_and_b32 v3, 0xffff0000, v38
    v_lshlrev_b32 v4, 16, v25
    v_and_b32 v5, 0xffff0000, v25
    v_mul_f32 v2, v2, v4
    v_mul_f32 v3, v3, v5
    v_cvt_pk_bf16_f32 v2, v2, v3
    v_lshlrev_b32 v4, 16, v2
    v_and_b32 v5, 0xffff0000, v2
    v_add_f32 v4, v4, v5
    v_add_f32 v6, v6, v4
    v_lshlrev_b32 v2, 16, v39
    v_and_b32 v3, 0xffff0000, v39
    v_lshlrev_b32 v4, 16, v26
    v_and_b32 v5, 0xffff0000, v26
    v_mul_f32 v2, v2, v4
    v_mul_f32 v3, v3, v5
    v_cvt_pk_bf16_f32 v2, v2, v3
    v_lshlrev_b32 v4, 16, v2
    v_and_b32 v5, 0xffff0000, v2
    v_add_f32 v4, v4, v5
    v_add_f32 v6, v6, v4
    v_lshlrev_b32 v2, 16, v40
    v_and_b32 v3, 0xffff0000, v40
    v_lshlrev_b32 v4, 16, v27
    v_and_b32 v5, 0xffff0000, v27
    v_mul_f32 v2, v2, v4
    v_mul_f32 v3, v3, v5
    v_cvt_pk_bf16_f32 v2, v2, v3
    v_lshlrev_b32 v4, 16, v2
    v_and_b32 v5, 0xffff0000, v2
    v_add_f32 v4, v4, v5
    v_add_f32 v6, v6, v4
    v_lshlrev_b32 v2, 16, v41
    v_and_b32 v3, 0xffff0000, v41
    v_lshlrev_b32 v4, 16, v28
    v_and_b32 v5, 0xffff0000, v28
    v_mul_f32 v2, v2, v4
    v_mul_f32 v3, v3, v5
    v_cvt_pk_bf16_f32 v2, v2, v3
    v_lshlrev_b32 v4, 16, v2
    v_and_b32 v5, 0xffff0000, v2
    v_add_f32 v4, v4, v5
    v_add_f32 v6, v6, v4
    s_nop 1
    v_add_f32_dpp v6, v6, v6 row_shr:1 row_mask:0xf bank_mask:0xf bound_ctrl:0
    s_nop 1
    v_add_f32_dpp v6, v6, v6 row_shr:2 row_mask:0xf bank_mask:0xf bound_ctrl:0
    s_nop 1
    v_add_f32_dpp v6, v6, v6 row_shr:4 row_mask:0xf bank_mask:0xf bound_ctrl:0
    s_nop 1
    v_add_f32_dpp v6, v6, v6 row_shr:8 row_mask:0xf bank_mask:0xf bound_ctrl:0
    s_nop 1
    v_readlane_b32 s26, v6, 15
    v_readlane_b32 s28, v6, 31
    v_readlane_b32 s29, v6, 47
    v_readlane_b32 s50, v6, 63
    s_nop 1
    v_mov_b32 v2, s26
    v_add_f32 v2, s28, v2
    v_add_f32 v2, s29, v2
    v_add_f32 v2, s50, v2
    v_cvt_pk_bf16_f32 v2, v2, v2
    v_lshlrev_b32 v2, 16, v2
    v_mul_f32 v2, 0xbfb8aa3b, v2
    v_exp_f32 v2, v2
    s_nop 0
    v_add_f32 v2, 1.0, v2
    v_rcp_f32 v2, v2
    s_nop 0
    v_cvt_pk_bf16_f32 v2, v2, v2
    v_lshlrev_b32 v8, 16, v2
    v_sub_f32 v3, 1.0, v8
    v_cvt_pk_bf16_f32 v3, v3, v3
    v_lshlrev_b32 v9, 16, v3
    s_lshl_b32 s26, s49, 3
    s_add_u32 s26, s26, 17563648
    v_mov_b32 v4, 0
    s_mov_b64 exec, 1
    buffer_store_dwordx2 v[8:9], v4, s[40:43], s26 offen
    s_mov_b64 exec, -1
    s_add_u32 s49, s49, 1
    s_waitcnt vmcnt(27)
    v_lshlrev_b32 v2, 16, v42
    v_and_b32 v3, 0xffff0000, v42
    v_lshlrev_b32 v4, 16, v24
    v_and_b32 v5, 0xffff0000, v24
    v_mul_f32 v2, v2, v4
    v_mul_f32 v3, v3, v5
    v_cvt_pk_bf16_f32 v2, v2, v3
    v_lshlrev_b32 v4, 16, v2
    v_and_b32 v5, 0xffff0000, v2
    v_add_f32 v6, v4, v5
    v_lshlrev_b32 v2, 16, v43
    v_and_b32 v3, 0xffff0000, v43
    v_lshlrev_b32 v4, 16, v25
    v_and_b32 v5, 0xffff0000, v25
    v_mul_f32 v2, v2, v4
    v_mul_f32 v3, v3, v5
    v_cvt_pk_bf16_f32 v2, v2, v3
    v_lshlrev_b32 v4, 16, v2
    v_and_b32 v5, 0xffff0000, v2
    v_add_f32 v4, v4, v5
    v_add_f32 v6, v6, v4
    v_lshlrev_b32 v2, 16, v44
    v_and_b32 v3, 0xffff0000, v44
    v_lshlrev_b32 v4, 16, v26
    v_and_b32 v5, 0xffff0000, v26
    v_mul_f32 v2, v2, v4
    v_mul_f32 v3, v3, v5
    v_cvt_pk_bf16_f32 v2, v2, v3
    v_lshlrev_b32 v4, 16, v2
    v_and_b32 v5, 0xffff0000, v2
    v_add_f32 v4, v4, v5
    v_add_f32 v6, v6, v4
    v_lshlrev_b32 v2, 16, v45
    v_and_b32 v3, 0xffff0000, v45
    v_lshlrev_b32 v4, 16, v27
    v_and_b32 v5, 0xffff0000, v27
    v_mul_f32 v2, v2, v4
    v_mul_f32 v3, v3, v5
    v_cvt_pk_bf16_f32 v2, v2, v3
    v_lshlrev_b32 v4, 16, v2
    v_and_b32 v5, 0xffff0000, v2
    v_add_f32 v4, v4, v5
    v_add_f32 v6, v6, v4
    v_lshlrev_b32 v2, 16, v46
    v_and_b32 v3, 0xffff0000, v46
    v_lshlrev_b32 v4, 16, v28
    v_and_b32 v5, 0xffff0000, v28
    v_mul_f32 v2, v2, v4
    v_mul_f32 v3, v3, v5
    v_cvt_pk_bf16_f32 v2, v2, v3
    v_lshlrev_b32 v4, 16, v2
    v_and_b32 v5, 0xffff0000, v2
    v_add_f32 v4, v4, v5
    v_add_f32 v6, v6, v4
    s_nop 1
    v_add_f32_dpp v6, v6, v6 row_shr:1 row_mask:0xf bank_mask:0xf bound_ctrl:0
    s_nop 1
    v_add_f32_dpp v6, v6, v6 row_shr:2 row_mask:0xf bank_mask:0xf bound_ctrl:0
    s_nop 1
    v_add_f32_dpp v6, v6, v6 row_shr:4 row_mask:0xf bank_mask:0xf bound_ctrl:0
    s_nop 1
    v_add_f32_dpp v6, v6, v6 row_shr:8 row_mask:0xf bank_mask:0xf bound_ctrl:0
    s_nop 1
    v_readlane_b32 s26, v6, 15
    v_readlane_b32 s28, v6, 31
    v_readlane_b32 s29, v6, 47
    v_readlane_b32 s50, v6, 63
    s_nop 1
    v_mov_b32 v2, s26
    v_add_f32 v2, s28, v2
    v_add_f32 v2, s29, v2
    v_add_f32 v2, s50, v2
    v_cvt_pk_bf16_f32 v2, v2, v2
    v_lshlrev_b32 v2, 16, v2
    v_mul_f32 v2, 0xbfb8aa3b, v2
    v_exp_f32 v2, v2
    s_nop 0
    v_add_f32 v2, 1.0, v2
    v_rcp_f32 v2, v2
    s_nop 0
    v_cvt_pk_bf16_f32 v2, v2, v2
    v_lshlrev_b32 v8, 16, v2
    v_sub_f32 v3, 1.0, v8
    v_cvt_pk_bf16_f32 v3, v3, v3
    v_lshlrev_b32 v9, 16, v3
    s_lshl_b32 s26, s49, 3
    s_add_u32 s26, s26, 17563648
    v_mov_b32 v4, 0
    s_mov_b64 exec, 1
    buffer_store_dwordx2 v[8:9], v4, s[40:43], s26 offen
    s_mov_b64 exec, -1
    s_add_u32 s49, s49, 1
    s_waitcnt vmcnt(23)
    v_lshlrev_b32 v2, 16, v47
    v_and_b32 v3, 0xffff0000, v47
    v_lshlrev_b32 v4, 16, v24
    v_and_b32 v5, 0xffff0000, v24
    v_mul_f32 v2, v2, v4
    v_mul_f32 v3, v3, v5
    v_cvt_pk_bf16_f32 v2, v2, v3
    v_lshlrev_b32 v4, 16, v2
    v_and_b32 v5, 0xffff0000, v2
    v_add_f32 v6, v4, v5
    v_lshlrev_b32 v2, 16, v48
    v_and_b32 v3, 0xffff0000, v48
    v_lshlrev_b32 v4, 16, v25
    v_and_b32 v5, 0xffff0000, v25
    v_mul_f32 v2, v2, v4
    v_mul_f32 v3, v3, v5
    v_cvt_pk_bf16_f32 v2, v2, v3
    v_lshlrev_b32 v4, 16, v2
    v_and_b32 v5, 0xffff0000, v2
    v_add_f32 v4, v4, v5
    v_add_f32 v6, v6, v4
    v_lshlrev_b32 v2, 16, v49
    v_and_b32 v3, 0xffff0000, v49
    v_lshlrev_b32 v4, 16, v26
    v_and_b32 v5, 0xffff0000, v26
    v_mul_f32 v2, v2, v4
    v_mul_f32 v3, v3, v5
    v_cvt_pk_bf16_f32 v2, v2, v3
    v_lshlrev_b32 v4, 16, v2
    v_and_b32 v5, 0xffff0000, v2
    v_add_f32 v4, v4, v5
    v_add_f32 v6, v6, v4
    v_lshlrev_b32 v2, 16, v50
    v_and_b32 v3, 0xffff0000, v50
    v_lshlrev_b32 v4, 16, v27
    v_and_b32 v5, 0xffff0000, v27
    v_mul_f32 v2, v2, v4
    v_mul_f32 v3, v3, v5
    v_cvt_pk_bf16_f32 v2, v2, v3
    v_lshlrev_b32 v4, 16, v2
    v_and_b32 v5, 0xffff0000, v2
    v_add_f32 v4, v4, v5
    v_add_f32 v6, v6, v4
    v_lshlrev_b32 v2, 16, v51
    v_and_b32 v3, 0xffff0000, v51
    v_lshlrev_b32 v4, 16, v28
    v_and_b32 v5, 0xffff0000, v28
    v_mul_f32 v2, v2, v4
    v_mul_f32 v3, v3, v5
    v_cvt_pk_bf16_f32 v2, v2, v3
    v_lshlrev_b32 v4, 16, v2
    v_and_b32 v5, 0xffff0000, v2
    v_add_f32 v4, v4, v5
    v_add_f32 v6, v6, v4
    s_nop 1
    v_add_f32_dpp v6, v6, v6 row_shr:1 row_mask:0xf bank_mask:0xf bound_ctrl:0
    s_nop 1
    v_add_f32_dpp v6, v6, v6 row_shr:2 row_mask:0xf bank_mask:0xf bound_ctrl:0
    s_nop 1
    v_add_f32_dpp v6, v6, v6 row_shr:4 row_mask:0xf bank_mask:0xf bound_ctrl:0
    s_nop 1
    v_add_f32_dpp v6, v6, v6 row_shr:8 row_mask:0xf bank_mask:0xf bound_ctrl:0
    s_nop 1
    v_readlane_b32 s26, v6, 15
    v_readlane_b32 s28, v6, 31
    v_readlane_b32 s29, v6, 47
    v_readlane_b32 s50, v6, 63
    s_nop 1
    v_mov_b32 v2, s26
    v_add_f32 v2, s28, v2
    v_add_f32 v2, s29, v2
    v_add_f32 v2, s50, v2
    v_cvt_pk_bf16_f32 v2, v2, v2
    v_lshlrev_b32 v2, 16, v2
    v_mul_f32 v2, 0xbfb8aa3b, v2
    v_exp_f32 v2, v2
    s_nop 0
    v_add_f32 v2, 1.0, v2
    v_rcp_f32 v2, v2
    s_nop 0
    v_cvt_pk_bf16_f32 v2, v2, v2
    v_lshlrev_b32 v8, 16, v2
    v_sub_f32 v3, 1.0, v8
    v_cvt_pk_bf16_f32 v3, v3, v3
    v_lshlrev_b32 v9, 16, v3
    s_lshl_b32 s26, s49, 3
    s_add_u32 s26, s26, 17563648
    v_mov_b32 v4, 0
    s_mov_b64 exec, 1
    buffer_store_dwordx2 v[8:9], v4, s[40:43], s26 offen
    s_mov_b64 exec, -1
    s_add_u32 s49, s49, 1
    s_waitcnt vmcnt(19)
    v_lshlrev_b32 v2, 16, v52
    v_and_b32 v3, 0xffff0000, v52
    v_lshlrev_b32 v4, 16, v24
    v_and_b32 v5, 0xffff0000, v24
    v_mul_f32 v2, v2, v4
    v_mul_f32 v3, v3, v5
    v_cvt_pk_bf16_f32 v2, v2, v3
    v_lshlrev_b32 v4, 16, v2
    v_and_b32 v5, 0xffff0000, v2
    v_add_f32 v6, v4, v5
    v_lshlrev_b32 v2, 16, v53
    v_and_b32 v3, 0xffff0000, v53
    v_lshlrev_b32 v4, 16, v25
    v_and_b32 v5, 0xffff0000, v25
    v_mul_f32 v2, v2, v4
    v_mul_f32 v3, v3, v5
    v_cvt_pk_bf16_f32 v2, v2, v3
    v_lshlrev_b32 v4, 16, v2
    v_and_b32 v5, 0xffff0000, v2
    v_add_f32 v4, v4, v5
    v_add_f32 v6, v6, v4
    v_lshlrev_b32 v2, 16, v54
    v_and_b32 v3, 0xffff0000, v54
    v_lshlrev_b32 v4, 16, v26
    v_and_b32 v5, 0xffff0000, v26
    v_mul_f32 v2, v2, v4
    v_mul_f32 v3, v3, v5
    v_cvt_pk_bf16_f32 v2, v2, v3
    v_lshlrev_b32 v4, 16, v2
    v_and_b32 v5, 0xffff0000, v2
    v_add_f32 v4, v4, v5
    v_add_f32 v6, v6, v4
    v_lshlrev_b32 v2, 16, v55
    v_and_b32 v3, 0xffff0000, v55
    v_lshlrev_b32 v4, 16, v27
    v_and_b32 v5, 0xffff0000, v27
    v_mul_f32 v2, v2, v4
    v_mul_f32 v3, v3, v5
    v_cvt_pk_bf16_f32 v2, v2, v3
    v_lshlrev_b32 v4, 16, v2
    v_and_b32 v5, 0xffff0000, v2
    v_add_f32 v4, v4, v5
    v_add_f32 v6, v6, v4
    v_lshlrev_b32 v2, 16, v56
    v_and_b32 v3, 0xffff0000, v56
    v_lshlrev_b32 v4, 16, v28
    v_and_b32 v5, 0xffff0000, v28
    v_mul_f32 v2, v2, v4
    v_mul_f32 v3, v3, v5
    v_cvt_pk_bf16_f32 v2, v2, v3
    v_lshlrev_b32 v4, 16, v2
    v_and_b32 v5, 0xffff0000, v2
    v_add_f32 v4, v4, v5
    v_add_f32 v6, v6, v4
    s_nop 1
    v_add_f32_dpp v6, v6, v6 row_shr:1 row_mask:0xf bank_mask:0xf bound_ctrl:0
    s_nop 1
    v_add_f32_dpp v6, v6, v6 row_shr:2 row_mask:0xf bank_mask:0xf bound_ctrl:0
    s_nop 1
    v_add_f32_dpp v6, v6, v6 row_shr:4 row_mask:0xf bank_mask:0xf bound_ctrl:0
    s_nop 1
    v_add_f32_dpp v6, v6, v6 row_shr:8 row_mask:0xf bank_mask:0xf bound_ctrl:0
    s_nop 1
    v_readlane_b32 s26, v6, 15
    v_readlane_b32 s28, v6, 31
    v_readlane_b32 s29, v6, 47
    v_readlane_b32 s50, v6, 63
    s_nop 1
    v_mov_b32 v2, s26
    v_add_f32 v2, s28, v2
    v_add_f32 v2, s29, v2
    v_add_f32 v2, s50, v2
    v_cvt_pk_bf16_f32 v2, v2, v2
    v_lshlrev_b32 v2, 16, v2
    v_mul_f32 v2, 0xbfb8aa3b, v2
    v_exp_f32 v2, v2
    s_nop 0
    v_add_f32 v2, 1.0, v2
    v_rcp_f32 v2, v2
    s_nop 0
    v_cvt_pk_bf16_f32 v2, v2, v2
    v_lshlrev_b32 v8, 16, v2
    v_sub_f32 v3, 1.0, v8
    v_cvt_pk_bf16_f32 v3, v3, v3
    v_lshlrev_b32 v9, 16, v3
    s_lshl_b32 s26, s49, 3
    s_add_u32 s26, s26, 17563648
    v_mov_b32 v4, 0
    s_mov_b64 exec, 1
    buffer_store_dwordx2 v[8:9], v4, s[40:43], s26 offen
    s_mov_b64 exec, -1
    s_add_u32 s49, s49, 1
    s_waitcnt vmcnt(15)
    v_lshlrev_b32 v2, 16, v57
    v_and_b32 v3, 0xffff0000, v57
    v_lshlrev_b32 v4, 16, v24
    v_and_b32 v5, 0xffff0000, v24
    v_mul_f32 v2, v2, v4
    v_mul_f32 v3, v3, v5
    v_cvt_pk_bf16_f32 v2, v2, v3
    v_lshlrev_b32 v4, 16, v2
    v_and_b32 v5, 0xffff0000, v2
    v_add_f32 v6, v4, v5
    v_lshlrev_b32 v2, 16, v58
    v_and_b32 v3, 0xffff0000, v58
    v_lshlrev_b32 v4, 16, v25
    v_and_b32 v5, 0xffff0000, v25
    v_mul_f32 v2, v2, v4
    v_mul_f32 v3, v3, v5
    v_cvt_pk_bf16_f32 v2, v2, v3
    v_lshlrev_b32 v4, 16, v2
    v_and_b32 v5, 0xffff0000, v2
    v_add_f32 v4, v4, v5
    v_add_f32 v6, v6, v4
    v_lshlrev_b32 v2, 16, v59
    v_and_b32 v3, 0xffff0000, v59
    v_lshlrev_b32 v4, 16, v26
    v_and_b32 v5, 0xffff0000, v26
    v_mul_f32 v2, v2, v4
    v_mul_f32 v3, v3, v5
    v_cvt_pk_bf16_f32 v2, v2, v3
    v_lshlrev_b32 v4, 16, v2
    v_and_b32 v5, 0xffff0000, v2
    v_add_f32 v4, v4, v5
    v_add_f32 v6, v6, v4
    v_lshlrev_b32 v2, 16, v60
    v_and_b32 v3, 0xffff0000, v60
    v_lshlrev_b32 v4, 16, v27
    v_and_b32 v5, 0xffff0000, v27
    v_mul_f32 v2, v2, v4
    v_mul_f32 v3, v3, v5
    v_cvt_pk_bf16_f32 v2, v2, v3
    v_lshlrev_b32 v4, 16, v2
    v_and_b32 v5, 0xffff0000, v2
    v_add_f32 v4, v4, v5
    v_add_f32 v6, v6, v4
    v_lshlrev_b32 v2, 16, v61
    v_and_b32 v3, 0xffff0000, v61
    v_lshlrev_b32 v4, 16, v28
    v_and_b32 v5, 0xffff0000, v28
    v_mul_f32 v2, v2, v4
    v_mul_f32 v3, v3, v5
    v_cvt_pk_bf16_f32 v2, v2, v3
    v_lshlrev_b32 v4, 16, v2
    v_and_b32 v5, 0xffff0000, v2
    v_add_f32 v4, v4, v5
    v_add_f32 v6, v6, v4
    s_nop 1
    v_add_f32_dpp v6, v6, v6 row_shr:1 row_mask:0xf bank_mask:0xf bound_ctrl:0
    s_nop 1
    v_add_f32_dpp v6, v6, v6 row_shr:2 row_mask:0xf bank_mask:0xf bound_ctrl:0
    s_nop 1
    v_add_f32_dpp v6, v6, v6 row_shr:4 row_mask:0xf bank_mask:0xf bound_ctrl:0
    s_nop 1
    v_add_f32_dpp v6, v6, v6 row_shr:8 row_mask:0xf bank_mask:0xf bound_ctrl:0
    s_nop 1
    v_readlane_b32 s26, v6, 15
    v_readlane_b32 s28, v6, 31
    v_readlane_b32 s29, v6, 47
    v_readlane_b32 s50, v6, 63
    s_nop 1
    v_mov_b32 v2, s26
    v_add_f32 v2, s28, v2
    v_add_f32 v2, s29, v2
    v_add_f32 v2, s50, v2
    v_cvt_pk_bf16_f32 v2, v2, v2
    v_lshlrev_b32 v2, 16, v2
    v_mul_f32 v2, 0xbfb8aa3b, v2
    v_exp_f32 v2, v2
    s_nop 0
    v_add_f32 v2, 1.0, v2
    v_rcp_f32 v2, v2
    s_nop 0
    v_cvt_pk_bf16_f32 v2, v2, v2
    v_lshlrev_b32 v8, 16, v2
    v_sub_f32 v3, 1.0, v8
    v_cvt_pk_bf16_f32 v3, v3, v3
    v_lshlrev_b32 v9, 16, v3
    s_lshl_b32 s26, s49, 3
    s_add_u32 s26, s26, 17563648
    v_mov_b32 v4, 0
    s_mov_b64 exec, 1
    buffer_store_dwordx2 v[8:9], v4, s[40:43], s26 offen
    s_mov_b64 exec, -1
    s_add_u32 s49, s49, 1
    s_waitcnt vmcnt(11)
    v_lshlrev_b32 v2, 16, v62
    v_and_b32 v3, 0xffff0000, v62
    v_lshlrev_b32 v4, 16, v24
    v_and_b32 v5, 0xffff0000, v24
    v_mul_f32 v2, v2, v4
    v_mul_f32 v3, v3, v5
    v_cvt_pk_bf16_f32 v2, v2, v3
    v_lshlrev_b32 v4, 16, v2
    v_and_b32 v5, 0xffff0000, v2
    v_add_f32 v6, v4, v5
    v_lshlrev_b32 v2, 16, v63
    v_and_b32 v3, 0xffff0000, v63
    v_lshlrev_b32 v4, 16, v25
    v_and_b32 v5, 0xffff0000, v25
    v_mul_f32 v2, v2, v4
    v_mul_f32 v3, v3, v5
    v_cvt_pk_bf16_f32 v2, v2, v3
    v_lshlrev_b32 v4, 16, v2
    v_and_b32 v5, 0xffff0000, v2
    v_add_f32 v4, v4, v5
    v_add_f32 v6, v6, v4
    v_lshlrev_b32 v2, 16, v64
    v_and_b32 v3, 0xffff0000, v64
    v_lshlrev_b32 v4, 16, v26
    v_and_b32 v5, 0xffff0000, v26
    v_mul_f32 v2, v2, v4
    v_mul_f32 v3, v3, v5
    v_cvt_pk_bf16_f32 v2, v2, v3
    v_lshlrev_b32 v4, 16, v2
    v_and_b32 v5, 0xffff0000, v2
    v_add_f32 v4, v4, v5
    v_add_f32 v6, v6, v4
    v_lshlrev_b32 v2, 16, v65
    v_and_b32 v3, 0xffff0000, v65
    v_lshlrev_b32 v4, 16, v27
    v_and_b32 v5, 0xffff0000, v27
    v_mul_f32 v2, v2, v4
    v_mul_f32 v3, v3, v5
    v_cvt_pk_bf16_f32 v2, v2, v3
    v_lshlrev_b32 v4, 16, v2
    v_and_b32 v5, 0xffff0000, v2
    v_add_f32 v4, v4, v5
    v_add_f32 v6, v6, v4
    v_lshlrev_b32 v2, 16, v66
    v_and_b32 v3, 0xffff0000, v66
    v_lshlrev_b32 v4, 16, v28
    v_and_b32 v5, 0xffff0000, v28
    v_mul_f32 v2, v2, v4
    v_mul_f32 v3, v3, v5
    v_cvt_pk_bf16_f32 v2, v2, v3
    v_lshlrev_b32 v4, 16, v2
    v_and_b32 v5, 0xffff0000, v2
    v_add_f32 v4, v4, v5
    v_add_f32 v6, v6, v4
    s_nop 1
    v_add_f32_dpp v6, v6, v6 row_shr:1 row_mask:0xf bank_mask:0xf bound_ctrl:0
    s_nop 1
    v_add_f32_dpp v6, v6, v6 row_shr:2 row_mask:0xf bank_mask:0xf bound_ctrl:0
    s_nop 1
    v_add_f32_dpp v6, v6, v6 row_shr:4 row_mask:0xf bank_mask:0xf bound_ctrl:0
    s_nop 1
    v_add_f32_dpp v6, v6, v6 row_shr:8 row_mask:0xf bank_mask:0xf bound_ctrl:0
    s_nop 1
    v_readlane_b32 s26, v6, 15
    v_readlane_b32 s28, v6, 31
    v_readlane_b32 s29, v6, 47
    v_readlane_b32 s50, v6, 63
    s_nop 1
    v_mov_b32 v2, s26
    v_add_f32 v2, s28, v2
    v_add_f32 v2, s29, v2
    v_add_f32 v2, s50, v2
    v_cvt_pk_bf16_f32 v2, v2, v2
    v_lshlrev_b32 v2, 16, v2
    v_mul_f32 v2, 0xbfb8aa3b, v2
    v_exp_f32 v2, v2
    s_nop 0
    v_add_f32 v2, 1.0, v2
    v_rcp_f32 v2, v2
    s_nop 0
    v_cvt_pk_bf16_f32 v2, v2, v2
    v_lshlrev_b32 v8, 16, v2
    v_sub_f32 v3, 1.0, v8
    v_cvt_pk_bf16_f32 v3, v3, v3
    v_lshlrev_b32 v9, 16, v3
    s_lshl_b32 s26, s49, 3
    s_add_u32 s26, s26, 17563648
    v_mov_b32 v4, 0
    s_mov_b64 exec, 1
    buffer_store_dwordx2 v[8:9], v4, s[40:43], s26 offen
    s_mov_b64 exec, -1
    s_add_u32 s49, s49, 1
    s_waitcnt vmcnt(7)
    v_lshlrev_b32 v2, 16, v67
    v_and_b32 v3, 0xffff0000, v67
    v_lshlrev_b32 v4, 16, v24
    v_and_b32 v5, 0xffff0000, v24
    v_mul_f32 v2, v2, v4
    v_mul_f32 v3, v3, v5
    v_cvt_pk_bf16_f32 v2, v2, v3
    v_lshlrev_b32 v4, 16, v2
    v_and_b32 v5, 0xffff0000, v2
    v_add_f32 v6, v4, v5
    v_lshlrev_b32 v2, 16, v68
    v_and_b32 v3, 0xffff0000, v68
    v_lshlrev_b32 v4, 16, v25
    v_and_b32 v5, 0xffff0000, v25
    v_mul_f32 v2, v2, v4
    v_mul_f32 v3, v3, v5
    v_cvt_pk_bf16_f32 v2, v2, v3
    v_lshlrev_b32 v4, 16, v2
    v_and_b32 v5, 0xffff0000, v2
    v_add_f32 v4, v4, v5
    v_add_f32 v6, v6, v4
    v_lshlrev_b32 v2, 16, v69
    v_and_b32 v3, 0xffff0000, v69
    v_lshlrev_b32 v4, 16, v26
    v_and_b32 v5, 0xffff0000, v26
    v_mul_f32 v2, v2, v4
    v_mul_f32 v3, v3, v5
    v_cvt_pk_bf16_f32 v2, v2, v3
    v_lshlrev_b32 v4, 16, v2
    v_and_b32 v5, 0xffff0000, v2
    v_add_f32 v4, v4, v5
    v_add_f32 v6, v6, v4
    v_lshlrev_b32 v2, 16, v70
    v_and_b32 v3, 0xffff0000, v70
    v_lshlrev_b32 v4, 16, v27
    v_and_b32 v5, 0xffff0000, v27
    v_mul_f32 v2, v2, v4
    v_mul_f32 v3, v3, v5
    v_cvt_pk_bf16_f32 v2, v2, v3
    v_lshlrev_b32 v4, 16, v2
    v_and_b32 v5, 0xffff0000, v2
    v_add_f32 v4, v4, v5
    v_add_f32 v6, v6, v4
    v_lshlrev_b32 v2, 16, v71
    v_and_b32 v3, 0xffff0000, v71
    v_lshlrev_b32 v4, 16, v28
    v_and_b32 v5, 0xffff0000, v28
    v_mul_f32 v2, v2, v4
    v_mul_f32 v3, v3, v5
    v_cvt_pk_bf16_f32 v2, v2, v3
    v_lshlrev_b32 v4, 16, v2
    v_and_b32 v5, 0xffff0000, v2
    v_add_f32 v4, v4, v5
    v_add_f32 v6, v6, v4
    s_nop 1
    v_add_f32_dpp v6, v6, v6 row_shr:1 row_mask:0xf bank_mask:0xf bound_ctrl:0
    s_nop 1
    v_add_f32_dpp v6, v6, v6 row_shr:2 row_mask:0xf bank_mask:0xf bound_ctrl:0
    s_nop 1
    v_add_f32_dpp v6, v6, v6 row_shr:4 row_mask:0xf bank_mask:0xf bound_ctrl:0
    s_nop 1
    v_add_f32_dpp v6, v6, v6 row_shr:8 row_mask:0xf bank_mask:0xf bound_ctrl:0
    s_nop 1
    v_readlane_b32 s26, v6, 15
    v_readlane_b32 s28, v6, 31
    v_readlane_b32 s29, v6, 47
    v_readlane_b32 s50, v6, 63
    s_nop 1
    v_mov_b32 v2, s26
    v_add_f32 v2, s28, v2
    v_add_f32 v2, s29, v2
    v_add_f32 v2, s50, v2
    v_cvt_pk_bf16_f32 v2, v2, v2
    v_lshlrev_b32 v2, 16, v2
    v_mul_f32 v2, 0xbfb8aa3b, v2
    v_exp_f32 v2, v2
    s_nop 0
    v_add_f32 v2, 1.0, v2
    v_rcp_f32 v2, v2
    s_nop 0
    v_cvt_pk_bf16_f32 v2, v2, v2
    v_lshlrev_b32 v8, 16, v2
    v_sub_f32 v3, 1.0, v8
    v_cvt_pk_bf16_f32 v3, v3, v3
    v_lshlrev_b32 v9, 16, v3
    s_lshl_b32 s26, s49, 3
    s_add_u32 s26, s26, 17563648
    v_mov_b32 v4, 0
    s_mov_b64 exec, 1
    buffer_store_dwordx2 v[8:9], v4, s[40:43], s26 offen
    s_mov_b64 exec, -1
    s_add_u32 s49, s49, 1
k1_kernel_FIN:
k1_kernel_END:
    s_endpgm
.section .rodata,"a"
.p2align 6
.amdhsa_kernel k1_kernel
  .amdhsa_next_free_vgpr 168
  .amdhsa_next_free_sgpr 102
  .amdhsa_accum_offset 168
  .amdhsa_group_segment_fixed_size 0
  .amdhsa_kernarg_size 88
  .amdhsa_user_sgpr_count 2
  .amdhsa_user_sgpr_kernarg_segment_ptr 1
  .amdhsa_system_sgpr_workgroup_id_x 1
  .amdhsa_float_denorm_mode_32 3
.end_amdhsa_kernel
.text
.globl k2_kernel
.p2align 8
.type k2_kernel,@function
k2_kernel:
    s_cmp_ge_u32 s2, 256
    s_cbranch_scc1 k2_kernel_END
    s_load_dwordx2 s[4:5], s[0:1], 80
    s_load_dwordx2 s[6:7], s[0:1], 48
    s_load_dwordx2 s[8:9], s[0:1], 16
    s_load_dwordx2 s[10:11], s[0:1], 64
    v_and_b32 v1, 63, v0
    v_lshrrev_b32 v2, 6, v0
    s_and_b32 s12, s2, 7
    s_lshr_b32 s13, s2, 3
    v_readfirstlane_b32 s16, v2
    s_lshr_b32 s19, s13, 3
    s_lshl_b32 s14, s12, 2
    s_add_u32 s14, s14, s19
    s_and_b32 s15, s13, 7
    v_lshlrev_b32 v10, 4, v1
    s_mul_i32 s44, s14, 163840
    s_add_u32 s44, s44, 2621440
    s_cmp_ge_u32 s16, 8
    s_cbranch_scc1 k2_kernel_GW
    s_and_b32 s17, s16, 3
    s_lshr_b32 s18, s16, 2
    s_mul_i32 s19, s18, 81920
    s_add_u32 s44, s44, s19
    s_lshl_b32 s19, s17, 10
    s_add_u32 s44, s44, s19
    s_mul_i32 s20, s18, 10240
    s_add_u32 s37, s20, s19
    s_add_u32 s38, s37, 4096
    s_add_u32 s39, s37, 8192
    s_cmp_lt_u32 s17, 2
    s_cselect_b32 s19, 0, 0x7f000000
    v_add_u32 v11, s19, v10
    s_mov_b32 s36, s44
    s_mov_b32 s40, 0
    s_lshl_b32 s45, s15, 3
    s_lshl_b32 s19, s17, 1
    s_add_u32 s45, s45, s19
    s_waitcnt lgkmcnt(0)
    s_mov_b32 s24, s4
    s_and_b32 s25, s5, 0xffff
    s_mov_b32 s26, 268435456
    s_mov_b32 s27, 0x20000
    s_add_u32 m0, s40, s37
    s_add_u32 s19, s36, 4096
    buffer_load_dwordx4 v10, s[24:27], s36 offen lds
    s_add_u32 m0, s40, s38
    s_add_u32 s20, s36, 8192
    buffer_load_dwordx4 v10, s[24:27], s19 offen lds
    s_add_u32 s19, s40, s39
    s_cmp_lt_u32 s17, 2
    s_cselect_b32 m0, s19, 61440
    s_add_u32 s36, s36, 10240
    buffer_load_dwordx4 v11, s[24:27], s20 offen lds
    s_add_u32 s40, s40, 20480
    s_cmp_eq_u32 s40, 61440
    s_cselect_b32 s40, 0, s40
    s_mul_i32 s21, s14, 81920
    s_mul_i32 s20, s45, 1280
    s_add_u32 s21, s21, s20
    s_add_u32 s22, s21, 1280
    v_and_b32 v2, 31, v1
    v_lshlrev_b32 v3, 3, v2
    s_mov_b32 s28, -1
    s_mov_b32 s29, 0
    v_mov_b32 v36, 0
    v_mov_b32 v37, 0
    v_mov_b32 v38, 0
    v_mov_b32 v39, 0
    buffer_load_dwordx4 v[28:31], v10, s[24:27], s21 offen
    buffer_load_dwordx4 v[32:35], v10, s[24:27], s22 offen
    s_mov_b64 exec, s[28:29]
    buffer_load_dwordx2 v[36:37], v3, s[24:27], s21 offen offset:1024
    buffer_load_dwordx2 v[38:39], v3, s[24:27], s22 offen offset:1024
    s_mov_b64 exec, -1
    v_mov_b32 v23, v3
    s_mov_b32 s43, 0
    s_mov_b32 s30, 0xfffff
    s_mov_b32 s31, 0xfffff
    s_mul_i32 s19, s18, 10240
    v_add_u32 v12, s19, v10
    v_add_u32 v13, s19, v3
    v_lshrrev_b32 v4, 5, v1
    v_mul_u32_u24 v9, 320, v4
    v_lshl_add_u32 v9, v2, 4, v9
    v_add_u32 v14, s19, v9
    v_mov_b32 v7, 5
    v_mov_b32 v8, 4
    v_cmp_eq_u32 vcc, 20, v2
    v_mov_b32 v6, 12
    s_nop 0
    v_cndmask_b32 v7, v7, v8, vcc
    v_cmp_lt_u32 vcc, 27, v2
    v_mul_u32_u24 v8, 320, v4
    s_nop 0
    v_cndmask_b32 v7, v7, v6, vcc
    v_lshl_add_u32 v7, v7, 4, v8
    v_add_u32 v7, 61440, v7
    v_cmp_lt_u32 vcc, 19, v2
    v_mov_b32 v6, 1
    v_mov_b32 v8, 0
    v_cndmask_b32 v14, v14, v7, vcc
    v_cndmask_b32 v24, v6, v8, vcc
    v_cmp_eq_u32 vcc, 20, v2
    v_mov_b32 v5, 0
    v_mov_b32 v6, 0x3f803f80
    v_cndmask_b32 v5, v5, v6, vcc
    v_mov_b32 v48, v5
    v_mov_b32 v52, v5
    v_mov_b32 v49, v5
    v_mov_b32 v53, v5
    v_mov_b32 v50, v5
    v_mov_b32 v54, v5
    v_mov_b32 v51, v5
    v_mov_b32 v55, v5
    v_mov_b32 v44, 0
    v_mov_b32 v45, 0
    v_mov_b32 v5, 0
    v_mov_b32 v6, 62464
    ds_write_b32 v6, v5
    s_add_u32 s46, s45, s18
    s_mul_i32 s46, s46, 40960
    s_add_u32 s46, s46, 14942208
    s_mul_i32 s20, s14, 5
    v_add_u32 v4, s20, v4
    v_lshlrev_b32 v5, 4, v2
    v_lshlrev_b32 v5, 3, v2
    v_add_u32 v6, 0, v4
    v_lshl_add_u32 v20, v6, 8, v5
    v_add_u32 v6, 2, v4
    v_lshl_add_u32 v21, v6, 8, v5
    v_add_u32 v6, 4, v4
    v_lshl_add_u32 v22, v6, 8, v5
    v_mul_u32_u24 v3, 21846, v1
    v_lshrrev_b32 v3, 16, v3
    v_mul_u32_u24 v4, 3, v3
    v_sub_u32 v4, v1, v4
    v_and_b32 v5, 1, v3
    v_mul_u32_u24 v5, 320, v5
    v_bfe_u32 v6, v3, 1, 1
    v_mul_u32_u24 v6, 640, v6
    v_lshrrev_b32 v3, 2, v3
    v_mul_u32_u24 v3, 2560, v3
    v_add3_u32 v3, v3, v5, v6
    v_mov_b32 v5, 4
    v_mov_b32 v6, 5
    v_cmp_eq_u32 vcc, 1, v4
    v_mov_b32 v7, 12
    v_mov_b32 v8, 0x3f803f80
    v_cndmask_b32 v5, v5, v6, vcc
    v_cmp_eq_u32 vcc, 2, v4
    v_mov_b32 v6, 0
    s_nop 0
    v_cndmask_b32 v5, v5, v7, vcc
    v_cmp_eq_u32 vcc, 0, v4
    v_lshl_add_u32 v3, v5, 4, v3
    v_add_u32 v3, 62720, v3
    v_cndmask_b32 v128, v6, v8, vcc
    v_cndmask_b32 v129, v6, v8, vcc
    v_cndmask_b32 v130, v6, v8, vcc
    v_cndmask_b32 v131, v6, v8, vcc
    s_mov_b32 exec_lo, -1
    s_mov_b32 exec_hi, 0xffff
    ds_write_b128 v3, v[128:131]
    s_mov_b64 exec, -1
    v_mov_b32 v88, 0
    v_mov_b32 v89, 0
    v_mov_b32 v90, 0
    v_mov_b32 v91, 0
    v_mov_b32 v92, 0
    v_mov_b32 v93, 0
    v_mov_b32 v94, 0
    v_mov_b32 v95, 0
    v_mov_b32 v96, 0
    v_mov_b32 v97, 0
    v_mov_b32 v98, 0
    v_mov_b32 v99, 0
    v_mov_b32 v100, 0
    v_mov_b32 v101, 0
    v_mov_b32 v102, 0
    v_mov_b32 v103, 0
    v_mov_b32 v104, 0
    v_mov_b32 v105, 0
    v_mov_b32 v106, 0
    v_mov_b32 v107, 0
    v_mov_b32 v108, 0
    v_mov_b32 v109, 0
    v_mov_b32 v110, 0
    v_mov_b32 v111, 0
    v_mov_b32 v112, 0
    v_mov_b32 v113, 0
    v_mov_b32 v114, 0
    v_mov_b32 v115, 0
    v_mov_b32 v116, 0
    v_mov_b32 v117, 0
    v_mov_b32 v118, 0
    v_mov_b32 v119, 0
    v_mov_b32 v124, 0
    v_mov_b32 v128, 0
    v_mov_b32 v125, 0
    v_mov_b32 v129, 0
    v_mov_b32 v126, 0
    v_mov_b32 v130, 0
    v_mov_b32 v127, 0
    v_mov_b32 v131, 0
    s_mov_b32 s41, 0
    s_mov_b32 s42, 0
    v_mov_b32 v15, v12
    v_mov_b32 v16, v13
    v_mov_b32 v17, v14
    s_waitcnt vmcnt(0) lgkmcnt(0)
    s_barrier
    ds_read_b64 v[44:45], v16 offset:1024
    ds_read_b128 v[40:43], v15 offset:0
    ds_read_b128 v[48:51], v17 offset:1280
    s_add_u32 m0, s40, s37
    s_add_u32 s19, s36, 4096
    buffer_load_dwordx4 v10, s[24:27], s36 offen lds
    s_add_u32 m0, s40, s38
    s_add_u32 s20, s36, 8192
    buffer_load_dwordx4 v10, s[24:27], s19 offen lds
    s_add_u32 s19, s40, s39
    s_cmp_lt_u32 s17, 2
    s_cselect_b32 m0, s19, 61440
    s_add_u32 s36, s36, 10240
    buffer_load_dwordx4 v11, s[24:27], s20 offen lds
    s_add_u32 s40, s40, 20480
    s_cmp_eq_u32 s40, 61440
    s_cselect_b32 s40, 0, s40
    s_lshl_b32 s21, s45, 8
    s_add_u32 s21, s21, 17563648
    buffer_load_dword v18, v23, s[24:27], s21 offen
    buffer_load_dword v19, v23, s[24:27], s21 offen offset:256
    s_waitcnt lgkmcnt(1)
    v_mfma_f32_32x32x16_bf16 v[56:71], v[40:43], v[28:31], 0
    v_mfma_f32_32x32x8_bf16 v[56:71], v[44:45], v[36:37], v[56:71]
    s_nop 7
    s_nop 3
k2_kernel_LOOP:
    v_mfma_f32_32x32x16_bf16 v[72:87], v[40:43], v[32:35], 0
    v_exp_f32 v56, v56
    v_cvt_pk_bf16_f32 v126, v128, v129
    v_exp_f32 v57, v57
    v_cvt_pk_bf16_f32 v127, v130, v131
    v_exp_f32 v58, v58
    v_exp_f32 v59, v59
    v_mfma_f32_32x32x8_bf16 v[72:87], v[44:45], v[38:39], v[72:87]
    ds_read_b64 v[44:45], v16 offset:3584
    ds_read_b128 v[40:43], v15 offset:2560
    v_exp_f32 v60, v60
    v_exp_f32 v61, v61
    v_cvt_pk_bf16_f32 v120, v56, v57
    v_exp_f32 v62, v62
    v_exp_f32 v63, v63
    v_cvt_pk_bf16_f32 v121, v58, v59
    v_mfma_f32_32x32x16_bf16 v[104:119], v[52:55], v[124:127], v[104:119]
    ds_read_b128 v[52:55], v17 offset:1920
    v_exp_f32 v64, v64
    v_cvt_pk_bf16_f32 v122, v60, v61
    v_exp_f32 v65, v65
    v_cvt_pk_bf16_f32 v123, v62, v63
    v_exp_f32 v66, v66
    v_exp_f32 v67, v67
    s_waitcnt lgkmcnt(3)
    v_mfma_f32_32x32x16_bf16 v[88:103], v[48:51], v[120:123], v[88:103]
    v_exp_f32 v128, v68
    v_exp_f32 v129, v69
    v_cvt_pk_bf16_f32 v124, v64, v65
    v_exp_f32 v130, v70
    v_exp_f32 v131, v71
    v_cvt_pk_bf16_f32 v125, v66, v67
    s_waitcnt lgkmcnt(1)
    v_mfma_f32_32x32x16_bf16 v[56:71], v[40:43], v[28:31], 0
    v_exp_f32 v72, v72
    v_cvt_pk_bf16_f32 v126, v128, v129
    v_exp_f32 v73, v73
    v_cvt_pk_bf16_f32 v127, v130, v131
    v_exp_f32 v74, v74
    v_exp_f32 v75, v75
    v_mfma_f32_32x32x8_bf16 v[56:71], v[44:45], v[36:37], v[56:71]
    v_exp_f32 v76, v76
    v_exp_f32 v77, v77
    v_cvt_pk_bf16_f32 v120, v72, v73
    v_exp_f32 v78, v78
    v_exp_f32 v79, v79
    v_cvt_pk_bf16_f32 v121, v74, v75
    s_waitcnt lgkmcnt(0)
    v_mfma_f32_32x32x16_bf16 v[88:103], v[52:55], v[124:127], v[88:103]
    v_exp_f32 v80, v80
    v_cvt_pk_bf16_f32 v122, v76, v77
    v_exp_f32 v81, v81
    v_cvt_pk_bf16_f32 v123, v78, v79
    v_exp_f32 v82, v82
    v_exp_f32 v83, v83
    v_mfma_f32_32x32x16_bf16 v[104:119], v[48:51], v[120:123], v[104:119]
    ds_read_b128 v[48:51], v17 offset:3840
    v_exp_f32 v128, v84
    v_exp_f32 v129, v85
    v_cvt_pk_bf16_f32 v124, v80, v81
    v_exp_f32 v130, v86
    v_exp_f32 v131, v87
    v_cvt_pk_bf16_f32 v125, v82, v83
    v_mfma_f32_32x32x16_bf16 v[72:87], v[40:43], v[32:35], 0
    v_exp_f32 v56, v56
    v_cvt_pk_bf16_f32 v126, v128, v129
    v_exp_f32 v57, v57
    v_cvt_pk_bf16_f32 v127, v130, v131
    v_exp_f32 v58, v58
    v_exp_f32 v59, v59
    v_mfma_f32_32x32x8_bf16 v[72:87], v[44:45], v[38:39], v[72:87]
    ds_read_b64 v[44:45], v16 offset:6144
    ds_read_b128 v[40:43], v15 offset:5120
    v_exp_f32 v60, v60
    v_exp_f32 v61, v61
    v_cvt_pk_bf16_f32 v120, v56, v57
    v_exp_f32 v62, v62
    v_exp_f32 v63, v63
    v_cvt_pk_bf16_f32 v121, v58, v59
    v_mfma_f32_32x32x16_bf16 v[104:119], v[52:55], v[124:127], v[104:119]
    ds_read_b128 v[52:55], v17 offset:4480
    v_exp_f32 v64, v64
    v_cvt_pk_bf16_f32 v122, v60, v61
    v_exp_f32 v65, v65
    v_cvt_pk_bf16_f32 v123, v62, v63
    v_exp_f32 v66, v66
    v_exp_f32 v67, v67
    s_waitcnt lgkmcnt(3)
    v_mfma_f32_32x32x16_bf16 v[88:103], v[48:51], v[120:123], v[88:103]
    v_exp_f32 v128, v68
    v_exp_f32 v129, v69
    v_cvt_pk_bf16_f32 v124, v64, v65
    v_exp_f32 v130, v70
    v_exp_f32 v131, v71
    v_cvt_pk_bf16_f32 v125, v66, v67
    s_waitcnt lgkmcnt(1)
    v_mfma_f32_32x32x16_bf16 v[56:71], v[40:43], v[28:31], 0
    v_exp_f32 v72, v72
    v_cvt_pk_bf16_f32 v126, v128, v129
    v_exp_f32 v73, v73
    v_cvt_pk_bf16_f32 v127, v130, v131
    v_exp_f32 v74, v74
    v_exp_f32 v75, v75
    v_mfma_f32_32x32x8_bf16 v[56:71], v[44:45], v[36:37], v[56:71]
    v_exp_f32 v76, v76
    v_exp_f32 v77, v77
    v_cvt_pk_bf16_f32 v120, v72, v73
    v_exp_f32 v78, v78
    v_exp_f32 v79, v79
    v_cvt_pk_bf16_f32 v121, v74, v75
    s_waitcnt lgkmcnt(0)
    v_mfma_f32_32x32x16_bf16 v[88:103], v[52:55], v[124:127], v[88:103]
    v_exp_f32 v80, v80
    v_cvt_pk_bf16_f32 v122, v76, v77
    v_exp_f32 v81, v81
    v_cvt_pk_bf16_f32 v123, v78, v79
    v_exp_f32 v82, v82
    v_exp_f32 v83, v83
    v_mfma_f32_32x32x16_bf16 v[104:119], v[48:51], v[120:123], v[104:119]
    ds_read_b128 v[48:51], v17 offset:6400
    v_exp_f32 v128, v84
    v_exp_f32 v129, v85
    v_cvt_pk_bf16_f32 v124, v80, v81
    v_exp_f32 v130, v86
    v_exp_f32 v131, v87
    v_cvt_pk_bf16_f32 v125, v82, v83
    v_mfma_f32_32x32x16_bf16 v[72:87], v[40:43], v[32:35], 0
    v_exp_f32 v56, v56
    v_cvt_pk_bf16_f32 v126, v128, v129
    v_exp_f32 v57, v57
    v_cvt_pk_bf16_f32 v127, v130, v131
    v_exp_f32 v58, v58
    v_exp_f32 v59, v59
    v_mfma_f32_32x32x8_bf16 v[72:87], v[44:45], v[38:39], v[72:87]
    ds_read_b64 v[44:45], v16 offset:8704
    ds_read_b128 v[40:43], v15 offset:7680
    v_exp_f32 v60, v60
    v_exp_f32 v61, v61
    v_cvt_pk_bf16_f32 v120, v56, v57
    v_exp_f32 v62, v62
    v_exp_f32 v63, v63
    v_cvt_pk_bf16_f32 v121, v58, v59
    v_mfma_f32_32x32x16_bf16 v[104:119], v[52:55], v[124:127], v[104:119]
    ds_read_b128 v[52:55], v17 offset:7040
    v_exp_f32 v64, v64
    v_cvt_pk_bf16_f32 v122, v60, v61
    v_exp_f32 v65, v65
    v_cvt_pk_bf16_f32 v123, v62, v63
    v_exp_f32 v66, v66
    v_exp_f32 v67, v67
    s_waitcnt lgkmcnt(3)
    v_mfma_f32_32x32x16_bf16 v[88:103], v[48:51], v[120:123], v[88:103]
    v_exp_f32 v128, v68
    v_exp_f32 v129, v69
    v_cvt_pk_bf16_f32 v124, v64, v65
    v_exp_f32 v130, v70
    v_exp_f32 v131, v71
    v_cvt_pk_bf16_f32 v125, v66, v67
    s_waitcnt lgkmcnt(1)
    v_mfma_f32_32x32x16_bf16 v[56:71], v[40:43], v[28:31], 0
    v_exp_f32 v72, v72
    v_cvt_pk_bf16_f32 v126, v128, v129
    v_exp_f32 v73, v73
    v_cvt_pk_bf16_f32 v127, v130, v131
    v_exp_f32 v74, v74
    v_exp_f32 v75, v75
    v_mfma_f32_32x32x8_bf16 v[56:71], v[44:45], v[36:37], v[56:71]
    v_exp_f32 v76, v76
    v_exp_f32 v77, v77
    v_cvt_pk_bf16_f32 v120, v72, v73
    v_exp_f32 v78, v78
    v_exp_f32 v79, v79
    v_cvt_pk_bf16_f32 v121, v74, v75
    s_waitcnt lgkmcnt(0)
    v_mfma_f32_32x32x16_bf16 v[88:103], v[52:55], v[124:127], v[88:103]
    v_exp_f32 v80, v80
    v_cvt_pk_bf16_f32 v122, v76, v77
    v_exp_f32 v81, v81
    v_cvt_pk_bf16_f32 v123, v78, v79
    v_exp_f32 v82, v82
    v_exp_f32 v83, v83
    v_mfma_f32_32x32x16_bf16 v[104:119], v[48:51], v[120:123], v[104:119]
    ds_read_b128 v[48:51], v17 offset:8960
    v_exp_f32 v128, v84
    v_exp_f32 v129, v85
    v_cvt_pk_bf16_f32 v124, v80, v81
    v_exp_f32 v130, v86
    v_exp_f32 v131, v87
    v_cvt_pk_bf16_f32 v125, v82, v83
    v_mfma_f32_32x32x16_bf16 v[72:87], v[40:43], v[32:35], 0
    v_exp_f32 v56, v56
    v_cvt_pk_bf16_f32 v126, v128, v129
    v_exp_f32 v57, v57
    v_cvt_pk_bf16_f32 v127, v130, v131
    v_exp_f32 v58, v58
    v_exp_f32 v59, v59
    v_mfma_f32_32x32x8_bf16 v[72:87], v[44:45], v[38:39], v[72:87]
    s_waitcnt vmcnt(0)
    s_barrier
    s_add_u32 s41, s41, 20480
    s_cmp_eq_u32 s41, 61440
    s_cselect_b32 s41, 0, s41
    v_add_u32 v15, s41, v12
    v_add_u32 v16, s41, v13
    ds_read_b64 v[44:45], v16 offset:1024
    ds_read_b128 v[40:43], v15 offset:0
    v_exp_f32 v60, v60
    v_exp_f32 v61, v61
    v_cvt_pk_bf16_f32 v120, v56, v57
    v_exp_f32 v62, v62
    v_exp_f32 v63, v63
    v_cvt_pk_bf16_f32 v121, v58, v59
    v_mfma_f32_32x32x16_bf16 v[104:119], v[52:55], v[124:127], v[104:119]
    ds_read_b128 v[52:55], v17 offset:9600
    v_mad_u32_u24 v17, v24, s41, v14
    v_exp_f32 v64, v64
    v_cvt_pk_bf16_f32 v122, v60, v61
    v_exp_f32 v65, v65
    v_cvt_pk_bf16_f32 v123, v62, v63
    v_exp_f32 v66, v66
    v_exp_f32 v67, v67
    s_waitcnt lgkmcnt(3)
    v_mfma_f32_32x32x16_bf16 v[88:103], v[48:51], v[120:123], v[88:103]
    v_exp_f32 v128, v68
    v_exp_f32 v129, v69
    v_cvt_pk_bf16_f32 v124, v64, v65
    v_exp_f32 v130, v70
    v_exp_f32 v131, v71
    v_cvt_pk_bf16_f32 v125, v66, v67
    s_cmp_ge_u32 s42, 6
    s_cbranch_scc1 k2_kernel_LOOP_NODMA
    s_add_u32 m0, s40, s37
    s_add_u32 s19, s36, 4096
    buffer_load_dwordx4 v10, s[24:27], s36 offen lds
    s_add_u32 m0, s40, s38
    s_add_u32 s20, s36, 8192
    buffer_load_dwordx4 v10, s[24:27], s19 offen lds
    s_add_u32 s19, s40, s39
    s_cmp_lt_u32 s17, 2
    s_cselect_b32 m0, s19, 61440
    s_add_u32 s36, s36, 10240
    buffer_load_dwordx4 v11, s[24:27], s20 offen lds
    s_add_u32 s40, s40, 20480
    s_cmp_eq_u32 s40, 61440
    s_cselect_b32 s40, 0, s40
k2_kernel_LOOP_NODMA:
    s_waitcnt lgkmcnt(1)
    v_mfma_f32_32x32x16_bf16 v[56:71], v[40:43], v[28:31], 0
    v_exp_f32 v72, v72
    v_cvt_pk_bf16_f32 v126, v128, v129
    v_exp_f32 v73, v73
    v_cvt_pk_bf16_f32 v127, v130, v131
    v_exp_f32 v74, v74
    v_exp_f32 v75, v75
    v_mfma_f32_32x32x8_bf16 v[56:71], v[44:45], v[36:37], v[56:71]
    v_exp_f32 v76, v76
    v_exp_f32 v77, v77
    v_cvt_pk_bf16_f32 v120, v72, v73
    v_exp_f32 v78, v78
    v_exp_f32 v79, v79
    v_cvt_pk_bf16_f32 v121, v74, v75
    s_waitcnt lgkmcnt(0)
    v_mfma_f32_32x32x16_bf16 v[88:103], v[52:55], v[124:127], v[88:103]
    v_exp_f32 v80, v80
    v_cvt_pk_bf16_f32 v122, v76, v77
    v_exp_f32 v81, v81
    v_cvt_pk_bf16_f32 v123, v78, v79
    v_exp_f32 v82, v82
    v_exp_f32 v83, v83
    v_mfma_f32_32x32x16_bf16 v[104:119], v[48:51], v[120:123], v[104:119]
    ds_read_b128 v[48:51], v17 offset:1280
    v_exp_f32 v128, v84
    v_exp_f32 v129, v85
    v_cvt_pk_bf16_f32 v124, v80, v81
    v_exp_f32 v130, v86
    v_exp_f32 v131, v87
    v_cvt_pk_bf16_f32 v125, v82, v83
    s_add_u32 s42, s42, 1
    s_cmp_lt_u32 s42, 8
    s_cbranch_scc1 k2_kernel_LOOP
    v_cvt_pk_bf16_f32 v126, v128, v129
    v_cvt_pk_bf16_f32 v127, v130, v131
    s_waitcnt lgkmcnt(0)
    s_nop 0
    v_mfma_f32_32x32x16_bf16 v[104:119], v[52:55], v[124:127], v[104:119]
k2_kernel_EPI:
    s_mul_i32 s19, s17, 3072
    s_mul_i32 s20, s18, 40960
    s_add_u32 s21, s19, s20
    v_add_u32 v6, s21, v10
    s_sub_u32 s20, 40960, s20
    s_add_u32 s21, s19, s20
    v_add_u32 v8, s21, v10
    v_mov_b32 v3, 0x7f800000
    v_mov_b32 v4, 0x5f000000
    v_mov_b32 v5, 0x20000000
    v_mov_b32 v7, 62464
    s_nop 3
    s_cmp_eq_u32 s18, 0
    s_cbranch_scc1 k2_kernel_NOSWAP
    v_swap_b32 v88, v104
    v_swap_b32 v89, v105
    v_swap_b32 v90, v106
    v_swap_b32 v91, v107
    v_swap_b32 v92, v108
    v_swap_b32 v93, v109
    v_swap_b32 v94, v110
    v_swap_b32 v95, v111
    v_swap_b32 v96, v112
    v_swap_b32 v97, v113
    v_swap_b32 v98, v114
    v_swap_b32 v99, v115
    v_swap_b32 v18, v19
k2_kernel_NOSWAP:
    ds_write_b128 v6, v[104:107] offset:0
    ds_write_b128 v6, v[108:111] offset:1024
    ds_write_b128 v6, v[112:115] offset:2048
    v_add_f32 v2, |v88|, |v104|
    v_add_f32 v2, |v89|, v2
    v_add_f32 v2, |v105|, v2
    v_add_f32 v2, |v90|, v2
    v_add_f32 v2, |v106|, v2
    v_add_f32 v2, |v91|, v2
    v_add_f32 v2, |v107|, v2
    v_add_f32 v2, |v92|, v2
    v_add_f32 v2, |v108|, v2
    v_add_f32 v2, |v93|, v2
    v_add_f32 v2, |v109|, v2
    v_add_f32 v2, |v94|, v2
    v_add_f32 v2, |v110|, v2
    v_add_f32 v2, |v95|, v2
    v_add_f32 v2, |v111|, v2
    v_add_f32 v2, |v96|, v2
    v_add_f32 v2, |v112|, v2
    v_add_f32 v2, |v97|, v2
    v_add_f32 v2, |v113|, v2
    v_add_f32 v2, |v98|, v2
    v_add_f32 v2, |v114|, v2
    v_add_f32 v2, |v99|, v2
    v_add_f32 v2, |v115|, v2
    v_min_f32 v9, v96, v112
    v_cmp_nlt_f32 s[32:33], v2, v3
    v_max_f32 v2, v96, v112
    v_cmp_nge_f32 s[34:35], v9, v5
    v_cmp_nle_f32 vcc, v2, v4
    s_nop 3
    s_or_b64 s[34:35], s[34:35], vcc
    s_andn2_b64 s[34:35], s[34:35], s[28:29]
    s_or_b64 s[32:33], s[32:33], s[34:35]
    s_cmp_eq_u64 s[32:33], 0
    s_cbranch_scc1 k2_kernel_SAFE
    v_mov_b32 v5, 1
    ds_write_b32 v7, v5
k2_kernel_SAFE:
    s_waitcnt lgkmcnt(0)
    s_barrier
    ds_read_b32 v5, v7
    ds_read_b128 v[56:59], v8 offset:0
    ds_read_b128 v[60:63], v8 offset:1024
    ds_read_b128 v[64:67], v8 offset:2048
    s_waitcnt lgkmcnt(3)
    v_readfirstlane_b32 s19, v5
    s_nop 3
    s_cmp_eq_u32 s43, 0
    s_cselect_b32 s19, s19, 0
    s_cmp_eq_u32 s19, 0
    s_cbranch_scc0 k2_kernel_FALLBACK
    s_waitcnt vmcnt(0) lgkmcnt(0)
    v_add_f32 v88, v88, v56
    v_add_f32 v89, v89, v57
    v_add_f32 v90, v90, v58
    v_add_f32 v91, v91, v59
    v_add_f32 v92, v92, v60
    v_add_f32 v93, v93, v61
    v_add_f32 v94, v94, v62
    v_add_f32 v95, v95, v63
    v_add_f32 v96, v96, v64
    v_add_f32 v97, v97, v65
    v_add_f32 v98, v98, v66
    v_add_f32 v99, v99, v67
    v_mov_b32 v2, v96
    v_mov_b32 v3, v96
    s_nop 1
    v_permlane32_swap_b32 v2, v3
    s_nop 1
    v_rcp_f32 v3, v3
    s_nop 0
    v_mul_f32 v3, v3, v18
    v_mul_f32 v88, v88, v3
    v_mul_f32 v89, v89, v3
    v_mul_f32 v90, v90, v3
    v_mul_f32 v91, v91, v3
    v_mul_f32 v92, v92, v3
    v_mul_f32 v93, v93, v3
    v_mul_f32 v94, v94, v3
    v_mul_f32 v95, v95, v3
    v_mul_f32 v96, v96, v3
    v_mul_f32 v97, v97, v3
    v_mul_f32 v98, v98, v3
    v_mul_f32 v99, v99, v3
    v_cvt_pk_bf16_f32 v72, v88, v89
    v_cvt_pk_bf16_f32 v73, v90, v91
    v_cvt_pk_bf16_f32 v74, v92, v93
    v_cvt_pk_bf16_f32 v75, v94, v95
    v_cvt_pk_bf16_f32 v76, v96, v97
    v_cvt_pk_bf16_f32 v77, v98, v99
    buffer_store_dwordx2 v[72:73], v20, s[24:27], s46 offen sc1
    buffer_store_dwordx2 v[74:75], v21, s[24:27], s46 offen sc1
    s_mov_b64 exec, s[28:29]
    buffer_store_dwordx2 v[76:77], v22, s[24:27], s46 offen sc1
    s_mov_b64 exec, -1
    s_waitcnt vmcnt(0)
    s_barrier
    s_cmp_eq_u32 s16, 0
    s_cbranch_scc0 k2_kernel_FIN
    s_lshl_b32 s19, s15, 7
    s_add_u32 s19, s19, 20201472
    v_mov_b32 v4, 0
    v_mov_b32 v5, 1
    s_mov_b64 exec, 1
    buffer_atomic_add v5, v4, s[24:27], s19 offen
    s_mov_b64 exec, -1
    s_branch k2_kernel_FIN
k2_kernel_FALLBACK:
    s_waitcnt vmcnt(0) lgkmcnt(0)
    s_cmp_eq_u32 s18, 0
    s_cbranch_scc1 k2_kernel_FB_NOSWAP
    v_swap_b32 v18, v19
k2_kernel_FB_NOSWAP:
    s_mov_b32 s43, 1
    v_mov_b32 v132, 0xff800000
    v_mov_b32 v133, 0xff800000
    s_mov_b32 s36, s44
    s_mov_b32 s42, 0
k2_kernel_FB_LOOP:
    s_barrier
    s_mov_b32 s40, 0
    s_add_u32 m0, s40, s37
    s_add_u32 s19, s36, 4096
    buffer_load_dwordx4 v10, s[24:27], s36 offen lds
    s_add_u32 m0, s40, s38
    s_add_u32 s20, s36, 8192
    buffer_load_dwordx4 v10, s[24:27], s19 offen lds
    s_add_u32 s19, s40, s39
    s_cmp_lt_u32 s17, 2
    s_cselect_b32 m0, s19, 61440
    s_add_u32 s36, s36, 10240
    buffer_load_dwordx4 v11, s[24:27], s20 offen lds
    s_add_u32 s40, s40, 20480
    s_cmp_eq_u32 s40, 61440
    s_cselect_b32 s40, 0, s40
    s_waitcnt vmcnt(0)
    s_barrier
    v_mov_b32 v15, v12
    v_mov_b32 v16, v13
    ds_read_b64 v[44:45], v16 offset:1024
    ds_read_b128 v[40:43], v15 offset:0
    s_waitcnt lgkmcnt(0)
    v_mfma_f32_32x32x16_bf16 v[56:71], v[40:43], v[28:31], 0
    v_mfma_f32_32x32x8_bf16 v[56:71], v[44:45], v[36:37], v[56:71]
    v_mfma_f32_32x32x16_bf16 v[72:87], v[40:43], v[32:35], 0
    v_mfma_f32_32x32x8_bf16 v[72:87], v[44:45], v[38:39], v[72:87]
    s_nop 7
    s_nop 7
    v_max3_f32 v132, v56, v57, v132
    v_max3_f32 v132, v58, v59, v132
    v_max3_f32 v132, v60, v61, v132
    v_max3_f32 v132, v62, v63, v132
    v_max3_f32 v132, v64, v65, v132
    v_max3_f32 v132, v66, v67, v132
    v_max3_f32 v132, v68, v69, v132
    v_max3_f32 v132, v70, v71, v132
    v_max3_f32 v133, v72, v73, v133
    v_max3_f32 v133, v74, v75, v133
    v_max3_f32 v133, v76, v77, v133
    v_max3_f32 v133, v78, v79, v133
    v_max3_f32 v133, v80, v81, v133
    v_max3_f32 v133, v82, v83, v133
    v_max3_f32 v133, v84, v85, v133
    v_max3_f32 v133, v86, v87, v133
    ds_read_b64 v[44:45], v16 offset:3584
    ds_read_b128 v[40:43], v15 offset:2560
    s_waitcnt lgkmcnt(0)
    v_mfma_f32_32x32x16_bf16 v[56:71], v[40:43], v[28:31], 0
    v_mfma_f32_32x32x8_bf16 v[56:71], v[44:45], v[36:37], v[56:71]
    v_mfma_f32_32x32x16_bf16 v[72:87], v[40:43], v[32:35], 0
    v_mfma_f32_32x32x8_bf16 v[72:87], v[44:45], v[38:39], v[72:87]
    s_nop 7
    s_nop 7
    v_max3_f32 v132, v56, v57, v132
    v_max3_f32 v132, v58, v59, v132
    v_max3_f32 v132, v60, v61, v132
    v_max3_f32 v132, v62, v63, v132
    v_max3_f32 v132, v64, v65, v132
    v_max3_f32 v132, v66, v67, v132
    v_max3_f32 v132, v68, v69, v132
    v_max3_f32 v132, v70, v71, v132
    v_max3_f32 v133, v72, v73, v133
    v_max3_f32 v133, v74, v75, v133
    v_max3_f32 v133, v76, v77, v133
    v_max3_f32 v133, v78, v79, v133
    v_max3_f32 v133, v80, v81, v133
    v_max3_f32 v133, v82, v83, v133
    v_max3_f32 v133, v84, v85, v133
    v_max3_f32 v133, v86, v87, v133
    ds_read_b64 v[44:45], v16 offset:6144
    ds_read_b128 v[40:43], v15 offset:5120
    s_waitcnt lgkmcnt(0)
    v_mfma_f32_32x32x16_bf16 v[56:71], v[40:43], v[28:31], 0
    v_mfma_f32_32x32x8_bf16 v[56:71], v[44:45], v[36:37], v[56:71]
    v_mfma_f32_32x32x16_bf16 v[72:87], v[40:43], v[32:35], 0
    v_mfma_f32_32x32x8_bf16 v[72:87], v[44:45], v[38:39], v[72:87]
    s_nop 7
    s_nop 7
    v_max3_f32 v132, v56, v57, v132
    v_max3_f32 v132, v58, v59, v132
    v_max3_f32 v132, v60, v61, v132
    v_max3_f32 v132, v62, v63, v132
    v_max3_f32 v132, v64, v65, v132
    v_max3_f32 v132, v66, v67, v132
    v_max3_f32 v132, v68, v69, v132
    v_max3_f32 v132, v70, v71, v132
    v_max3_f32 v133, v72, v73, v133
    v_max3_f32 v133, v74, v75, v133
    v_max3_f32 v133, v76, v77, v133
    v_max3_f32 v133, v78, v79, v133
    v_max3_f32 v133, v80, v81, v133
    v_max3_f32 v133, v82, v83, v133
    v_max3_f32 v133, v84, v85, v133
    v_max3_f32 v133, v86, v87, v133
    ds_read_b64 v[44:45], v16 offset:8704
    ds_read_b128 v[40:43], v15 offset:7680
    s_waitcnt lgkmcnt(0)
    v_mfma_f32_32x32x16_bf16 v[56:71], v[40:43], v[28:31], 0
    v_mfma_f32_32x32x8_bf16 v[56:71], v[44:45], v[36:37], v[56:71]
    v_mfma_f32_32x32x16_bf16 v[72:87], v[40:43], v[32:35], 0
    v_mfma_f32_32x32x8_bf16 v[72:87], v[44:45], v[38:39], v[72:87]
    s_nop 7
    s_nop 7
    v_max3_f32 v132, v56, v57, v132
    v_max3_f32 v132, v58, v59, v132
    v_max3_f32 v132, v60, v61, v132
    v_max3_f32 v132, v62, v63, v132
    v_max3_f32 v132, v64, v65, v132
    v_max3_f32 v132, v66, v67, v132
    v_max3_f32 v132, v68, v69, v132
    v_max3_f32 v132, v70, v71, v132
    v_max3_f32 v133, v72, v73, v133
    v_max3_f32 v133, v74, v75, v133
    v_max3_f32 v133, v76, v77, v133
    v_max3_f32 v133, v78, v79, v133
    v_max3_f32 v133, v80, v81, v133
    v_max3_f32 v133, v82, v83, v133
    v_max3_f32 v133, v84, v85, v133
    v_max3_f32 v133, v86, v87, v133
    s_add_u32 s42, s42, 1
    s_cmp_lt_u32 s42, 8
    s_cbranch_scc1 k2_kernel_FB_LOOP
    v_mov_b32 v2, v132
    v_mov_b32 v3, v132
    s_nop 1
    v_permlane32_swap_b32 v2, v3
    s_nop 1
    v_max_f32 v132, v2, v3
    v_mov_b32 v2, v133
    v_mov_b32 v3, v133
    s_nop 1
    v_permlane32_swap_b32 v2, v3
    s_nop 1
    v_max_f32 v133, v2, v3
    s_lshl_b32 s19, s16, 9
    s_add_u32 s19, s19, 62528
    v_lshlrev_b32 v4, 2, v1
    v_add_u32 v5, s19, v4
    s_barrier
    ds_write_b32 v5, v132
    ds_write_b32 v5, v133 offset:256
    s_xor_b32 s19, s16, 4
    s_lshl_b32 s19, s19, 9
    s_add_u32 s19, s19, 62528
    v_add_u32 v5, s19, v4
    s_waitcnt lgkmcnt(0)
    s_barrier
    ds_read_b32 v6, v5
    ds_read_b32 v7, v5 offset:256
    s_waitcnt lgkmcnt(0)
    v_max_f32 v132, v132, v6
    v_max_f32 v133, v133, v7
    s_barrier
    v_sub_f32 v136, 0, v132
    v_sub_f32 v137, 0, v132
    v_sub_f32 v138, 0, v132
    v_sub_f32 v139, 0, v132
    v_sub_f32 v140, 0, v132
    v_sub_f32 v141, 0, v132
    v_sub_f32 v142, 0, v132
    v_sub_f32 v143, 0, v132
    v_sub_f32 v144, 0, v132
    v_sub_f32 v145, 0, v132
    v_sub_f32 v146, 0, v132
    v_sub_f32 v147, 0, v132
    v_sub_f32 v148, 0, v132
    v_sub_f32 v149, 0, v132
    v_sub_f32 v150, 0, v132
    v_sub_f32 v151, 0, v132
    v_sub_f32 v152, 0, v133
    v_sub_f32 v153, 0, v133
    v_sub_f32 v154, 0, v133
    v_sub_f32 v155, 0, v133
    v_sub_f32 v156, 0, v133
    v_sub_f32 v157, 0, v133
    v_sub_f32 v158, 0, v133
    v_sub_f32 v159, 0, v133
    v_sub_f32 v160, 0, v133
    v_sub_f32 v161, 0, v133
    v_sub_f32 v162, 0, v133
    v_sub_f32 v163, 0, v133
    v_sub_f32 v164, 0, v133
    v_sub_f32 v165, 0, v133
    v_sub_f32 v166, 0, v133
    v_sub_f32 v167, 0, v133
    s_mov_b32 s36, s44
    s_mov_b32 s40, 0
    s_add_u32 m0, s40, s37
    s_add_u32 s19, s36, 4096
    buffer_load_dwordx4 v10, s[24:27], s36 offen lds
    s_add_u32 m0, s40, s38
    s_add_u32 s20, s36, 8192
    buffer_load_dwordx4 v10, s[24:27], s19 offen lds
    s_add_u32 s19, s40, s39
    s_cmp_lt_u32 s17, 2
    s_cselect_b32 m0, s19, 61440
    s_add_u32 s36, s36, 10240
    buffer_load_dwordx4 v11, s[24:27], s20 offen lds
    s_add_u32 s40, s40, 20480
    s_cmp_eq_u32 s40, 61440
    s_cselect_b32 s40, 0, s40
    s_add_u32 m0, s40, s37
    s_add_u32 s19, s36, 4096
    buffer_load_dwordx4 v10, s[24:27], s36 offen lds
    s_add_u32 m0, s40, s38
    s_add_u32 s20, s36, 8192
    buffer_load_dwordx4 v10, s[24:27], s19 offen lds
    s_add_u32 s19, s40, s39
    s_cmp_lt_u32 s17, 2
    s_cselect_b32 m0, s19, 61440
    s_add_u32 s36, s36, 10240
    buffer_load_dwordx4 v11, s[24:27], s20 offen lds
    s_add_u32 s40, s40, 20480
    s_cmp_eq_u32 s40, 61440
    s_cselect_b32 s40, 0, s40
    v_mul_u32_u24 v3, 21846, v1
    v_lshrrev_b32 v3, 16, v3
    v_mul_u32_u24 v4, 3, v3
    v_sub_u32 v4, v1, v4
    v_and_b32 v5, 1, v3
    v_mul_u32_u24 v5, 320, v5
    v_bfe_u32 v6, v3, 1, 1
    v_mul_u32_u24 v6, 640, v6
    v_lshrrev_b32 v3, 2, v3
    v_mul_u32_u24 v3, 2560, v3
    v_add3_u32 v3, v3, v5, v6
    v_mov_b32 v5, 4
    v_mov_b32 v6, 5
    v_cmp_eq_u32 vcc, 1, v4
    v_mov_b32 v7, 12
    v_mov_b32 v8, 0x3f803f80
    v_cndmask_b32 v5, v5, v6, vcc
    v_cmp_eq_u32 vcc, 2, v4
    v_mov_b32 v6, 0
    s_nop 0
    v_cndmask_b32 v5, v5, v7, vcc
    v_cmp_eq_u32 vcc, 0, v4
    v_lshl_add_u32 v3, v5, 4, v3
    v_add_u32 v3, 62720, v3
    v_cndmask_b32 v128, v6, v8, vcc
    v_cndmask_b32 v129, v6, v8, vcc
    v_cndmask_b32 v130, v6, v8, vcc
    v_cndmask_b32 v131, v6, v8, vcc
    s_mov_b32 exec_lo, -1
    s_mov_b32 exec_hi, 0xffff
    ds_write_b128 v3, v[128:131]
    s_mov_b64 exec, -1
    v_mov_b32 v88, 0
    v_mov_b32 v89, 0
    v_mov_b32 v90, 0
    v_mov_b32 v91, 0
    v_mov_b32 v92, 0
    v_mov_b32 v93, 0
    v_mov_b32 v94, 0
    v_mov_b32 v95, 0
    v_mov_b32 v96, 0
    v_mov_b32 v97, 0
    v_mov_b32 v98, 0
    v_mov_b32 v99, 0
    v_mov_b32 v100, 0
    v_mov_b32 v101, 0
    v_mov_b32 v102, 0
    v_mov_b32 v103, 0
    v_mov_b32 v104, 0
    v_mov_b32 v105, 0
    v_mov_b32 v106, 0
    v_mov_b32 v107, 0
    v_mov_b32 v108, 0
    v_mov_b32 v109, 0
    v_mov_b32 v110, 0
    v_mov_b32 v111, 0
    v_mov_b32 v112, 0
    v_mov_b32 v113, 0
    v_mov_b32 v114, 0
    v_mov_b32 v115, 0
    v_mov_b32 v116, 0
    v_mov_b32 v117, 0
    v_mov_b32 v118, 0
    v_mov_b32 v119, 0
    v_mov_b32 v124, 0
    v_mov_b32 v128, 0
    v_mov_b32 v125, 0
    v_mov_b32 v129, 0
    v_mov_b32 v126, 0
    v_mov_b32 v130, 0
    v_mov_b32 v127, 0
    v_mov_b32 v131, 0
    s_mov_b32 s41, 0
    s_mov_b32 s42, 0
    v_mov_b32 v15, v12
    v_mov_b32 v16, v13
    v_mov_b32 v17, v14
    s_waitcnt vmcnt(3) lgkmcnt(0)
    s_barrier
    ds_read_b64 v[44:45], v16 offset:1024
    ds_read_b128 v[40:43], v15 offset:0
    ds_read_b128 v[48:51], v17 offset:1280
    s_waitcnt lgkmcnt(1)
    v_mfma_f32_32x32x16_bf16 v[56:71], v[40:43], v[28:31], v[136:151]
    v_mfma_f32_32x32x8_bf16 v[56:71], v[44:45], v[36:37], v[56:71]
    s_nop 7
    s_nop 3
k2_kernel_LOOPFB:
    v_mfma_f32_32x32x16_bf16 v[72:87], v[40:43], v[32:35], v[152:167]
    v_exp_f32 v56, v56
    v_cvt_pk_bf16_f32 v126, v128, v129
    v_exp_f32 v57, v57
    v_cvt_pk_bf16_f32 v127, v130, v131
    v_exp_f32 v58, v58
    v_exp_f32 v59, v59
    v_mfma_f32_32x32x8_bf16 v[72:87], v[44:45], v[38:39], v[72:87]
    ds_read_b64 v[44:45], v16 offset:3584
    ds_read_b128 v[40:43], v15 offset:2560
    v_exp_f32 v60, v60
    v_exp_f32 v61, v61
    v_cvt_pk_bf16_f32 v120, v56, v57
    v_exp_f32 v62, v62
    v_exp_f32 v63, v63
    v_cvt_pk_bf16_f32 v121, v58, v59
    v_mfma_f32_32x32x16_bf16 v[104:119], v[52:55], v[124:127], v[104:119]
    ds_read_b128 v[52:55], v17 offset:1920
    v_exp_f32 v64, v64
    v_cvt_pk_bf16_f32 v122, v60, v61
    v_exp_f32 v65, v65
    v_cvt_pk_bf16_f32 v123, v62, v63
    v_exp_f32 v66, v66
    v_exp_f32 v67, v67
    s_waitcnt lgkmcnt(3)
    v_mfma_f32_32x32x16_bf16 v[88:103], v[48:51], v[120:123], v[88:103]
    v_exp_f32 v128, v68
    v_exp_f32 v129, v69
    v_cvt_pk_bf16_f32 v124, v64, v65
    v_exp_f32 v130, v70
    v_exp_f32 v131, v71
    v_cvt_pk_bf16_f32 v125, v66, v67
    s_waitcnt lgkmcnt(1)
    v_mfma_f32_32x32x16_bf16 v[56:71], v[40:43], v[28:31], v[136:151]
    v_exp_f32 v72, v72
    v_cvt_pk_bf16_f32 v126, v128, v129
    v_exp_f32 v73, v73
    v_cvt_pk_bf16_f32 v127, v130, v131
    v_exp_f32 v74, v74
    v_exp_f32 v75, v75
    v_mfma_f32_32x32x8_bf16 v[56:71], v[44:45], v[36:37], v[56:71]
    v_exp_f32 v76, v76
    v_exp_f32 v77, v77
    v_cvt_pk_bf16_f32 v120, v72, v73
    v_exp_f32 v78, v78
    v_exp_f32 v79, v79
    v_cvt_pk_bf16_f32 v121, v74, v75
    s_waitcnt lgkmcnt(0)
    v_mfma_f32_32x32x16_bf16 v[88:103], v[52:55], v[124:127], v[88:103]
    v_exp_f32 v80, v80
    v_cvt_pk_bf16_f32 v122, v76, v77
    v_exp_f32 v81, v81
    v_cvt_pk_bf16_f32 v123, v78, v79
    v_exp_f32 v82, v82
    v_exp_f32 v83, v83
    v_mfma_f32_32x32x16_bf16 v[104:119], v[48:51], v[120:123], v[104:119]
    ds_read_b128 v[48:51], v17 offset:3840
    v_exp_f32 v128, v84
    v_exp_f32 v129, v85
    v_cvt_pk_bf16_f32 v124, v80, v81
    v_exp_f32 v130, v86
    v_exp_f32 v131, v87
    v_cvt_pk_bf16_f32 v125, v82, v83
    v_mfma_f32_32x32x16_bf16 v[72:87], v[40:43], v[32:35], v[152:167]
    v_exp_f32 v56, v56
    v_cvt_pk_bf16_f32 v126, v128, v129
    v_exp_f32 v57, v57
    v_cvt_pk_bf16_f32 v127, v130, v131
    v_exp_f32 v58, v58
    v_exp_f32 v59, v59
    v_mfma_f32_32x32x8_bf16 v[72:87], v[44:45], v[38:39], v[72:87]
    ds_read_b64 v[44:45], v16 offset:6144
    ds_read_b128 v[40:43], v15 offset:5120
    v_exp_f32 v60, v60
    v_exp_f32 v61, v61
    v_cvt_pk_bf16_f32 v120, v56, v57
    v_exp_f32 v62, v62
    v_exp_f32 v63, v63
    v_cvt_pk_bf16_f32 v121, v58, v59
    v_mfma_f32_32x32x16_bf16 v[104:119], v[52:55], v[124:127], v[104:119]
    ds_read_b128 v[52:55], v17 offset:4480
    v_exp_f32 v64, v64
    v_cvt_pk_bf16_f32 v122, v60, v61
    v_exp_f32 v65, v65
    v_cvt_pk_bf16_f32 v123, v62, v63
    v_exp_f32 v66, v66
    v_exp_f32 v67, v67
    s_waitcnt lgkmcnt(3)
    v_mfma_f32_32x32x16_bf16 v[88:103], v[48:51], v[120:123], v[88:103]
    v_exp_f32 v128, v68
    v_exp_f32 v129, v69
    v_cvt_pk_bf16_f32 v124, v64, v65
    v_exp_f32 v130, v70
    v_exp_f32 v131, v71
    v_cvt_pk_bf16_f32 v125, v66, v67
    s_waitcnt lgkmcnt(1)
    v_mfma_f32_32x32x16_bf16 v[56:71], v[40:43], v[28:31], v[136:151]
    v_exp_f32 v72, v72
    v_cvt_pk_bf16_f32 v126, v128, v129
    v_exp_f32 v73, v73
    v_cvt_pk_bf16_f32 v127, v130, v131
    v_exp_f32 v74, v74
    v_exp_f32 v75, v75
    v_mfma_f32_32x32x8_bf16 v[56:71], v[44:45], v[36:37], v[56:71]
    v_exp_f32 v76, v76
    v_exp_f32 v77, v77
    v_cvt_pk_bf16_f32 v120, v72, v73
    v_exp_f32 v78, v78
    v_exp_f32 v79, v79
    v_cvt_pk_bf16_f32 v121, v74, v75
    s_waitcnt lgkmcnt(0)
    v_mfma_f32_32x32x16_bf16 v[88:103], v[52:55], v[124:127], v[88:103]
    v_exp_f32 v80, v80
    v_cvt_pk_bf16_f32 v122, v76, v77
    v_exp_f32 v81, v81
    v_cvt_pk_bf16_f32 v123, v78, v79
    v_exp_f32 v82, v82
    v_exp_f32 v83, v83
    v_mfma_f32_32x32x16_bf16 v[104:119], v[48:51], v[120:123], v[104:119]
    ds_read_b128 v[48:51], v17 offset:6400
    v_exp_f32 v128, v84
    v_exp_f32 v129, v85
    v_cvt_pk_bf16_f32 v124, v80, v81
    v_exp_f32 v130, v86
    v_exp_f32 v131, v87
    v_cvt_pk_bf16_f32 v125, v82, v83
    v_mfma_f32_32x32x16_bf16 v[72:87], v[40:43], v[32:35], v[152:167]
    v_exp_f32 v56, v56
    v_cvt_pk_bf16_f32 v126, v128, v129
    v_exp_f32 v57, v57
    v_cvt_pk_bf16_f32 v127, v130, v131
    v_exp_f32 v58, v58
    v_exp_f32 v59, v59
    v_mfma_f32_32x32x8_bf16 v[72:87], v[44:45], v[38:39], v[72:87]
    ds_read_b64 v[44:45], v16 offset:8704
    ds_read_b128 v[40:43], v15 offset:7680
    v_exp_f32 v60, v60
    v_exp_f32 v61, v61
    v_cvt_pk_bf16_f32 v120, v56, v57
    v_exp_f32 v62, v62
    v_exp_f32 v63, v63
    v_cvt_pk_bf16_f32 v121, v58, v59
    v_mfma_f32_32x32x16_bf16 v[104:119], v[52:55], v[124:127], v[104:119]
    ds_read_b128 v[52:55], v17 offset:7040
    v_exp_f32 v64, v64
    v_cvt_pk_bf16_f32 v122, v60, v61
    v_exp_f32 v65, v65
    v_cvt_pk_bf16_f32 v123, v62, v63
    v_exp_f32 v66, v66
    v_exp_f32 v67, v67
    s_waitcnt lgkmcnt(3)
    v_mfma_f32_32x32x16_bf16 v[88:103], v[48:51], v[120:123], v[88:103]
    v_exp_f32 v128, v68
    v_exp_f32 v129, v69
    v_cvt_pk_bf16_f32 v124, v64, v65
    v_exp_f32 v130, v70
    v_exp_f32 v131, v71
    v_cvt_pk_bf16_f32 v125, v66, v67
    s_waitcnt lgkmcnt(1)
    v_mfma_f32_32x32x16_bf16 v[56:71], v[40:43], v[28:31], v[136:151]
    v_exp_f32 v72, v72
    v_cvt_pk_bf16_f32 v126, v128, v129
    v_exp_f32 v73, v73
    v_cvt_pk_bf16_f32 v127, v130, v131
    v_exp_f32 v74, v74
    v_exp_f32 v75, v75
    v_mfma_f32_32x32x8_bf16 v[56:71], v[44:45], v[36:37], v[56:71]
    v_exp_f32 v76, v76
    v_exp_f32 v77, v77
    v_cvt_pk_bf16_f32 v120, v72, v73
    v_exp_f32 v78, v78
    v_exp_f32 v79, v79
    v_cvt_pk_bf16_f32 v121, v74, v75
    s_waitcnt lgkmcnt(0)
    v_mfma_f32_32x32x16_bf16 v[88:103], v[52:55], v[124:127], v[88:103]
    v_exp_f32 v80, v80
    v_cvt_pk_bf16_f32 v122, v76, v77
    v_exp_f32 v81, v81
    v_cvt_pk_bf16_f32 v123, v78, v79
    v_exp_f32 v82, v82
    v_exp_f32 v83, v83
    v_mfma_f32_32x32x16_bf16 v[104:119], v[48:51], v[120:123], v[104:119]
    ds_read_b128 v[48:51], v17 offset:8960
    v_exp_f32 v128, v84
    v_exp_f32 v129, v85
    v_cvt_pk_bf16_f32 v124, v80, v81
    v_exp_f32 v130, v86
    v_exp_f32 v131, v87
    v_cvt_pk_bf16_f32 v125, v82, v83
    v_mfma_f32_32x32x16_bf16 v[72:87], v[40:43], v[32:35], v[152:167]
    v_exp_f32 v56, v56
    v_cvt_pk_bf16_f32 v126, v128, v129
    v_exp_f32 v57, v57
    v_cvt_pk_bf16_f32 v127, v130, v131
    v_exp_f32 v58, v58
    v_exp_f32 v59, v59
    v_mfma_f32_32x32x8_bf16 v[72:87], v[44:45], v[38:39], v[72:87]
    s_waitcnt vmcnt(0)
    s_barrier
    s_add_u32 s41, s41, 20480
    s_cmp_eq_u32 s41, 61440
    s_cselect_b32 s41, 0, s41
    v_add_u32 v15, s41, v12
    v_add_u32 v16, s41, v13
    ds_read_b64 v[44:45], v16 offset:1024
    ds_read_b128 v[40:43], v15 offset:0
    v_exp_f32 v60, v60
    v_exp_f32 v61, v61
    v_cvt_pk_bf16_f32 v120, v56, v57
    v_exp_f32 v62, v62
    v_exp_f32 v63, v63
    v_cvt_pk_bf16_f32 v121, v58, v59
    v_mfma_f32_32x32x16_bf16 v[104:119], v[52:55], v[124:127], v[104:119]
    ds_read_b128 v[52:55], v17 offset:9600
    v_mad_u32_u24 v17, v24, s41, v14
    v_exp_f32 v64, v64
    v_cvt_pk_bf16_f32 v122, v60, v61
    v_exp_f32 v65, v65
    v_cvt_pk_bf16_f32 v123, v62, v63
    v_exp_f32 v66, v66
    v_exp_f32 v67, v67
    s_waitcnt lgkmcnt(3)
    v_mfma_f32_32x32x16_bf16 v[88:103], v[48:51], v[120:123], v[88:103]
    v_exp_f32 v128, v68
    v_exp_f32 v129, v69
    v_cvt_pk_bf16_f32 v124, v64, v65
    v_exp_f32 v130, v70
    v_exp_f32 v131, v71
    v_cvt_pk_bf16_f32 v125, v66, v67
    s_cmp_ge_u32 s42, 6
    s_cbranch_scc1 k2_kernel_LOOPFB_NODMA
    s_add_u32 m0, s40, s37
    s_add_u32 s19, s36, 4096
    buffer_load_dwordx4 v10, s[24:27], s36 offen lds
    s_add_u32 m0, s40, s38
    s_add_u32 s20, s36, 8192
    buffer_load_dwordx4 v10, s[24:27], s19 offen lds
    s_add_u32 s19, s40, s39
    s_cmp_lt_u32 s17, 2
    s_cselect_b32 m0, s19, 61440
    s_add_u32 s36, s36, 10240
    buffer_load_dwordx4 v11, s[24:27], s20 offen lds
    s_add_u32 s40, s40, 20480
    s_cmp_eq_u32 s40, 61440
    s_cselect_b32 s40, 0, s40
k2_kernel_LOOPFB_NODMA:
    s_waitcnt lgkmcnt(1)
    v_mfma_f32_32x32x16_bf16 v[56:71], v[40:43], v[28:31], v[136:151]
    v_exp_f32 v72, v72
    v_cvt_pk_bf16_f32 v126, v128, v129
    v_exp_f32 v73, v73
    v_cvt_pk_bf16_f32 v127, v130, v131
    v_exp_f32 v74, v74
    v_exp_f32 v75, v75
    v_mfma_f32_32x32x8_bf16 v[56:71], v[44:45], v[36:37], v[56:71]
    v_exp_f32 v76, v76
    v_exp_f32 v77, v77
    v_cvt_pk_bf16_f32 v120, v72, v73
    v_exp_f32 v78, v78
    v_exp_f32 v79, v79
    v_cvt_pk_bf16_f32 v121, v74, v75
    s_waitcnt lgkmcnt(0)
    v_mfma_f32_32x32x16_bf16 v[88:103], v[52:55], v[124:127], v[88:103]
    v_exp_f32 v80, v80
    v_cvt_pk_bf16_f32 v122, v76, v77
    v_exp_f32 v81, v81
    v_cvt_pk_bf16_f32 v123, v78, v79
    v_exp_f32 v82, v82
    v_exp_f32 v83, v83
    v_mfma_f32_32x32x16_bf16 v[104:119], v[48:51], v[120:123], v[104:119]
    ds_read_b128 v[48:51], v17 offset:1280
    v_exp_f32 v128, v84
    v_exp_f32 v129, v85
    v_cvt_pk_bf16_f32 v124, v80, v81
    v_exp_f32 v130, v86
    v_exp_f32 v131, v87
    v_cvt_pk_bf16_f32 v125, v82, v83
    s_add_u32 s42, s42, 1
    s_cmp_lt_u32 s42, 8
    s_cbranch_scc1 k2_kernel_LOOPFB
    v_cvt_pk_bf16_f32 v126, v128, v129
    v_cvt_pk_bf16_f32 v127, v130, v131
    s_waitcnt lgkmcnt(0)
    s_nop 0
    v_mfma_f32_32x32x16_bf16 v[104:119], v[52:55], v[124:127], v[104:119]
    s_branch k2_kernel_EPI
k2_kernel_GW:
    s_sub_u32 s15, s16, 8
    s_lshr_b32 s19, s13, 2
    s_lshl_b32 s17, s12, 3
    s_add_u32 s17, s17, s19
    s_and_b32 s18, s13, 3
    s_mul_i32 s19, s18, 320
    v_add_u32 v12, 0, v1
    v_mul_u32_u24 v13, 3277, v12
    v_lshrrev_b32 v13, 16, v13
    v_mul_u32_u24 v14, 20, v13
    v_sub_u32 v14, v12, v14
    v_mul_u32_u24 v13, 1280, v13
    v_lshl_add_u32 v13, v14, 4, v13
    v_add_u32 v2, s19, v13
    v_add_u32 v12, 64, v1
    v_mul_u32_u24 v13, 3277, v12
    v_lshrrev_b32 v13, 16, v13
    v_mul_u32_u24 v14, 20, v13
    v_sub_u32 v14, v12, v14
    v_mul_u32_u24 v13, 1280, v13
    v_lshl_add_u32 v13, v14, 4, v13
    v_add_u32 v3, s19, v13
    v_add_u32 v12, 128, v1
    v_mul_u32_u24 v13, 3277, v12
    v_lshrrev_b32 v13, 16, v13
    v_mul_u32_u24 v14, 20, v13
    v_sub_u32 v14, v12, v14
    v_mul_u32_u24 v13, 1280, v13
    v_lshl_add_u32 v13, v14, 4, v13
    v_add_u32 v4, s19, v13
    v_add_u32 v12, 192, v1
    v_mul_u32_u24 v13, 3277, v12
    v_lshrrev_b32 v13, 16, v13
    v_mul_u32_u24 v14, 20, v13
    v_sub_u32 v14, v12, v14
    v_mul_u32_u24 v13, 1280, v13
    v_lshl_add_u32 v13, v14, 4, v13
    v_add_u32 v5, s19, v13
    v_add_u32 v12, 256, v1
    v_mul_u32_u24 v13, 3277, v12
    v_lshrrev_b32 v13, 16, v13
    v_mul_u32_u24 v14, 20, v13
    v_sub_u32 v14, v12, v14
    v_mul_u32_u24 v13, 1280, v13
    v_lshl_add_u32 v13, v14, 4, v13
    v_add_u32 v6, s19, v13
    v_lshlrev_b32 v7, 4, v1
    s_mul_i32 s36, s15, 18432
    s_add_u32 s36, s36, 87104
    s_mul_i32 s44, s15, 20480
    s_mul_i32 s45, s17, 108
    s_add_u32 s45, s45, s15
    s_lshl_b32 s45, s45, 10
    s_add_u32 s45, s45, 7864320
    s_waitcnt lgkmcnt(0)
    s_mov_b32 s24, s4
    s_and_b32 s25, s5, 0xffff
    s_mov_b32 s26, 268435456
    s_mov_b32 s27, 0x20000
    s_mov_b32 s48, s6
    s_and_b32 s49, s7, 0xffff
    s_mov_b32 s50, 2211840
    s_mov_b32 s51, 0x20000
    s_mov_b32 s52, s10
    s_and_b32 s53, s11, 0xffff
    s_mov_b32 s54, 2621440
    s_mov_b32 s55, 0x20000
    v_and_b32 v11, 31, v1
    v_lshlrev_b32 v12, 3, v11
    s_lshl_b32 s19, s17, 8
    s_add_u32 s19, s19, 17563652
    s_mov_b32 s56, s19
    buffer_load_dword v10, v12, s[24:27], s19 offen
    v_and_b32 v14, 15, v1
    v_lshrrev_b32 v15, 2, v14
    v_lshrrev_b32 v13, 5, v1
    v_lshl_add_u32 v15, v13, 2, v15
    v_mul_u32_u24 v15, 320, v15
    v_and_b32 v14, 3, v14
    v_lshl_add_u32 v15, v14, 3, v15
    v_lshrrev_b32 v14, 4, v1
    v_and_b32 v14, 1, v14
    v_lshl_add_u32 v15, v14, 5, v15
    v_add_u32 v8, s36, v15
    v_add_u32 v9, 5120, v7
    v_add_u32 v9, s36, v9
    v_mov_b32 v44, 0
    v_mov_b32 v45, 0
    v_mov_b32 v46, 0
    v_mov_b32 v47, 0
    v_mov_b32 v48, 0
    v_mov_b32 v49, 0
    v_mov_b32 v50, 0
    v_mov_b32 v51, 0
    v_mov_b32 v52, 0
    v_mov_b32 v53, 0
    v_mov_b32 v54, 0
    v_mov_b32 v55, 0
    v_mov_b32 v56, 0
    v_mov_b32 v57, 0
    v_mov_b32 v58, 0
    v_mov_b32 v59, 0
    v_mov_b32 v60, 0
    v_mov_b32 v61, 0
    v_mov_b32 v62, 0
    v_mov_b32 v63, 0
    v_mov_b32 v64, 0
    v_mov_b32 v65, 0
    v_mov_b32 v66, 0
    v_mov_b32 v67, 0
    v_mov_b32 v68, 0
    v_mov_b32 v69, 0
    v_mov_b32 v70, 0
    v_mov_b32 v71, 0
    v_mov_b32 v72, 0
    v_mov_b32 v73, 0
    v_mov_b32 v74, 0
    v_mov_b32 v75, 0
    v_mov_b32 v76, 0
    v_mov_b32 v77, 0
    v_mov_b32 v78, 0
    v_mov_b32 v79, 0
    v_mov_b32 v80, 0
    v_mov_b32 v81, 0
    v_mov_b32 v82, 0
    v_mov_b32 v83, 0
    v_mov_b32 v84, 0
    v_mov_b32 v85, 0
    v_mov_b32 v86, 0
    v_mov_b32 v87, 0
    v_mov_b32 v88, 0
    v_mov_b32 v89, 0
    v_mov_b32 v90, 0
    v_mov_b32 v91, 0
    v_mov_b32 v92, 0
    v_mov_b32 v93, 0
    v_mov_b32 v94, 0
    v_mov_b32 v95, 0
    v_mov_b32 v96, 0
    v_mov_b32 v97, 0
    v_mov_b32 v98, 0
    v_mov_b32 v99, 0
    v_mov_b32 v100, 0
    v_mov_b32 v101, 0
    v_mov_b32 v102, 0
    v_mov_b32 v103, 0
    v_mov_b32 v104, 0
    v_mov_b32 v105, 0
    v_mov_b32 v106, 0
    v_mov_b32 v107, 0
    v_mov_b32 v108, 0
    v_mov_b32 v109, 0
    v_mov_b32 v110, 0
    v_mov_b32 v111, 0
    v_mov_b32 v112, 0
    v_mov_b32 v113, 0
    v_mov_b32 v114, 0
    v_mov_b32 v115, 0
    v_mov_b32 v116, 0
    v_mov_b32 v117, 0
    v_mov_b32 v118, 0
    v_mov_b32 v119, 0
    v_mov_b32 v120, 0
    v_mov_b32 v121, 0
    v_mov_b32 v122, 0
    v_mov_b32 v123, 0
    s_barrier
    s_add_u32 m0, s36, 0
    s_nop 0
    buffer_load_dwordx4 v2, s[48:51], s44 offen lds
    s_add_u32 m0, s36, 1024
    s_nop 0
    buffer_load_dwordx4 v3, s[48:51], s44 offen lds
    s_add_u32 m0, s36, 2048
    s_nop 0
    buffer_load_dwordx4 v4, s[48:51], s44 offen lds
    s_add_u32 m0, s36, 3072
    s_nop 0
    buffer_load_dwordx4 v5, s[48:51], s44 offen lds
    s_add_u32 m0, s36, 4096
    s_nop 0
    buffer_load_dwordx4 v6, s[48:51], s44 offen lds
    s_add_u32 s44, s44, 81920
    s_add_u32 m0, s36, 5120
    s_nop 0
    buffer_load_dwordx4 v7, s[24:27], s45 offen lds
    s_add_u32 s45, s45, 4096
    s_add_u32 m0, s36, 6144
    s_nop 0
    buffer_load_dwordx4 v2, s[48:51], s44 offen lds
    s_add_u32 m0, s36, 7168
    s_nop 0
    buffer_load_dwordx4 v3, s[48:51], s44 offen lds
    s_add_u32 m0, s36, 8192
    s_nop 0
    buffer_load_dwordx4 v4, s[48:51], s44 offen lds
    s_add_u32 m0, s36, 9216
    s_nop 0
    buffer_load_dwordx4 v5, s[48:51], s44 offen lds
    s_add_u32 m0, s36, 10240
    s_nop 0
    buffer_load_dwordx4 v6, s[48:51], s44 offen lds
    s_add_u32 s44, s44, 81920
    s_add_u32 m0, s36, 11264
    s_nop 0
    buffer_load_dwordx4 v7, s[24:27], s45 offen lds
    s_add_u32 s45, s45, 4096
    s_waitcnt vmcnt(6)
    ds_read_b128 v[20:23], v9 offset:0
    ds_read_b64_tr_b16 v[24:25], v8 offset:0
    ds_read_b64_tr_b16 v[26:27], v8 offset:2560
    ds_read_b64_tr_b16 v[28:29], v8 offset:64
    ds_read_b64_tr_b16 v[30:31], v8 offset:2624
    ds_read_b64_tr_b16 v[32:33], v8 offset:128
    ds_read_b64_tr_b16 v[34:35], v8 offset:2688
    ds_read_b64_tr_b16 v[36:37], v8 offset:192
    ds_read_b64_tr_b16 v[38:39], v8 offset:2752
    ds_read_b64_tr_b16 v[40:41], v8 offset:256
    ds_read_b64_tr_b16 v[42:43], v8 offset:2816
    s_add_u32 m0, s36, 12288
    s_nop 0
    buffer_load_dwordx4 v2, s[48:51], s44 offen lds
    s_add_u32 m0, s36, 13312
    s_nop 0
    buffer_load_dwordx4 v3, s[48:51], s44 offen lds
    s_add_u32 m0, s36, 14336
    s_nop 0
    buffer_load_dwordx4 v4, s[48:51], s44 offen lds
    s_add_u32 m0, s36, 15360
    s_nop 0
    buffer_load_dwordx4 v5, s[48:51], s44 offen lds
    s_add_u32 m0, s36, 16384
    s_nop 0
    buffer_load_dwordx4 v6, s[48:51], s44 offen lds
    s_add_u32 s44, s44, 81920
    s_add_u32 m0, s36, 17408
    s_nop 0
    buffer_load_dwordx4 v7, s[24:27], s45 offen lds
    s_add_u32 s45, s45, 4096
    s_waitcnt lgkmcnt(8)
    v_mfma_f32_32x32x16_bf16 v[44:59], v[24:27], v[20:23], v[44:59]
    s_waitcnt lgkmcnt(6)
    v_mfma_f32_32x32x16_bf16 v[60:75], v[28:31], v[20:23], v[60:75]
    s_waitcnt lgkmcnt(4)
    v_mfma_f32_32x32x16_bf16 v[76:91], v[32:35], v[20:23], v[76:91]
    s_waitcnt lgkmcnt(2)
    v_mfma_f32_32x32x16_bf16 v[92:107], v[36:39], v[20:23], v[92:107]
    s_waitcnt lgkmcnt(0)
    v_mfma_f32_32x32x16_bf16 v[108:123], v[40:43], v[20:23], v[108:123]
    s_waitcnt vmcnt(6)
    ds_read_b128 v[20:23], v9 offset:6144
    ds_read_b64_tr_b16 v[24:25], v8 offset:6144
    ds_read_b64_tr_b16 v[26:27], v8 offset:8704
    ds_read_b64_tr_b16 v[28:29], v8 offset:6208
    ds_read_b64_tr_b16 v[30:31], v8 offset:8768
    ds_read_b64_tr_b16 v[32:33], v8 offset:6272
    ds_read_b64_tr_b16 v[34:35], v8 offset:8832
    ds_read_b64_tr_b16 v[36:37], v8 offset:6336
    ds_read_b64_tr_b16 v[38:39], v8 offset:8896
    ds_read_b64_tr_b16 v[40:41], v8 offset:6400
    ds_read_b64_tr_b16 v[42:43], v8 offset:8960
    s_add_u32 m0, s36, 0
    s_nop 0
    buffer_load_dwordx4 v2, s[48:51], s44 offen lds
    s_add_u32 m0, s36, 1024
    s_nop 0
    buffer_load_dwordx4 v3, s[48:51], s44 offen lds
    s_add_u32 m0, s36, 2048
    s_nop 0
    buffer_load_dwordx4 v4, s[48:51], s44 offen lds
    s_add_u32 m0, s36, 3072
    s_nop 0
    buffer_load_dwordx4 v5, s[48:51], s44 offen lds
    s_add_u32 m0, s36, 4096
    s_nop 0
    buffer_load_dwordx4 v6, s[48:51], s44 offen lds
    s_add_u32 s44, s44, 81920
    s_add_u32 m0, s36, 5120
    s_nop 0
    buffer_load_dwordx4 v7, s[24:27], s45 offen lds
    s_add_u32 s45, s45, 4096
    s_waitcnt lgkmcnt(8)
    v_mfma_f32_32x32x16_bf16 v[44:59], v[24:27], v[20:23], v[44:59]
    s_waitcnt lgkmcnt(6)
    v_mfma_f32_32x32x16_bf16 v[60:75], v[28:31], v[20:23], v[60:75]
    s_waitcnt lgkmcnt(4)
    v_mfma_f32_32x32x16_bf16 v[76:91], v[32:35], v[20:23], v[76:91]
    s_waitcnt lgkmcnt(2)
    v_mfma_f32_32x32x16_bf16 v[92:107], v[36:39], v[20:23], v[92:107]
    s_waitcnt lgkmcnt(0)
    v_mfma_f32_32x32x16_bf16 v[108:123], v[40:43], v[20:23], v[108:123]
    s_waitcnt vmcnt(6)
    ds_read_b128 v[20:23], v9 offset:12288
    ds_read_b64_tr_b16 v[24:25], v8 offset:12288
    ds_read_b64_tr_b16 v[26:27], v8 offset:14848
    ds_read_b64_tr_b16 v[28:29], v8 offset:12352
    ds_read_b64_tr_b16 v[30:31], v8 offset:14912
    ds_read_b64_tr_b16 v[32:33], v8 offset:12416
    ds_read_b64_tr_b16 v[34:35], v8 offset:14976
    ds_read_b64_tr_b16 v[36:37], v8 offset:12480
    ds_read_b64_tr_b16 v[38:39], v8 offset:15040
    ds_read_b64_tr_b16 v[40:41], v8 offset:12544
    ds_read_b64_tr_b16 v[42:43], v8 offset:15104
    s_add_u32 m0, s36, 6144
    s_nop 0
    buffer_load_dwordx4 v2, s[48:51], s44 offen lds
    s_add_u32 m0, s36, 7168
    s_nop 0
    buffer_load_dwordx4 v3, s[48:51], s44 offen lds
    s_add_u32 m0, s36, 8192
    s_nop 0
    buffer_load_dwordx4 v4, s[48:51], s44 offen lds
    s_add_u32 m0, s36, 9216
    s_nop 0
    buffer_load_dwordx4 v5, s[48:51], s44 offen lds
    s_add_u32 m0, s36, 10240
    s_nop 0
    buffer_load_dwordx4 v6, s[48:51], s44 offen lds
    s_add_u32 s44, s44, 81920
    s_add_u32 m0, s36, 11264
    s_nop 0
    buffer_load_dwordx4 v7, s[24:27], s45 offen lds
    s_add_u32 s45, s45, 4096
    s_waitcnt lgkmcnt(8)
    v_mfma_f32_32x32x16_bf16 v[44:59], v[24:27], v[20:23], v[44:59]
    s_waitcnt lgkmcnt(6)
    v_mfma_f32_32x32x16_bf16 v[60:75], v[28:31], v[20:23], v[60:75]
    s_waitcnt lgkmcnt(4)
    v_mfma_f32_32x32x16_bf16 v[76:91], v[32:35], v[20:23], v[76:91]
    s_waitcnt lgkmcnt(2)
    v_mfma_f32_32x32x16_bf16 v[92:107], v[36:39], v[20:23], v[92:107]
    s_waitcnt lgkmcnt(0)
    v_mfma_f32_32x32x16_bf16 v[108:123], v[40:43], v[20:23], v[108:123]
    s_barrier
    s_waitcnt vmcnt(6)
    ds_read_b128 v[20:23], v9 offset:0
    ds_read_b64_tr_b16 v[24:25], v8 offset:0
    ds_read_b64_tr_b16 v[26:27], v8 offset:2560
    ds_read_b64_tr_b16 v[28:29], v8 offset:64
    ds_read_b64_tr_b16 v[30:31], v8 offset:2624
    ds_read_b64_tr_b16 v[32:33], v8 offset:128
    ds_read_b64_tr_b16 v[34:35], v8 offset:2688
    ds_read_b64_tr_b16 v[36:37], v8 offset:192
    ds_read_b64_tr_b16 v[38:39], v8 offset:2752
    ds_read_b64_tr_b16 v[40:41], v8 offset:256
    ds_read_b64_tr_b16 v[42:43], v8 offset:2816
    s_add_u32 m0, s36, 12288
    s_nop 0
    buffer_load_dwordx4 v2, s[48:51], s44 offen lds
    s_add_u32 m0, s36, 13312
    s_nop 0
    buffer_load_dwordx4 v3, s[48:51], s44 offen lds
    s_add_u32 m0, s36, 14336
    s_nop 0
    buffer_load_dwordx4 v4, s[48:51], s44 offen lds
    s_add_u32 m0, s36, 15360
    s_nop 0
    buffer_load_dwordx4 v5, s[48:51], s44 offen lds
    s_add_u32 m0, s36, 16384
    s_nop 0
    buffer_load_dwordx4 v6, s[48:51], s44 offen lds
    s_add_u32 s44, s44, 81920
    s_add_u32 m0, s36, 17408
    s_nop 0
    buffer_load_dwordx4 v7, s[24:27], s45 offen lds
    s_add_u32 s45, s45, 4096
    s_waitcnt lgkmcnt(8)
    v_mfma_f32_32x32x16_bf16 v[44:59], v[24:27], v[20:23], v[44:59]
    s_waitcnt lgkmcnt(6)
    v_mfma_f32_32x32x16_bf16 v[60:75], v[28:31], v[20:23], v[60:75]
    s_waitcnt lgkmcnt(4)
    v_mfma_f32_32x32x16_bf16 v[76:91], v[32:35], v[20:23], v[76:91]
    s_waitcnt lgkmcnt(2)
    v_mfma_f32_32x32x16_bf16 v[92:107], v[36:39], v[20:23], v[92:107]
    s_waitcnt lgkmcnt(0)
    v_mfma_f32_32x32x16_bf16 v[108:123], v[40:43], v[20:23], v[108:123]
    s_waitcnt vmcnt(6)
    ds_read_b128 v[20:23], v9 offset:6144
    ds_read_b64_tr_b16 v[24:25], v8 offset:6144
    ds_read_b64_tr_b16 v[26:27], v8 offset:8704
    ds_read_b64_tr_b16 v[28:29], v8 offset:6208
    ds_read_b64_tr_b16 v[30:31], v8 offset:8768
    ds_read_b64_tr_b16 v[32:33], v8 offset:6272
    ds_read_b64_tr_b16 v[34:35], v8 offset:8832
    ds_read_b64_tr_b16 v[36:37], v8 offset:6336
    ds_read_b64_tr_b16 v[38:39], v8 offset:8896
    ds_read_b64_tr_b16 v[40:41], v8 offset:6400
    ds_read_b64_tr_b16 v[42:43], v8 offset:8960
    s_add_u32 m0, s36, 0
    s_nop 0
    buffer_load_dwordx4 v2, s[48:51], s44 offen lds
    s_add_u32 m0, s36, 1024
    s_nop 0
    buffer_load_dwordx4 v3, s[48:51], s44 offen lds
    s_add_u32 m0, s36, 2048
    s_nop 0
    buffer_load_dwordx4 v4, s[48:51], s44 offen lds
    s_add_u32 m0, s36, 3072
    s_nop 0
    buffer_load_dwordx4 v5, s[48:51], s44 offen lds
    s_add_u32 m0, s36, 4096
    s_nop 0
    buffer_load_dwordx4 v6, s[48:51], s44 offen lds
    s_add_u32 s44, s44, 81920
    s_add_u32 m0, s36, 5120
    s_nop 0
    buffer_load_dwordx4 v7, s[24:27], s45 offen lds
    s_add_u32 s45, s45, 4096
    s_waitcnt lgkmcnt(8)
    v_mfma_f32_32x32x16_bf16 v[44:59], v[24:27], v[20:23], v[44:59]
    s_waitcnt lgkmcnt(6)
    v_mfma_f32_32x32x16_bf16 v[60:75], v[28:31], v[20:23], v[60:75]
    s_waitcnt lgkmcnt(4)
    v_mfma_f32_32x32x16_bf16 v[76:91], v[32:35], v[20:23], v[76:91]
    s_waitcnt lgkmcnt(2)
    v_mfma_f32_32x32x16_bf16 v[92:107], v[36:39], v[20:23], v[92:107]
    s_waitcnt lgkmcnt(0)
    v_mfma_f32_32x32x16_bf16 v[108:123], v[40:43], v[20:23], v[108:123]
    s_waitcnt vmcnt(6)
    ds_read_b128 v[20:23], v9 offset:12288
    ds_read_b64_tr_b16 v[24:25], v8 offset:12288
    ds_read_b64_tr_b16 v[26:27], v8 offset:14848
    ds_read_b64_tr_b16 v[28:29], v8 offset:12352
    ds_read_b64_tr_b16 v[30:31], v8 offset:14912
    ds_read_b64_tr_b16 v[32:33], v8 offset:12416
    ds_read_b64_tr_b16 v[34:35], v8 offset:14976
    ds_read_b64_tr_b16 v[36:37], v8 offset:12480
    ds_read_b64_tr_b16 v[38:39], v8 offset:15040
    ds_read_b64_tr_b16 v[40:41], v8 offset:12544
    ds_read_b64_tr_b16 v[42:43], v8 offset:15104
    s_add_u32 m0, s36, 6144
    s_nop 0
    buffer_load_dwordx4 v2, s[48:51], s44 offen lds
    s_add_u32 m0, s36, 7168
    s_nop 0
    buffer_load_dwordx4 v3, s[48:51], s44 offen lds
    s_add_u32 m0, s36, 8192
    s_nop 0
    buffer_load_dwordx4 v4, s[48:51], s44 offen lds
    s_add_u32 m0, s36, 9216
    s_nop 0
    buffer_load_dwordx4 v5, s[48:51], s44 offen lds
    s_add_u32 m0, s36, 10240
    s_nop 0
    buffer_load_dwordx4 v6, s[48:51], s44 offen lds
    s_add_u32 s44, s44, 81920
    s_add_u32 m0, s36, 11264
    s_nop 0
    buffer_load_dwordx4 v7, s[24:27], s45 offen lds
    s_add_u32 s45, s45, 4096
    s_waitcnt lgkmcnt(8)
    v_mfma_f32_32x32x16_bf16 v[44:59], v[24:27], v[20:23], v[44:59]
    s_waitcnt lgkmcnt(6)
    v_mfma_f32_32x32x16_bf16 v[60:75], v[28:31], v[20:23], v[60:75]
    s_waitcnt lgkmcnt(4)
    v_mfma_f32_32x32x16_bf16 v[76:91], v[32:35], v[20:23], v[76:91]
    s_waitcnt lgkmcnt(2)
    v_mfma_f32_32x32x16_bf16 v[92:107], v[36:39], v[20:23], v[92:107]
    s_waitcnt lgkmcnt(0)
    v_mfma_f32_32x32x16_bf16 v[108:123], v[40:43], v[20:23], v[108:123]
    s_waitcnt vmcnt(6)
    ds_read_b128 v[20:23], v9 offset:0
    ds_read_b64_tr_b16 v[24:25], v8 offset:0
    ds_read_b64_tr_b16 v[26:27], v8 offset:2560
    ds_read_b64_tr_b16 v[28:29], v8 offset:64
    ds_read_b64_tr_b16 v[30:31], v8 offset:2624
    ds_read_b64_tr_b16 v[32:33], v8 offset:128
    ds_read_b64_tr_b16 v[34:35], v8 offset:2688
    ds_read_b64_tr_b16 v[36:37], v8 offset:192
    ds_read_b64_tr_b16 v[38:39], v8 offset:2752
    ds_read_b64_tr_b16 v[40:41], v8 offset:256
    ds_read_b64_tr_b16 v[42:43], v8 offset:2816
    s_add_u32 m0, s36, 12288
    s_nop 0
    buffer_load_dwordx4 v2, s[48:51], s44 offen lds
    s_add_u32 m0, s36, 13312
    s_nop 0
    buffer_load_dwordx4 v3, s[48:51], s44 offen lds
    s_add_u32 m0, s36, 14336
    s_nop 0
    buffer_load_dwordx4 v4, s[48:51], s44 offen lds
    s_add_u32 m0, s36, 15360
    s_nop 0
    buffer_load_dwordx4 v5, s[48:51], s44 offen lds
    s_add_u32 m0, s36, 16384
    s_nop 0
    buffer_load_dwordx4 v6, s[48:51], s44 offen lds
    s_add_u32 s44, s44, 81920
    s_add_u32 m0, s36, 17408
    s_nop 0
    buffer_load_dwordx4 v7, s[24:27], s45 offen lds
    s_add_u32 s45, s45, 4096
    s_barrier
    s_waitcnt lgkmcnt(8)
    v_mfma_f32_32x32x16_bf16 v[44:59], v[24:27], v[20:23], v[44:59]
    s_waitcnt lgkmcnt(6)
    v_mfma_f32_32x32x16_bf16 v[60:75], v[28:31], v[20:23], v[60:75]
    s_waitcnt lgkmcnt(4)
    v_mfma_f32_32x32x16_bf16 v[76:91], v[32:35], v[20:23], v[76:91]
    s_waitcnt lgkmcnt(2)
    v_mfma_f32_32x32x16_bf16 v[92:107], v[36:39], v[20:23], v[92:107]
    s_waitcnt lgkmcnt(0)
    v_mfma_f32_32x32x16_bf16 v[108:123], v[40:43], v[20:23], v[108:123]
    s_waitcnt vmcnt(6)
    ds_read_b128 v[20:23], v9 offset:6144
    ds_read_b64_tr_b16 v[24:25], v8 offset:6144
    ds_read_b64_tr_b16 v[26:27], v8 offset:8704
    ds_read_b64_tr_b16 v[28:29], v8 offset:6208
    ds_read_b64_tr_b16 v[30:31], v8 offset:8768
    ds_read_b64_tr_b16 v[32:33], v8 offset:6272
    ds_read_b64_tr_b16 v[34:35], v8 offset:8832
    ds_read_b64_tr_b16 v[36:37], v8 offset:6336
    ds_read_b64_tr_b16 v[38:39], v8 offset:8896
    ds_read_b64_tr_b16 v[40:41], v8 offset:6400
    ds_read_b64_tr_b16 v[42:43], v8 offset:8960
    s_add_u32 m0, s36, 0
    s_nop 0
    buffer_load_dwordx4 v2, s[48:51], s44 offen lds
    s_add_u32 m0, s36, 1024
    s_nop 0
    buffer_load_dwordx4 v3, s[48:51], s44 offen lds
    s_add_u32 m0, s36, 2048
    s_nop 0
    buffer_load_dwordx4 v4, s[48:51], s44 offen lds
    s_add_u32 m0, s36, 3072
    s_nop 0
    buffer_load_dwordx4 v5, s[48:51], s44 offen lds
    s_add_u32 m0, s36, 4096
    s_nop 0
    buffer_load_dwordx4 v6, s[48:51], s44 offen lds
    s_add_u32 s44, s44, 81920
    s_add_u32 m0, s36, 5120
    s_nop 0
    buffer_load_dwordx4 v7, s[24:27], s45 offen lds
    s_add_u32 s45, s45, 4096
    s_waitcnt lgkmcnt(8)
    v_mfma_f32_32x32x16_bf16 v[44:59], v[24:27], v[20:23], v[44:59]
    s_waitcnt lgkmcnt(6)
    v_mfma_f32_32x32x16_bf16 v[60:75], v[28:31], v[20:23], v[60:75]
    s_waitcnt lgkmcnt(4)
    v_mfma_f32_32x32x16_bf16 v[76:91], v[32:35], v[20:23], v[76:91]
    s_waitcnt lgkmcnt(2)
    v_mfma_f32_32x32x16_bf16 v[92:107], v[36:39], v[20:23], v[92:107]
    s_waitcnt lgkmcnt(0)
    v_mfma_f32_32x32x16_bf16 v[108:123], v[40:43], v[20:23], v[108:123]
    s_waitcnt vmcnt(6)
    ds_read_b128 v[20:23], v9 offset:12288
    ds_read_b64_tr_b16 v[24:25], v8 offset:12288
    ds_read_b64_tr_b16 v[26:27], v8 offset:14848
    ds_read_b64_tr_b16 v[28:29], v8 offset:12352
    ds_read_b64_tr_b16 v[30:31], v8 offset:14912
    ds_read_b64_tr_b16 v[32:33], v8 offset:12416
    ds_read_b64_tr_b16 v[34:35], v8 offset:14976
    ds_read_b64_tr_b16 v[36:37], v8 offset:12480
    ds_read_b64_tr_b16 v[38:39], v8 offset:15040
    ds_read_b64_tr_b16 v[40:41], v8 offset:12544
    ds_read_b64_tr_b16 v[42:43], v8 offset:15104
    s_add_u32 m0, s36, 6144
    s_nop 0
    buffer_load_dwordx4 v2, s[48:51], s44 offen lds
    s_add_u32 m0, s36, 7168
    s_nop 0
    buffer_load_dwordx4 v3, s[48:51], s44 offen lds
    s_add_u32 m0, s36, 8192
    s_nop 0
    buffer_load_dwordx4 v4, s[48:51], s44 offen lds
    s_add_u32 m0, s36, 9216
    s_nop 0
    buffer_load_dwordx4 v5, s[48:51], s44 offen lds
    s_add_u32 m0, s36, 10240
    s_nop 0
    buffer_load_dwordx4 v6, s[48:51], s44 offen lds
    s_add_u32 s44, s44, 81920
    s_add_u32 m0, s36, 11264
    s_nop 0
    buffer_load_dwordx4 v7, s[24:27], s45 offen lds
    s_add_u32 s45, s45, 4096
    s_waitcnt lgkmcnt(8)
    v_mfma_f32_32x32x16_bf16 v[44:59], v[24:27], v[20:23], v[44:59]
    s_waitcnt lgkmcnt(6)
    v_mfma_f32_32x32x16_bf16 v[60:75], v[28:31], v[20:23], v[60:75]
    s_waitcnt lgkmcnt(4)
    v_mfma_f32_32x32x16_bf16 v[76:91], v[32:35], v[20:23], v[76:91]
    s_waitcnt lgkmcnt(2)
    v_mfma_f32_32x32x16_bf16 v[92:107], v[36:39], v[20:23], v[92:107]
    s_waitcnt lgkmcnt(0)
    v_mfma_f32_32x32x16_bf16 v[108:123], v[40:43], v[20:23], v[108:123]
    s_waitcnt vmcnt(6)
    ds_read_b128 v[20:23], v9 offset:0
    ds_read_b64_tr_b16 v[24:25], v8 offset:0
    ds_read_b64_tr_b16 v[26:27], v8 offset:2560
    ds_read_b64_tr_b16 v[28:29], v8 offset:64
    ds_read_b64_tr_b16 v[30:31], v8 offset:2624
    ds_read_b64_tr_b16 v[32:33], v8 offset:128
    ds_read_b64_tr_b16 v[34:35], v8 offset:2688
    ds_read_b64_tr_b16 v[36:37], v8 offset:192
    ds_read_b64_tr_b16 v[38:39], v8 offset:2752
    ds_read_b64_tr_b16 v[40:41], v8 offset:256
    ds_read_b64_tr_b16 v[42:43], v8 offset:2816
    s_add_u32 m0, s36, 12288
    s_nop 0
    buffer_load_dwordx4 v2, s[48:51], s44 offen lds
    s_add_u32 m0, s36, 13312
    s_nop 0
    buffer_load_dwordx4 v3, s[48:51], s44 offen lds
    s_add_u32 m0, s36, 14336
    s_nop 0
    buffer_load_dwordx4 v4, s[48:51], s44 offen lds
    s_add_u32 m0, s36, 15360
    s_nop 0
    buffer_load_dwordx4 v5, s[48:51], s44 offen lds
    s_add_u32 m0, s36, 16384
    s_nop 0
    buffer_load_dwordx4 v6, s[48:51], s44 offen lds
    s_add_u32 s44, s44, 81920
    s_add_u32 m0, s36, 17408
    s_nop 0
    buffer_load_dwordx4 v7, s[24:27], s45 offen lds
    s_add_u32 s45, s45, 4096
    s_waitcnt lgkmcnt(8)
    v_mfma_f32_32x32x16_bf16 v[44:59], v[24:27], v[20:23], v[44:59]
    s_waitcnt lgkmcnt(6)
    v_mfma_f32_32x32x16_bf16 v[60:75], v[28:31], v[20:23], v[60:75]
    s_waitcnt lgkmcnt(4)
    v_mfma_f32_32x32x16_bf16 v[76:91], v[32:35], v[20:23], v[76:91]
    s_waitcnt lgkmcnt(2)
    v_mfma_f32_32x32x16_bf16 v[92:107], v[36:39], v[20:23], v[92:107]
    s_waitcnt lgkmcnt(0)
    v_mfma_f32_32x32x16_bf16 v[108:123], v[40:43], v[20:23], v[108:123]
    s_barrier
    s_waitcnt vmcnt(6)
    ds_read_b128 v[20:23], v9 offset:6144
    ds_read_b64_tr_b16 v[24:25], v8 offset:6144
    ds_read_b64_tr_b16 v[26:27], v8 offset:8704
    ds_read_b64_tr_b16 v[28:29], v8 offset:6208
    ds_read_b64_tr_b16 v[30:31], v8 offset:8768
    ds_read_b64_tr_b16 v[32:33], v8 offset:6272
    ds_read_b64_tr_b16 v[34:35], v8 offset:8832
    ds_read_b64_tr_b16 v[36:37], v8 offset:6336
    ds_read_b64_tr_b16 v[38:39], v8 offset:8896
    ds_read_b64_tr_b16 v[40:41], v8 offset:6400
    ds_read_b64_tr_b16 v[42:43], v8 offset:8960
    s_add_u32 m0, s36, 0
    s_nop 0
    buffer_load_dwordx4 v2, s[48:51], s44 offen lds
    s_add_u32 m0, s36, 1024
    s_nop 0
    buffer_load_dwordx4 v3, s[48:51], s44 offen lds
    s_add_u32 m0, s36, 2048
    s_nop 0
    buffer_load_dwordx4 v4, s[48:51], s44 offen lds
    s_add_u32 m0, s36, 3072
    s_nop 0
    buffer_load_dwordx4 v5, s[48:51], s44 offen lds
    s_add_u32 m0, s36, 4096
    s_nop 0
    buffer_load_dwordx4 v6, s[48:51], s44 offen lds
    s_add_u32 s44, s44, 81920
    s_add_u32 m0, s36, 5120
    s_nop 0
    buffer_load_dwordx4 v7, s[24:27], s45 offen lds
    s_add_u32 s45, s45, 4096
    s_waitcnt lgkmcnt(8)
    v_mfma_f32_32x32x16_bf16 v[44:59], v[24:27], v[20:23], v[44:59]
    s_waitcnt lgkmcnt(6)
    v_mfma_f32_32x32x16_bf16 v[60:75], v[28:31], v[20:23], v[60:75]
    s_waitcnt lgkmcnt(4)
    v_mfma_f32_32x32x16_bf16 v[76:91], v[32:35], v[20:23], v[76:91]
    s_waitcnt lgkmcnt(2)
    v_mfma_f32_32x32x16_bf16 v[92:107], v[36:39], v[20:23], v[92:107]
    s_waitcnt lgkmcnt(0)
    v_mfma_f32_32x32x16_bf16 v[108:123], v[40:43], v[20:23], v[108:123]
    s_waitcnt vmcnt(6)
    ds_read_b128 v[20:23], v9 offset:12288
    ds_read_b64_tr_b16 v[24:25], v8 offset:12288
    ds_read_b64_tr_b16 v[26:27], v8 offset:14848
    ds_read_b64_tr_b16 v[28:29], v8 offset:12352
    ds_read_b64_tr_b16 v[30:31], v8 offset:14912
    ds_read_b64_tr_b16 v[32:33], v8 offset:12416
    ds_read_b64_tr_b16 v[34:35], v8 offset:14976
    ds_read_b64_tr_b16 v[36:37], v8 offset:12480
    ds_read_b64_tr_b16 v[38:39], v8 offset:15040
    ds_read_b64_tr_b16 v[40:41], v8 offset:12544
    ds_read_b64_tr_b16 v[42:43], v8 offset:15104
    s_add_u32 m0, s36, 6144
    s_nop 0
    buffer_load_dwordx4 v2, s[48:51], s44 offen lds
    s_add_u32 m0, s36, 7168
    s_nop 0
    buffer_load_dwordx4 v3, s[48:51], s44 offen lds
    s_add_u32 m0, s36, 8192
    s_nop 0
    buffer_load_dwordx4 v4, s[48:51], s44 offen lds
    s_add_u32 m0, s36, 9216
    s_nop 0
    buffer_load_dwordx4 v5, s[48:51], s44 offen lds
    s_add_u32 m0, s36, 10240
    s_nop 0
    buffer_load_dwordx4 v6, s[48:51], s44 offen lds
    s_add_u32 s44, s44, 81920
    s_add_u32 m0, s36, 11264
    s_nop 0
    buffer_load_dwordx4 v7, s[24:27], s45 offen lds
    s_add_u32 s45, s45, 4096
    s_waitcnt lgkmcnt(8)
    v_mfma_f32_32x32x16_bf16 v[44:59], v[24:27], v[20:23], v[44:59]
    s_waitcnt lgkmcnt(6)
    v_mfma_f32_32x32x16_bf16 v[60:75], v[28:31], v[20:23], v[60:75]
    s_waitcnt lgkmcnt(4)
    v_mfma_f32_32x32x16_bf16 v[76:91], v[32:35], v[20:23], v[76:91]
    s_waitcnt lgkmcnt(2)
    v_mfma_f32_32x32x16_bf16 v[92:107], v[36:39], v[20:23], v[92:107]
    s_waitcnt lgkmcnt(0)
    v_mfma_f32_32x32x16_bf16 v[108:123], v[40:43], v[20:23], v[108:123]
    s_waitcnt vmcnt(6)
    ds_read_b128 v[20:23], v9 offset:0
    ds_read_b64_tr_b16 v[24:25], v8 offset:0
    ds_read_b64_tr_b16 v[26:27], v8 offset:2560
    ds_read_b64_tr_b16 v[28:29], v8 offset:64
    ds_read_b64_tr_b16 v[30:31], v8 offset:2624
    ds_read_b64_tr_b16 v[32:33], v8 offset:128
    ds_read_b64_tr_b16 v[34:35], v8 offset:2688
    ds_read_b64_tr_b16 v[36:37], v8 offset:192
    ds_read_b64_tr_b16 v[38:39], v8 offset:2752
    ds_read_b64_tr_b16 v[40:41], v8 offset:256
    ds_read_b64_tr_b16 v[42:43], v8 offset:2816
    s_add_u32 m0, s36, 12288
    s_nop 0
    buffer_load_dwordx4 v2, s[48:51], s44 offen lds
    s_add_u32 m0, s36, 13312
    s_nop 0
    buffer_load_dwordx4 v3, s[48:51], s44 offen lds
    s_add_u32 m0, s36, 14336
    s_nop 0
    buffer_load_dwordx4 v4, s[48:51], s44 offen lds
    s_add_u32 m0, s36, 15360
    s_nop 0
    buffer_load_dwordx4 v5, s[48:51], s44 offen lds
    s_add_u32 m0, s36, 16384
    s_nop 0
    buffer_load_dwordx4 v6, s[48:51], s44 offen lds
    s_add_u32 s44, s44, 81920
    s_add_u32 m0, s36, 17408
    s_nop 0
    buffer_load_dwordx4 v7, s[24:27], s45 offen lds
    s_add_u32 s45, s45, 4096
    s_waitcnt lgkmcnt(8)
    v_mfma_f32_32x32x16_bf16 v[44:59], v[24:27], v[20:23], v[44:59]
    s_waitcnt lgkmcnt(6)
    v_mfma_f32_32x32x16_bf16 v[60:75], v[28:31], v[20:23], v[60:75]
    s_waitcnt lgkmcnt(4)
    v_mfma_f32_32x32x16_bf16 v[76:91], v[32:35], v[20:23], v[76:91]
    s_waitcnt lgkmcnt(2)
    v_mfma_f32_32x32x16_bf16 v[92:107], v[36:39], v[20:23], v[92:107]
    s_waitcnt lgkmcnt(0)
    v_mfma_f32_32x32x16_bf16 v[108:123], v[40:43], v[20:23], v[108:123]
    s_waitcnt vmcnt(6)
    ds_read_b128 v[20:23], v9 offset:6144
    ds_read_b64_tr_b16 v[24:25], v8 offset:6144
    ds_read_b64_tr_b16 v[26:27], v8 offset:8704
    ds_read_b64_tr_b16 v[28:29], v8 offset:6208
    ds_read_b64_tr_b16 v[30:31], v8 offset:8768
    ds_read_b64_tr_b16 v[32:33], v8 offset:6272
    ds_read_b64_tr_b16 v[34:35], v8 offset:8832
    ds_read_b64_tr_b16 v[36:37], v8 offset:6336
    ds_read_b64_tr_b16 v[38:39], v8 offset:8896
    ds_read_b64_tr_b16 v[40:41], v8 offset:6400
    ds_read_b64_tr_b16 v[42:43], v8 offset:8960
    s_add_u32 m0, s36, 0
    s_nop 0
    buffer_load_dwordx4 v2, s[48:51], s44 offen lds
    s_add_u32 m0, s36, 1024
    s_nop 0
    buffer_load_dwordx4 v3, s[48:51], s44 offen lds
    s_add_u32 m0, s36, 2048
    s_nop 0
    buffer_load_dwordx4 v4, s[48:51], s44 offen lds
    s_add_u32 m0, s36, 3072
    s_nop 0
    buffer_load_dwordx4 v5, s[48:51], s44 offen lds
    s_add_u32 m0, s36, 4096
    s_nop 0
    buffer_load_dwordx4 v6, s[48:51], s44 offen lds
    s_add_u32 s44, s44, 81920
    s_add_u32 m0, s36, 5120
    s_nop 0
    buffer_load_dwordx4 v7, s[24:27], s45 offen lds
    s_add_u32 s45, s45, 4096
    s_barrier
    s_waitcnt lgkmcnt(8)
    v_mfma_f32_32x32x16_bf16 v[44:59], v[24:27], v[20:23], v[44:59]
    s_waitcnt lgkmcnt(6)
    v_mfma_f32_32x32x16_bf16 v[60:75], v[28:31], v[20:23], v[60:75]
    s_waitcnt lgkmcnt(4)
    v_mfma_f32_32x32x16_bf16 v[76:91], v[32:35], v[20:23], v[76:91]
    s_waitcnt lgkmcnt(2)
    v_mfma_f32_32x32x16_bf16 v[92:107], v[36:39], v[20:23], v[92:107]
    s_waitcnt lgkmcnt(0)
    v_mfma_f32_32x32x16_bf16 v[108:123], v[40:43], v[20:23], v[108:123]
    s_waitcnt vmcnt(6)
    ds_read_b128 v[20:23], v9 offset:12288
    ds_read_b64_tr_b16 v[24:25], v8 offset:12288
    ds_read_b64_tr_b16 v[26:27], v8 offset:14848
    ds_read_b64_tr_b16 v[28:29], v8 offset:12352
    ds_read_b64_tr_b16 v[30:31], v8 offset:14912
    ds_read_b64_tr_b16 v[32:33], v8 offset:12416
    ds_read_b64_tr_b16 v[34:35], v8 offset:14976
    ds_read_b64_tr_b16 v[36:37], v8 offset:12480
    ds_read_b64_tr_b16 v[38:39], v8 offset:15040
    ds_read_b64_tr_b16 v[40:41], v8 offset:12544
    ds_read_b64_tr_b16 v[42:43], v8 offset:15104
    s_add_u32 m0, s36, 6144
    s_nop 0
    buffer_load_dwordx4 v2, s[48:51], s44 offen lds
    s_add_u32 m0, s36, 7168
    s_nop 0
    buffer_load_dwordx4 v3, s[48:51], s44 offen lds
    s_add_u32 m0, s36, 8192
    s_nop 0
    buffer_load_dwordx4 v4, s[48:51], s44 offen lds
    s_add_u32 m0, s36, 9216
    s_nop 0
    buffer_load_dwordx4 v5, s[48:51], s44 offen lds
    s_add_u32 m0, s36, 10240
    s_nop 0
    buffer_load_dwordx4 v6, s[48:51], s44 offen lds
    s_add_u32 s44, s44, 81920
    s_add_u32 m0, s36, 11264
    s_nop 0
    buffer_load_dwordx4 v7, s[24:27], s45 offen lds
    s_add_u32 s45, s45, 4096
    s_waitcnt lgkmcnt(8)
    v_mfma_f32_32x32x16_bf16 v[44:59], v[24:27], v[20:23], v[44:59]
    s_waitcnt lgkmcnt(6)
    v_mfma_f32_32x32x16_bf16 v[60:75], v[28:31], v[20:23], v[60:75]
    s_waitcnt lgkmcnt(4)
    v_mfma_f32_32x32x16_bf16 v[76:91], v[32:35], v[20:23], v[76:91]
    s_waitcnt lgkmcnt(2)
    v_mfma_f32_32x32x16_bf16 v[92:107], v[36:39], v[20:23], v[92:107]
    s_waitcnt lgkmcnt(0)
    v_mfma_f32_32x32x16_bf16 v[108:123], v[40:43], v[20:23], v[108:123]
    s_waitcnt vmcnt(6)
    ds_read_b128 v[20:23], v9 offset:0
    ds_read_b64_tr_b16 v[24:25], v8 offset:0
    ds_read_b64_tr_b16 v[26:27], v8 offset:2560
    ds_read_b64_tr_b16 v[28:29], v8 offset:64
    ds_read_b64_tr_b16 v[30:31], v8 offset:2624
    ds_read_b64_tr_b16 v[32:33], v8 offset:128
    ds_read_b64_tr_b16 v[34:35], v8 offset:2688
    ds_read_b64_tr_b16 v[36:37], v8 offset:192
    ds_read_b64_tr_b16 v[38:39], v8 offset:2752
    ds_read_b64_tr_b16 v[40:41], v8 offset:256
    ds_read_b64_tr_b16 v[42:43], v8 offset:2816
    s_add_u32 m0, s36, 12288
    s_nop 0
    buffer_load_dwordx4 v2, s[48:51], s44 offen lds
    s_add_u32 m0, s36, 13312
    s_nop 0
    buffer_load_dwordx4 v3, s[48:51], s44 offen lds
    s_add_u32 m0, s36, 14336
    s_nop 0
    buffer_load_dwordx4 v4, s[48:51], s44 offen lds
    s_add_u32 m0, s36, 15360
    s_nop 0
    buffer_load_dwordx4 v5, s[48:51], s44 offen lds
    s_add_u32 m0, s36, 16384
    s_nop 0
    buffer_load_dwordx4 v6, s[48:51], s44 offen lds
    s_add_u32 s44, s44, 81920
    s_add_u32 m0, s36, 17408
    s_nop 0
    buffer_load_dwordx4 v7, s[24:27], s45 offen lds
    s_add_u32 s45, s45, 4096
    s_waitcnt lgkmcnt(8)
    v_mfma_f32_32x32x16_bf16 v[44:59], v[24:27], v[20:23], v[44:59]
    s_waitcnt lgkmcnt(6)
    v_mfma_f32_32x32x16_bf16 v[60:75], v[28:31], v[20:23], v[60:75]
    s_waitcnt lgkmcnt(4)
    v_mfma_f32_32x32x16_bf16 v[76:91], v[32:35], v[20:23], v[76:91]
    s_waitcnt lgkmcnt(2)
    v_mfma_f32_32x32x16_bf16 v[92:107], v[36:39], v[20:23], v[92:107]
    s_waitcnt lgkmcnt(0)
    v_mfma_f32_32x32x16_bf16 v[108:123], v[40:43], v[20:23], v[108:123]
    s_waitcnt vmcnt(6)
    ds_read_b128 v[20:23], v9 offset:6144
    ds_read_b64_tr_b16 v[24:25], v8 offset:6144
    ds_read_b64_tr_b16 v[26:27], v8 offset:8704
    ds_read_b64_tr_b16 v[28:29], v8 offset:6208
    ds_read_b64_tr_b16 v[30:31], v8 offset:8768
    ds_read_b64_tr_b16 v[32:33], v8 offset:6272
    ds_read_b64_tr_b16 v[34:35], v8 offset:8832
    ds_read_b64_tr_b16 v[36:37], v8 offset:6336
    ds_read_b64_tr_b16 v[38:39], v8 offset:8896
    ds_read_b64_tr_b16 v[40:41], v8 offset:6400
    ds_read_b64_tr_b16 v[42:43], v8 offset:8960
    s_add_u32 m0, s36, 0
    s_nop 0
    buffer_load_dwordx4 v2, s[48:51], s44 offen lds
    s_add_u32 m0, s36, 1024
    s_nop 0
    buffer_load_dwordx4 v3, s[48:51], s44 offen lds
    s_add_u32 m0, s36, 2048
    s_nop 0
    buffer_load_dwordx4 v4, s[48:51], s44 offen lds
    s_add_u32 m0, s36, 3072
    s_nop 0
    buffer_load_dwordx4 v5, s[48:51], s44 offen lds
    s_add_u32 m0, s36, 4096
    s_nop 0
    buffer_load_dwordx4 v6, s[48:51], s44 offen lds
    s_add_u32 s44, s44, 81920
    s_add_u32 m0, s36, 5120
    s_nop 0
    buffer_load_dwordx4 v7, s[24:27], s45 offen lds
    s_add_u32 s45, s45, 4096
    s_barrier
    s_waitcnt lgkmcnt(8)
    v_mfma_f32_32x32x16_bf16 v[44:59], v[24:27], v[20:23], v[44:59]
    s_waitcnt lgkmcnt(6)
    v_mfma_f32_32x32x16_bf16 v[60:75], v[28:31], v[20:23], v[60:75]
    s_waitcnt lgkmcnt(4)
    v_mfma_f32_32x32x16_bf16 v[76:91], v[32:35], v[20:23], v[76:91]
    s_waitcnt lgkmcnt(2)
    v_mfma_f32_32x32x16_bf16 v[92:107], v[36:39], v[20:23], v[92:107]
    s_waitcnt lgkmcnt(0)
    v_mfma_f32_32x32x16_bf16 v[108:123], v[40:43], v[20:23], v[108:123]
    s_waitcnt vmcnt(6)
    ds_read_b128 v[20:23], v9 offset:12288
    ds_read_b64_tr_b16 v[24:25], v8 offset:12288
    ds_read_b64_tr_b16 v[26:27], v8 offset:14848
    ds_read_b64_tr_b16 v[28:29], v8 offset:12352
    ds_read_b64_tr_b16 v[30:31], v8 offset:14912
    ds_read_b64_tr_b16 v[32:33], v8 offset:12416
    ds_read_b64_tr_b16 v[34:35], v8 offset:14976
    ds_read_b64_tr_b16 v[36:37], v8 offset:12480
    ds_read_b64_tr_b16 v[38:39], v8 offset:15040
    ds_read_b64_tr_b16 v[40:41], v8 offset:12544
    ds_read_b64_tr_b16 v[42:43], v8 offset:15104
    s_add_u32 m0, s36, 6144
    s_nop 0
    buffer_load_dwordx4 v2, s[48:51], s44 offen lds
    s_add_u32 m0, s36, 7168
    s_nop 0
    buffer_load_dwordx4 v3, s[48:51], s44 offen lds
    s_add_u32 m0, s36, 8192
    s_nop 0
    buffer_load_dwordx4 v4, s[48:51], s44 offen lds
    s_add_u32 m0, s36, 9216
    s_nop 0
    buffer_load_dwordx4 v5, s[48:51], s44 offen lds
    s_add_u32 m0, s36, 10240
    s_nop 0
    buffer_load_dwordx4 v6, s[48:51], s44 offen lds
    s_add_u32 s44, s44, 81920
    s_add_u32 m0, s36, 11264
    s_nop 0
    buffer_load_dwordx4 v7, s[24:27], s45 offen lds
    s_add_u32 s45, s45, 4096
    s_waitcnt lgkmcnt(8)
    v_mfma_f32_32x32x16_bf16 v[44:59], v[24:27], v[20:23], v[44:59]
    s_waitcnt lgkmcnt(6)
    v_mfma_f32_32x32x16_bf16 v[60:75], v[28:31], v[20:23], v[60:75]
    s_waitcnt lgkmcnt(4)
    v_mfma_f32_32x32x16_bf16 v[76:91], v[32:35], v[20:23], v[76:91]
    s_waitcnt lgkmcnt(2)
    v_mfma_f32_32x32x16_bf16 v[92:107], v[36:39], v[20:23], v[92:107]
    s_waitcnt lgkmcnt(0)
    v_mfma_f32_32x32x16_bf16 v[108:123], v[40:43], v[20:23], v[108:123]
    s_waitcnt vmcnt(6)
    ds_read_b128 v[20:23], v9 offset:0
    ds_read_b64_tr_b16 v[24:25], v8 offset:0
    ds_read_b64_tr_b16 v[26:27], v8 offset:2560
    ds_read_b64_tr_b16 v[28:29], v8 offset:64
    ds_read_b64_tr_b16 v[30:31], v8 offset:2624
    ds_read_b64_tr_b16 v[32:33], v8 offset:128
    ds_read_b64_tr_b16 v[34:35], v8 offset:2688
    ds_read_b64_tr_b16 v[36:37], v8 offset:192
    ds_read_b64_tr_b16 v[38:39], v8 offset:2752
    ds_read_b64_tr_b16 v[40:41], v8 offset:256
    ds_read_b64_tr_b16 v[42:43], v8 offset:2816
    s_add_u32 m0, s36, 12288
    s_nop 0
    buffer_load_dwordx4 v2, s[48:51], s44 offen lds
    s_add_u32 m0, s36, 13312
    s_nop 0
    buffer_load_dwordx4 v3, s[48:51], s44 offen lds
    s_add_u32 m0, s36, 14336
    s_nop 0
    buffer_load_dwordx4 v4, s[48:51], s44 offen lds
    s_add_u32 m0, s36, 15360
    s_nop 0
    buffer_load_dwordx4 v5, s[48:51], s44 offen lds
    s_add_u32 m0, s36, 16384
    s_nop 0
    buffer_load_dwordx4 v6, s[48:51], s44 offen lds
    s_add_u32 s44, s44, 81920
    s_add_u32 m0, s36, 17408
    s_nop 0
    buffer_load_dwordx4 v7, s[24:27], s45 offen lds
    s_add_u32 s45, s45, 4096
    s_waitcnt lgkmcnt(8)
    v_mfma_f32_32x32x16_bf16 v[44:59], v[24:27], v[20:23], v[44:59]
    s_waitcnt lgkmcnt(6)
    v_mfma_f32_32x32x16_bf16 v[60:75], v[28:31], v[20:23], v[60:75]
    s_waitcnt lgkmcnt(4)
    v_mfma_f32_32x32x16_bf16 v[76:91], v[32:35], v[20:23], v[76:91]
    s_waitcnt lgkmcnt(2)
    v_mfma_f32_32x32x16_bf16 v[92:107], v[36:39], v[20:23], v[92:107]
    s_waitcnt lgkmcnt(0)
    v_mfma_f32_32x32x16_bf16 v[108:123], v[40:43], v[20:23], v[108:123]
    s_waitcnt vmcnt(6)
    ds_read_b128 v[20:23], v9 offset:6144
    ds_read_b64_tr_b16 v[24:25], v8 offset:6144
    ds_read_b64_tr_b16 v[26:27], v8 offset:8704
    ds_read_b64_tr_b16 v[28:29], v8 offset:6208
    ds_read_b64_tr_b16 v[30:31], v8 offset:8768
    ds_read_b64_tr_b16 v[32:33], v8 offset:6272
    ds_read_b64_tr_b16 v[34:35], v8 offset:8832
    ds_read_b64_tr_b16 v[36:37], v8 offset:6336
    ds_read_b64_tr_b16 v[38:39], v8 offset:8896
    ds_read_b64_tr_b16 v[40:41], v8 offset:6400
    ds_read_b64_tr_b16 v[42:43], v8 offset:8960
    s_add_u32 m0, s36, 0
    s_nop 0
    buffer_load_dwordx4 v2, s[48:51], s44 offen lds
    s_add_u32 m0, s36, 1024
    s_nop 0
    buffer_load_dwordx4 v3, s[48:51], s44 offen lds
    s_add_u32 m0, s36, 2048
    s_nop 0
    buffer_load_dwordx4 v4, s[48:51], s44 offen lds
    s_add_u32 m0, s36, 3072
    s_nop 0
    buffer_load_dwordx4 v5, s[48:51], s44 offen lds
    s_add_u32 m0, s36, 4096
    s_nop 0
    buffer_load_dwordx4 v6, s[48:51], s44 offen lds
    s_add_u32 s44, s44, 81920
    s_add_u32 m0, s36, 5120
    s_nop 0
    buffer_load_dwordx4 v7, s[24:27], s45 offen lds
    s_add_u32 s45, s45, 4096
    s_waitcnt lgkmcnt(8)
    v_mfma_f32_32x32x16_bf16 v[44:59], v[24:27], v[20:23], v[44:59]
    s_waitcnt lgkmcnt(6)
    v_mfma_f32_32x32x16_bf16 v[60:75], v[28:31], v[20:23], v[60:75]
    s_waitcnt lgkmcnt(4)
    v_mfma_f32_32x32x16_bf16 v[76:91], v[32:35], v[20:23], v[76:91]
    s_waitcnt lgkmcnt(2)
    v_mfma_f32_32x32x16_bf16 v[92:107], v[36:39], v[20:23], v[92:107]
    s_waitcnt lgkmcnt(0)
    v_mfma_f32_32x32x16_bf16 v[108:123], v[40:43], v[20:23], v[108:123]
    s_barrier
    s_waitcnt vmcnt(6)
    ds_read_b128 v[20:23], v9 offset:12288
    ds_read_b64_tr_b16 v[24:25], v8 offset:12288
    ds_read_b64_tr_b16 v[26:27], v8 offset:14848
    ds_read_b64_tr_b16 v[28:29], v8 offset:12352
    ds_read_b64_tr_b16 v[30:31], v8 offset:14912
    ds_read_b64_tr_b16 v[32:33], v8 offset:12416
    ds_read_b64_tr_b16 v[34:35], v8 offset:14976
    ds_read_b64_tr_b16 v[36:37], v8 offset:12480
    ds_read_b64_tr_b16 v[38:39], v8 offset:15040
    ds_read_b64_tr_b16 v[40:41], v8 offset:12544
    ds_read_b64_tr_b16 v[42:43], v8 offset:15104
    s_add_u32 m0, s36, 6144
    s_nop 0
    buffer_load_dwordx4 v2, s[48:51], s44 offen lds
    s_add_u32 m0, s36, 7168
    s_nop 0
    buffer_load_dwordx4 v3, s[48:51], s44 offen lds
    s_add_u32 m0, s36, 8192
    s_nop 0
    buffer_load_dwordx4 v4, s[48:51], s44 offen lds
    s_add_u32 m0, s36, 9216
    s_nop 0
    buffer_load_dwordx4 v5, s[48:51], s44 offen lds
    s_add_u32 m0, s36, 10240
    s_nop 0
    buffer_load_dwordx4 v6, s[48:51], s44 offen lds
    s_add_u32 s44, s44, 81920
    s_add_u32 m0, s36, 11264
    s_nop 0
    buffer_load_dwordx4 v7, s[24:27], s45 offen lds
    s_add_u32 s45, s45, 4096
    s_waitcnt lgkmcnt(8)
    v_mfma_f32_32x32x16_bf16 v[44:59], v[24:27], v[20:23], v[44:59]
    s_waitcnt lgkmcnt(6)
    v_mfma_f32_32x32x16_bf16 v[60:75], v[28:31], v[20:23], v[60:75]
    s_waitcnt lgkmcnt(4)
    v_mfma_f32_32x32x16_bf16 v[76:91], v[32:35], v[20:23], v[76:91]
    s_waitcnt lgkmcnt(2)
    v_mfma_f32_32x32x16_bf16 v[92:107], v[36:39], v[20:23], v[92:107]
    s_waitcnt lgkmcnt(0)
    v_mfma_f32_32x32x16_bf16 v[108:123], v[40:43], v[20:23], v[108:123]
    s_waitcnt vmcnt(6)
    ds_read_b128 v[20:23], v9 offset:0
    ds_read_b64_tr_b16 v[24:25], v8 offset:0
    ds_read_b64_tr_b16 v[26:27], v8 offset:2560
    ds_read_b64_tr_b16 v[28:29], v8 offset:64
    ds_read_b64_tr_b16 v[30:31], v8 offset:2624
    ds_read_b64_tr_b16 v[32:33], v8 offset:128
    ds_read_b64_tr_b16 v[34:35], v8 offset:2688
    ds_read_b64_tr_b16 v[36:37], v8 offset:192
    ds_read_b64_tr_b16 v[38:39], v8 offset:2752
    ds_read_b64_tr_b16 v[40:41], v8 offset:256
    ds_read_b64_tr_b16 v[42:43], v8 offset:2816
    s_add_u32 m0, s36, 12288
    s_nop 0
    buffer_load_dwordx4 v2, s[48:51], s44 offen lds
    s_add_u32 m0, s36, 13312
    s_nop 0
    buffer_load_dwordx4 v3, s[48:51], s44 offen lds
    s_add_u32 m0, s36, 14336
    s_nop 0
    buffer_load_dwordx4 v4, s[48:51], s44 offen lds
    s_add_u32 m0, s36, 15360
    s_nop 0
    buffer_load_dwordx4 v5, s[48:51], s44 offen lds
    s_add_u32 m0, s36, 16384
    s_nop 0
    buffer_load_dwordx4 v6, s[48:51], s44 offen lds
    s_add_u32 s44, s44, 81920
    s_add_u32 m0, s36, 17408
    s_nop 0
    buffer_load_dwordx4 v7, s[24:27], s45 offen lds
    s_add_u32 s45, s45, 4096
    s_waitcnt lgkmcnt(8)
    v_mfma_f32_32x32x16_bf16 v[44:59], v[24:27], v[20:23], v[44:59]
    s_waitcnt lgkmcnt(6)
    v_mfma_f32_32x32x16_bf16 v[60:75], v[28:31], v[20:23], v[60:75]
    s_waitcnt lgkmcnt(4)
    v_mfma_f32_32x32x16_bf16 v[76:91], v[32:35], v[20:23], v[76:91]
    s_waitcnt lgkmcnt(2)
    v_mfma_f32_32x32x16_bf16 v[92:107], v[36:39], v[20:23], v[92:107]
    s_waitcnt lgkmcnt(0)
    v_mfma_f32_32x32x16_bf16 v[108:123], v[40:43], v[20:23], v[108:123]
    s_waitcnt vmcnt(6)
    ds_read_b128 v[20:23], v9 offset:6144
    ds_read_b64_tr_b16 v[24:25], v8 offset:6144
    ds_read_b64_tr_b16 v[26:27], v8 offset:8704
    ds_read_b64_tr_b16 v[28:29], v8 offset:6208
    ds_read_b64_tr_b16 v[30:31], v8 offset:8768
    ds_read_b64_tr_b16 v[32:33], v8 offset:6272
    ds_read_b64_tr_b16 v[34:35], v8 offset:8832
    ds_read_b64_tr_b16 v[36:37], v8 offset:6336
    ds_read_b64_tr_b16 v[38:39], v8 offset:8896
    ds_read_b64_tr_b16 v[40:41], v8 offset:6400
    ds_read_b64_tr_b16 v[42:43], v8 offset:8960
    s_add_u32 m0, s36, 0
    s_nop 0
    buffer_load_dwordx4 v2, s[48:51], s44 offen lds
    s_add_u32 m0, s36, 1024
    s_nop 0
    buffer_load_dwordx4 v3, s[48:51], s44 offen lds
    s_add_u32 m0, s36, 2048
    s_nop 0
    buffer_load_dwordx4 v4, s[48:51], s44 offen lds
    s_add_u32 m0, s36, 3072
    s_nop 0
    buffer_load_dwordx4 v5, s[48:51], s44 offen lds
    s_add_u32 m0, s36, 4096
    s_nop 0
    buffer_load_dwordx4 v6, s[48:51], s44 offen lds
    s_add_u32 s44, s44, 81920
    s_add_u32 m0, s36, 5120
    s_nop 0
    buffer_load_dwordx4 v7, s[24:27], s45 offen lds
    s_add_u32 s45, s45, 4096
    s_waitcnt lgkmcnt(8)
    v_mfma_f32_32x32x16_bf16 v[44:59], v[24:27], v[20:23], v[44:59]
    s_waitcnt lgkmcnt(6)
    v_mfma_f32_32x32x16_bf16 v[60:75], v[28:31], v[20:23], v[60:75]
    s_waitcnt lgkmcnt(4)
    v_mfma_f32_32x32x16_bf16 v[76:91], v[32:35], v[20:23], v[76:91]
    s_waitcnt lgkmcnt(2)
    v_mfma_f32_32x32x16_bf16 v[92:107], v[36:39], v[20:23], v[92:107]
    s_waitcnt lgkmcnt(0)
    v_mfma_f32_32x32x16_bf16 v[108:123], v[40:43], v[20:23], v[108:123]
    s_waitcnt vmcnt(6)
    ds_read_b128 v[20:23], v9 offset:12288
    ds_read_b64_tr_b16 v[24:25], v8 offset:12288
    ds_read_b64_tr_b16 v[26:27], v8 offset:14848
    ds_read_b64_tr_b16 v[28:29], v8 offset:12352
    ds_read_b64_tr_b16 v[30:31], v8 offset:14912
    ds_read_b64_tr_b16 v[32:33], v8 offset:12416
    ds_read_b64_tr_b16 v[34:35], v8 offset:14976
    ds_read_b64_tr_b16 v[36:37], v8 offset:12480
    ds_read_b64_tr_b16 v[38:39], v8 offset:15040
    ds_read_b64_tr_b16 v[40:41], v8 offset:12544
    ds_read_b64_tr_b16 v[42:43], v8 offset:15104
    s_add_u32 m0, s36, 6144
    s_nop 0
    buffer_load_dwordx4 v2, s[48:51], s44 offen lds
    s_add_u32 m0, s36, 7168
    s_nop 0
    buffer_load_dwordx4 v3, s[48:51], s44 offen lds
    s_add_u32 m0, s36, 8192
    s_nop 0
    buffer_load_dwordx4 v4, s[48:51], s44 offen lds
    s_add_u32 m0, s36, 9216
    s_nop 0
    buffer_load_dwordx4 v5, s[48:51], s44 offen lds
    s_add_u32 m0, s36, 10240
    s_nop 0
    buffer_load_dwordx4 v6, s[48:51], s44 offen lds
    s_add_u32 s44, s44, 81920
    s_add_u32 m0, s36, 11264
    s_nop 0
    buffer_load_dwordx4 v7, s[24:27], s45 offen lds
    s_add_u32 s45, s45, 4096
    s_barrier
    s_waitcnt lgkmcnt(8)
    v_mfma_f32_32x32x16_bf16 v[44:59], v[24:27], v[20:23], v[44:59]
    s_waitcnt lgkmcnt(6)
    v_mfma_f32_32x32x16_bf16 v[60:75], v[28:31], v[20:23], v[60:75]
    s_waitcnt lgkmcnt(4)
    v_mfma_f32_32x32x16_bf16 v[76:91], v[32:35], v[20:23], v[76:91]
    s_waitcnt lgkmcnt(2)
    v_mfma_f32_32x32x16_bf16 v[92:107], v[36:39], v[20:23], v[92:107]
    s_waitcnt lgkmcnt(0)
    v_mfma_f32_32x32x16_bf16 v[108:123], v[40:43], v[20:23], v[108:123]
    s_waitcnt vmcnt(6)
    ds_read_b128 v[20:23], v9 offset:0
    ds_read_b64_tr_b16 v[24:25], v8 offset:0
    ds_read_b64_tr_b16 v[26:27], v8 offset:2560
    ds_read_b64_tr_b16 v[28:29], v8 offset:64
    ds_read_b64_tr_b16 v[30:31], v8 offset:2624
    ds_read_b64_tr_b16 v[32:33], v8 offset:128
    ds_read_b64_tr_b16 v[34:35], v8 offset:2688
    ds_read_b64_tr_b16 v[36:37], v8 offset:192
    ds_read_b64_tr_b16 v[38:39], v8 offset:2752
    ds_read_b64_tr_b16 v[40:41], v8 offset:256
    ds_read_b64_tr_b16 v[42:43], v8 offset:2816
    s_add_u32 m0, s36, 12288
    s_nop 0
    buffer_load_dwordx4 v2, s[48:51], s44 offen lds
    s_add_u32 m0, s36, 13312
    s_nop 0
    buffer_load_dwordx4 v3, s[48:51], s44 offen lds
    s_add_u32 m0, s36, 14336
    s_nop 0
    buffer_load_dwordx4 v4, s[48:51], s44 offen lds
    s_add_u32 m0, s36, 15360
    s_nop 0
    buffer_load_dwordx4 v5, s[48:51], s44 offen lds
    s_add_u32 m0, s36, 16384
    s_nop 0
    buffer_load_dwordx4 v6, s[48:51], s44 offen lds
    s_add_u32 s44, s44, 81920
    s_add_u32 m0, s36, 17408
    s_nop 0
    buffer_load_dwordx4 v7, s[24:27], s45 offen lds
    s_add_u32 s45, s45, 4096
    s_waitcnt lgkmcnt(8)
    v_mfma_f32_32x32x16_bf16 v[44:59], v[24:27], v[20:23], v[44:59]
    s_waitcnt lgkmcnt(6)
    v_mfma_f32_32x32x16_bf16 v[60:75], v[28:31], v[20:23], v[60:75]
    s_waitcnt lgkmcnt(4)
    v_mfma_f32_32x32x16_bf16 v[76:91], v[32:35], v[20:23], v[76:91]
    s_waitcnt lgkmcnt(2)
    v_mfma_f32_32x32x16_bf16 v[92:107], v[36:39], v[20:23], v[92:107]
    s_waitcnt lgkmcnt(0)
    v_mfma_f32_32x32x16_bf16 v[108:123], v[40:43], v[20:23], v[108:123]
    s_waitcnt vmcnt(6)
    ds_read_b128 v[20:23], v9 offset:6144
    ds_read_b64_tr_b16 v[24:25], v8 offset:6144
    ds_read_b64_tr_b16 v[26:27], v8 offset:8704
    ds_read_b64_tr_b16 v[28:29], v8 offset:6208
    ds_read_b64_tr_b16 v[30:31], v8 offset:8768
    ds_read_b64_tr_b16 v[32:33], v8 offset:6272
    ds_read_b64_tr_b16 v[34:35], v8 offset:8832
    ds_read_b64_tr_b16 v[36:37], v8 offset:6336
    ds_read_b64_tr_b16 v[38:39], v8 offset:8896
    ds_read_b64_tr_b16 v[40:41], v8 offset:6400
    ds_read_b64_tr_b16 v[42:43], v8 offset:8960
    s_waitcnt lgkmcnt(8)
    v_mfma_f32_32x32x16_bf16 v[44:59], v[24:27], v[20:23], v[44:59]
    s_waitcnt lgkmcnt(6)
    v_mfma_f32_32x32x16_bf16 v[60:75], v[28:31], v[20:23], v[60:75]
    s_waitcnt lgkmcnt(4)
    v_mfma_f32_32x32x16_bf16 v[76:91], v[32:35], v[20:23], v[76:91]
    s_waitcnt lgkmcnt(2)
    v_mfma_f32_32x32x16_bf16 v[92:107], v[36:39], v[20:23], v[92:107]
    s_waitcnt lgkmcnt(0)
    v_mfma_f32_32x32x16_bf16 v[108:123], v[40:43], v[20:23], v[108:123]
    s_waitcnt vmcnt(0)
    ds_read_b128 v[20:23], v9 offset:12288
    ds_read_b64_tr_b16 v[24:25], v8 offset:12288
    ds_read_b64_tr_b16 v[26:27], v8 offset:14848
    ds_read_b64_tr_b16 v[28:29], v8 offset:12352
    ds_read_b64_tr_b16 v[30:31], v8 offset:14912
    ds_read_b64_tr_b16 v[32:33], v8 offset:12416
    ds_read_b64_tr_b16 v[34:35], v8 offset:14976
    ds_read_b64_tr_b16 v[36:37], v8 offset:12480
    ds_read_b64_tr_b16 v[38:39], v8 offset:15040
    ds_read_b64_tr_b16 v[40:41], v8 offset:12544
    ds_read_b64_tr_b16 v[42:43], v8 offset:15104
    s_waitcnt lgkmcnt(8)
    v_mfma_f32_32x32x16_bf16 v[44:59], v[24:27], v[20:23], v[44:59]
    s_waitcnt lgkmcnt(6)
    v_mfma_f32_32x32x16_bf16 v[60:75], v[28:31], v[20:23], v[60:75]
    s_waitcnt lgkmcnt(4)
    v_mfma_f32_32x32x16_bf16 v[76:91], v[32:35], v[20:23], v[76:91]
    s_waitcnt lgkmcnt(2)
    v_mfma_f32_32x32x16_bf16 v[92:107], v[36:39], v[20:23], v[92:107]
    s_waitcnt lgkmcnt(0)
    v_mfma_f32_32x32x16_bf16 v[108:123], v[40:43], v[20:23], v[108:123]
    s_mov_b32 s48, s8
    s_and_b32 s49, s9, 0xffff
    s_mov_b32 s50, 819200
    s_mul_i32 s44, s15, 20480
    s_mul_i32 s46, s15, 20480
    v_subrev_u32 v16, s36, v8
    v_add_u32 v16, s46, v16
    s_add_u32 m0, s36, 0
    s_nop 0
    buffer_load_dwordx4 v2, s[48:51], s44 offen lds
    s_add_u32 m0, s36, 1024
    s_nop 0
    buffer_load_dwordx4 v3, s[48:51], s44 offen lds
    s_add_u32 m0, s36, 2048
    s_nop 0
    buffer_load_dwordx4 v4, s[48:51], s44 offen lds
    s_add_u32 m0, s36, 3072
    s_nop 0
    buffer_load_dwordx4 v5, s[48:51], s44 offen lds
    s_add_u32 m0, s36, 4096
    s_nop 0
    buffer_load_dwordx4 v6, s[48:51], s44 offen lds
    s_add_u32 s44, s44, 81920
    s_add_u32 m0, s36, 6144
    s_nop 0
    buffer_load_dwordx4 v2, s[48:51], s44 offen lds
    s_add_u32 m0, s36, 7168
    s_nop 0
    buffer_load_dwordx4 v3, s[48:51], s44 offen lds
    s_add_u32 m0, s36, 8192
    s_nop 0
    buffer_load_dwordx4 v4, s[48:51], s44 offen lds
    s_add_u32 m0, s36, 9216
    s_nop 0
    buffer_load_dwordx4 v5, s[48:51], s44 offen lds
    s_add_u32 m0, s36, 10240
    s_nop 0
    buffer_load_dwordx4 v6, s[48:51], s44 offen lds
    s_add_u32 s44, s44, 81920
    s_add_u32 m0, s36, 12288
    s_nop 0
    buffer_load_dwordx4 v2, s[48:51], s44 offen lds
    s_add_u32 m0, s36, 13312
    s_nop 0
    buffer_load_dwordx4 v3, s[48:51], s44 offen lds
    s_add_u32 m0, s36, 14336
    s_nop 0
    buffer_load_dwordx4 v4, s[48:51], s44 offen lds
    s_add_u32 m0, s36, 15360
    s_nop 0
    buffer_load_dwordx4 v5, s[48:51], s44 offen lds
    s_add_u32 m0, s36, 16384
    s_nop 0
    buffer_load_dwordx4 v6, s[48:51], s44 offen lds
    s_add_u32 s44, s44, 81920
    s_barrier
    s_nop 7
    v_mul_f32 v44, v44, v10
    v_mul_f32 v45, v45, v10
    v_mul_f32 v46, v46, v10
    v_mul_f32 v47, v47, v10
    v_mul_f32 v48, v48, v10
    v_mul_f32 v49, v49, v10
    v_mul_f32 v50, v50, v10
    v_mul_f32 v51, v51, v10
    v_mul_f32 v52, v52, v10
    v_mul_f32 v53, v53, v10
    v_mul_f32 v54, v54, v10
    v_mul_f32 v55, v55, v10
    v_mul_f32 v56, v56, v10
    v_mul_f32 v57, v57, v10
    v_mul_f32 v58, v58, v10
    v_mul_f32 v59, v59, v10
    v_mul_f32 v60, v60, v10
    v_mul_f32 v61, v61, v10
    v_mul_f32 v62, v62, v10
    v_mul_f32 v63, v63, v10
    v_mul_f32 v64, v64, v10
    v_mul_f32 v65, v65, v10
    v_mul_f32 v66, v66, v10
    v_mul_f32 v67, v67, v10
    v_mul_f32 v68, v68, v10
    v_mul_f32 v69, v69, v10
    v_mul_f32 v70, v70, v10
    v_mul_f32 v71, v71, v10
    v_mul_f32 v72, v72, v10
    v_mul_f32 v73, v73, v10
    v_mul_f32 v74, v74, v10
    v_mul_f32 v75, v75, v10
    v_mul_f32 v76, v76, v10
    v_mul_f32 v77, v77, v10
    v_mul_f32 v78, v78, v10
    v_mul_f32 v79, v79, v10
    v_mul_f32 v80, v80, v10
    v_mul_f32 v81, v81, v10
    v_mul_f32 v82, v82, v10
    v_mul_f32 v83, v83, v10
    v_mul_f32 v84, v84, v10
    v_mul_f32 v85, v85, v10
    v_mul_f32 v86, v86, v10
    v_mul_f32 v87, v87, v10
    v_mul_f32 v88, v88, v10
    v_mul_f32 v89, v89, v10
    v_mul_f32 v90, v90, v10
    v_mul_f32 v91, v91, v10
    v_mul_f32 v92, v92, v10
    v_mul_f32 v93, v93, v10
    v_mul_f32 v94, v94, v10
    v_mul_f32 v95, v95, v10
    v_mul_f32 v96, v96, v10
    v_mul_f32 v97, v97, v10
    v_mul_f32 v98, v98, v10
    v_mul_f32 v99, v99, v10
    v_mul_f32 v100, v100, v10
    v_mul_f32 v101, v101, v10
    v_mul_f32 v102, v102, v10
    v_mul_f32 v103, v103, v10
    v_mul_f32 v104, v104, v10
    v_mul_f32 v105, v105, v10
    v_mul_f32 v106, v106, v10
    v_mul_f32 v107, v107, v10
    v_mul_f32 v108, v108, v10
    v_mul_f32 v109, v109, v10
    v_mul_f32 v110, v110, v10
    v_mul_f32 v111, v111, v10
    v_mul_f32 v112, v112, v10
    v_mul_f32 v113, v113, v10
    v_mul_f32 v114, v114, v10
    v_mul_f32 v115, v115, v10
    v_mul_f32 v116, v116, v10
    v_mul_f32 v117, v117, v10
    v_mul_f32 v118, v118, v10
    v_mul_f32 v119, v119, v10
    v_mul_f32 v120, v120, v10
    v_mul_f32 v121, v121, v10
    v_mul_f32 v122, v122, v10
    v_mul_f32 v123, v123, v10
    s_barrier
    v_mov_b32 v14, 62464
    ds_read_b32 v14, v14
    s_waitcnt lgkmcnt(0)
    v_readfirstlane_b32 s20, v14
    s_nop 3
    s_cmp_eq_u32 s20, 0
    s_cbranch_scc1 k2_kernel_GNOFB
    s_mov_b32 s19, 29
k2_kernel_GFB:
    s_barrier
    s_sub_u32 s19, s19, 1
    s_cmp_lg_u32 s19, 0
    s_cbranch_scc1 k2_kernel_GFB
k2_kernel_GNOFB:
    s_barrier
    s_lshr_b32 s22, s17, 3
    s_lshl_b32 s22, s22, 7
    s_add_u32 s22, s22, 20201472
    v_mov_b32 v13, 0
    s_add_u32 m0, s46, 0
    s_nop 0
    buffer_load_dwordx4 v2, s[48:51], s44 offen lds
    s_add_u32 m0, s46, 1024
    s_nop 0
    buffer_load_dwordx4 v3, s[48:51], s44 offen lds
    s_add_u32 m0, s46, 2048
    s_nop 0
    buffer_load_dwordx4 v4, s[48:51], s44 offen lds
    s_add_u32 m0, s46, 3072
    s_nop 0
    buffer_load_dwordx4 v5, s[48:51], s44 offen lds
    s_add_u32 m0, s46, 4096
    s_nop 0
    buffer_load_dwordx4 v6, s[48:51], s44 offen lds
    s_add_u32 s44, s44, 81920
    s_add_u32 m0, s46, 5120
    s_nop 0
    buffer_load_dwordx4 v2, s[48:51], s44 offen lds
    s_add_u32 m0, s46, 6144
    s_nop 0
    buffer_load_dwordx4 v3, s[48:51], s44 offen lds
    s_add_u32 m0, s46, 7168
    s_nop 0
    buffer_load_dwordx4 v4, s[48:51], s44 offen lds
    s_add_u32 m0, s46, 8192
    s_nop 0
    buffer_load_dwordx4 v5, s[48:51], s44 offen lds
    s_add_u32 m0, s46, 9216
    s_nop 0
    buffer_load_dwordx4 v6, s[48:51], s44 offen lds
    s_add_u32 s44, s44, 81920
    buffer_load_dword v14, v13, s[24:27], s22 offen sc1
    s_add_u32 m0, s46, 10240
    s_nop 0
    buffer_load_dwordx4 v2, s[48:51], s44 offen lds
    s_add_u32 m0, s46, 11264
    s_nop 0
    buffer_load_dwordx4 v3, s[48:51], s44 offen lds
    s_add_u32 m0, s46, 12288
    s_nop 0
    buffer_load_dwordx4 v4, s[48:51], s44 offen lds
    s_add_u32 m0, s46, 13312
    s_nop 0
    buffer_load_dwordx4 v5, s[48:51], s44 offen lds
    s_add_u32 m0, s46, 14336
    s_nop 0
    buffer_load_dwordx4 v6, s[48:51], s44 offen lds
    s_add_u32 s44, s44, 81920
    s_add_u32 m0, s46, 15360
    s_nop 0
    buffer_load_dwordx4 v2, s[48:51], s44 offen lds
    s_add_u32 m0, s46, 16384
    s_nop 0
    buffer_load_dwordx4 v3, s[48:51], s44 offen lds
    s_add_u32 m0, s46, 17408
    s_nop 0
    buffer_load_dwordx4 v4, s[48:51], s44 offen lds
    s_add_u32 m0, s46, 18432
    s_nop 0
    buffer_load_dwordx4 v5, s[48:51], s44 offen lds
    s_add_u32 m0, s46, 19456
    s_nop 0
    buffer_load_dwordx4 v6, s[48:51], s44 offen lds
    s_add_u32 s44, s44, 81920
    s_waitcnt vmcnt(10)
    v_readfirstlane_b32 s20, v14
    s_nop 3
    s_cmp_ge_u32 s20, 32
    s_cbranch_scc1 k2_kernel_GO
    s_lshr_b32 s19, s17, 3
    s_lshl_b32 s19, s19, 7
    s_add_u32 s19, s19, 20201472
    v_mov_b32 v13, 0
    s_mov_b32 s21, 0
k2_kernel_POLL:
    buffer_load_dword v14, v13, s[24:27], s19 offen sc1
    s_waitcnt vmcnt(0)
    v_readfirstlane_b32 s20, v14
    s_add_u32 s21, s21, 1
    s_nop 2
    s_cmp_ge_u32 s20, 32
    s_cbranch_scc1 k2_kernel_GO
    s_sleep 1
    s_cmp_lt_u32 s21, 0x40000
    s_cbranch_scc1 k2_kernel_POLL
k2_kernel_GO:
    s_mul_i32 s19, s17, 40
    s_add_u32 s19, s19, s15
    s_lshl_b32 s19, s19, 10
    s_add_u32 s19, s19, 14942208
    v_lshlrev_b32 v13, 3, v1
    buffer_load_dwordx2 v[124:125], v13, s[24:27], s19 offen sc1
    buffer_load_dwordx2 v[126:127], v13, s[24:27], s19 offen offset:512 sc1
    s_add_u32 s19, s19, 4096
    buffer_load_dwordx2 v[128:129], v13, s[24:27], s19 offen sc1
    buffer_load_dwordx2 v[130:131], v13, s[24:27], s19 offen offset:512 sc1
    s_add_u32 s19, s19, 4096
    buffer_load_dwordx2 v[132:133], v13, s[24:27], s19 offen sc1
    buffer_load_dwordx2 v[134:135], v13, s[24:27], s19 offen offset:512 sc1
    s_add_u32 s19, s19, 4096
    buffer_load_dwordx2 v[136:137], v13, s[24:27], s19 offen sc1
    buffer_load_dwordx2 v[138:139], v13, s[24:27], s19 offen offset:512 sc1
    s_add_u32 s19, s19, 4096
    buffer_load_dwordx2 v[140:141], v13, s[24:27], s19 offen sc1
    buffer_load_dwordx2 v[142:143], v13, s[24:27], s19 offen offset:512 sc1
    s_add_u32 s19, s19, 4096
    buffer_load_dwordx2 v[144:145], v13, s[24:27], s19 offen sc1
    buffer_load_dwordx2 v[146:147], v13, s[24:27], s19 offen offset:512 sc1
    s_add_u32 s19, s19, 4096
    buffer_load_dwordx2 v[148:149], v13, s[24:27], s19 offen sc1
    buffer_load_dwordx2 v[150:151], v13, s[24:27], s19 offen offset:512 sc1
    s_add_u32 s19, s19, 4096
    buffer_load_dwordx2 v[152:153], v13, s[24:27], s19 offen sc1
    buffer_load_dwordx2 v[154:155], v13, s[24:27], s19 offen offset:512 sc1
    s_add_u32 s19, s19, 4096
    buffer_load_dwordx2 v[156:157], v13, s[24:27], s19 offen sc1
    buffer_load_dwordx2 v[158:159], v13, s[24:27], s19 offen offset:512 sc1
    s_add_u32 s19, s19, 4096
    buffer_load_dwordx2 v[160:161], v13, s[24:27], s19 offen sc1
    buffer_load_dwordx2 v[162:163], v13, s[24:27], s19 offen offset:512 sc1
    s_add_u32 s19, s19, 4096
    ds_read_b64_tr_b16 v[24:25], v8 offset:0
    ds_read_b64_tr_b16 v[26:27], v8 offset:2560
    ds_read_b64_tr_b16 v[28:29], v8 offset:64
    ds_read_b64_tr_b16 v[30:31], v8 offset:2624
    ds_read_b64_tr_b16 v[32:33], v8 offset:128
    ds_read_b64_tr_b16 v[34:35], v8 offset:2688
    ds_read_b64_tr_b16 v[36:37], v8 offset:192
    ds_read_b64_tr_b16 v[38:39], v8 offset:2752
    ds_read_b64_tr_b16 v[40:41], v8 offset:256
    ds_read_b64_tr_b16 v[42:43], v8 offset:2816
    s_waitcnt vmcnt(18)
    s_waitcnt lgkmcnt(8)
    v_mfma_f32_32x32x16_bf16 v[44:59], v[24:27], v[124:127], v[44:59]
    ds_read_b64_tr_b16 v[24:25], v8 offset:6144
    ds_read_b64_tr_b16 v[26:27], v8 offset:8704
    s_waitcnt lgkmcnt(8)
    v_mfma_f32_32x32x16_bf16 v[60:75], v[28:31], v[124:127], v[60:75]
    ds_read_b64_tr_b16 v[28:29], v8 offset:6208
    ds_read_b64_tr_b16 v[30:31], v8 offset:8768
    s_waitcnt lgkmcnt(8)
    v_mfma_f32_32x32x16_bf16 v[76:91], v[32:35], v[124:127], v[76:91]
    ds_read_b64_tr_b16 v[32:33], v8 offset:6272
    ds_read_b64_tr_b16 v[34:35], v8 offset:8832
    s_waitcnt lgkmcnt(8)
    v_mfma_f32_32x32x16_bf16 v[92:107], v[36:39], v[124:127], v[92:107]
    ds_read_b64_tr_b16 v[36:37], v8 offset:6336
    ds_read_b64_tr_b16 v[38:39], v8 offset:8896
    s_waitcnt lgkmcnt(8)
    v_mfma_f32_32x32x16_bf16 v[108:123], v[40:43], v[124:127], v[108:123]
    ds_read_b64_tr_b16 v[40:41], v8 offset:6400
    ds_read_b64_tr_b16 v[42:43], v8 offset:8960
    s_add_u32 m0, s36, 0
    s_nop 0
    buffer_load_dwordx4 v2, s[48:51], s44 offen lds
    s_add_u32 m0, s36, 1024
    s_nop 0
    buffer_load_dwordx4 v3, s[48:51], s44 offen lds
    s_add_u32 m0, s36, 2048
    s_nop 0
    buffer_load_dwordx4 v4, s[48:51], s44 offen lds
    s_add_u32 m0, s36, 3072
    s_nop 0
    buffer_load_dwordx4 v5, s[48:51], s44 offen lds
    s_add_u32 m0, s36, 4096
    s_nop 0
    buffer_load_dwordx4 v6, s[48:51], s44 offen lds
    s_add_u32 s44, s44, 81920
    s_waitcnt vmcnt(21)
    s_waitcnt lgkmcnt(8)
    v_mfma_f32_32x32x16_bf16 v[44:59], v[24:27], v[128:131], v[44:59]
    ds_read_b64_tr_b16 v[24:25], v8 offset:12288
    ds_read_b64_tr_b16 v[26:27], v8 offset:14848
    s_waitcnt lgkmcnt(8)
    v_mfma_f32_32x32x16_bf16 v[60:75], v[28:31], v[128:131], v[60:75]
    ds_read_b64_tr_b16 v[28:29], v8 offset:12352
    ds_read_b64_tr_b16 v[30:31], v8 offset:14912
    s_waitcnt lgkmcnt(8)
    v_mfma_f32_32x32x16_bf16 v[76:91], v[32:35], v[128:131], v[76:91]
    ds_read_b64_tr_b16 v[32:33], v8 offset:12416
    ds_read_b64_tr_b16 v[34:35], v8 offset:14976
    s_waitcnt lgkmcnt(8)
    v_mfma_f32_32x32x16_bf16 v[92:107], v[36:39], v[128:131], v[92:107]
    ds_read_b64_tr_b16 v[36:37], v8 offset:12480
    ds_read_b64_tr_b16 v[38:39], v8 offset:15040
    s_waitcnt lgkmcnt(8)
    v_mfma_f32_32x32x16_bf16 v[108:123], v[40:43], v[128:131], v[108:123]
    ds_read_b64_tr_b16 v[40:41], v8 offset:12544
    ds_read_b64_tr_b16 v[42:43], v8 offset:15104
    s_add_u32 m0, s36, 6144
    s_nop 0
    buffer_load_dwordx4 v2, s[48:51], s44 offen lds
    s_add_u32 m0, s36, 7168
    s_nop 0
    buffer_load_dwordx4 v3, s[48:51], s44 offen lds
    s_add_u32 m0, s36, 8192
    s_nop 0
    buffer_load_dwordx4 v4, s[48:51], s44 offen lds
    s_add_u32 m0, s36, 9216
    s_nop 0
    buffer_load_dwordx4 v5, s[48:51], s44 offen lds
    s_add_u32 m0, s36, 10240
    s_nop 0
    buffer_load_dwordx4 v6, s[48:51], s44 offen lds
    s_add_u32 s44, s44, 81920
    s_waitcnt vmcnt(24)
    s_waitcnt lgkmcnt(8)
    v_mfma_f32_32x32x16_bf16 v[44:59], v[24:27], v[132:135], v[44:59]
    ds_read_b64_tr_b16 v[24:25], v16 offset:0
    ds_read_b64_tr_b16 v[26:27], v16 offset:2560
    s_waitcnt lgkmcnt(8)
    v_mfma_f32_32x32x16_bf16 v[60:75], v[28:31], v[132:135], v[60:75]
    ds_read_b64_tr_b16 v[28:29], v16 offset:64
    ds_read_b64_tr_b16 v[30:31], v16 offset:2624
    s_waitcnt lgkmcnt(8)
    v_mfma_f32_32x32x16_bf16 v[76:91], v[32:35], v[132:135], v[76:91]
    ds_read_b64_tr_b16 v[32:33], v16 offset:128
    ds_read_b64_tr_b16 v[34:35], v16 offset:2688
    s_waitcnt lgkmcnt(8)
    v_mfma_f32_32x32x16_bf16 v[92:107], v[36:39], v[132:135], v[92:107]
    ds_read_b64_tr_b16 v[36:37], v16 offset:192
    ds_read_b64_tr_b16 v[38:39], v16 offset:2752
    s_waitcnt lgkmcnt(8)
    v_mfma_f32_32x32x16_bf16 v[108:123], v[40:43], v[132:135], v[108:123]
    ds_read_b64_tr_b16 v[40:41], v16 offset:256
    ds_read_b64_tr_b16 v[42:43], v16 offset:2816
    s_add_u32 m0, s36, 12288
    s_nop 0
    buffer_load_dwordx4 v2, s[48:51], s44 offen lds
    s_add_u32 m0, s36, 13312
    s_nop 0
    buffer_load_dwordx4 v3, s[48:51], s44 offen lds
    s_add_u32 m0, s36, 14336
    s_nop 0
    buffer_load_dwordx4 v4, s[48:51], s44 offen lds
    s_add_u32 m0, s36, 15360
    s_nop 0
    buffer_load_dwordx4 v5, s[48:51], s44 offen lds
    s_add_u32 m0, s36, 16384
    s_nop 0
    buffer_load_dwordx4 v6, s[48:51], s44 offen lds
    s_add_u32 s44, s44, 81920
    s_waitcnt vmcnt(27)
    s_waitcnt lgkmcnt(8)
    v_mfma_f32_32x32x16_bf16 v[44:59], v[24:27], v[136:139], v[44:59]
    ds_read_b64_tr_b16 v[24:25], v16 offset:5120
    ds_read_b64_tr_b16 v[26:27], v16 offset:7680
    s_waitcnt lgkmcnt(8)
    v_mfma_f32_32x32x16_bf16 v[60:75], v[28:31], v[136:139], v[60:75]
    ds_read_b64_tr_b16 v[28:29], v16 offset:5184
    ds_read_b64_tr_b16 v[30:31], v16 offset:7744
    s_waitcnt lgkmcnt(8)
    v_mfma_f32_32x32x16_bf16 v[76:91], v[32:35], v[136:139], v[76:91]
    ds_read_b64_tr_b16 v[32:33], v16 offset:5248
    ds_read_b64_tr_b16 v[34:35], v16 offset:7808
    s_waitcnt lgkmcnt(8)
    v_mfma_f32_32x32x16_bf16 v[92:107], v[36:39], v[136:139], v[92:107]
    ds_read_b64_tr_b16 v[36:37], v16 offset:5312
    ds_read_b64_tr_b16 v[38:39], v16 offset:7872
    s_waitcnt lgkmcnt(8)
    v_mfma_f32_32x32x16_bf16 v[108:123], v[40:43], v[136:139], v[108:123]
    ds_read_b64_tr_b16 v[40:41], v16 offset:5376
    ds_read_b64_tr_b16 v[42:43], v16 offset:7936
    s_waitcnt vmcnt(25)
    s_waitcnt lgkmcnt(8)
    v_mfma_f32_32x32x16_bf16 v[44:59], v[24:27], v[140:143], v[44:59]
    ds_read_b64_tr_b16 v[24:25], v16 offset:10240
    ds_read_b64_tr_b16 v[26:27], v16 offset:12800
    s_waitcnt lgkmcnt(8)
    v_mfma_f32_32x32x16_bf16 v[60:75], v[28:31], v[140:143], v[60:75]
    ds_read_b64_tr_b16 v[28:29], v16 offset:10304
    ds_read_b64_tr_b16 v[30:31], v16 offset:12864
    s_waitcnt lgkmcnt(8)
    v_mfma_f32_32x32x16_bf16 v[76:91], v[32:35], v[140:143], v[76:91]
    ds_read_b64_tr_b16 v[32:33], v16 offset:10368
    ds_read_b64_tr_b16 v[34:35], v16 offset:12928
    s_waitcnt lgkmcnt(8)
    v_mfma_f32_32x32x16_bf16 v[92:107], v[36:39], v[140:143], v[92:107]
    ds_read_b64_tr_b16 v[36:37], v16 offset:10432
    ds_read_b64_tr_b16 v[38:39], v16 offset:12992
    s_waitcnt lgkmcnt(8)
    v_mfma_f32_32x32x16_bf16 v[108:123], v[40:43], v[140:143], v[108:123]
    ds_read_b64_tr_b16 v[40:41], v16 offset:10496
    ds_read_b64_tr_b16 v[42:43], v16 offset:13056
    s_waitcnt vmcnt(23)
    s_waitcnt lgkmcnt(8)
    v_mfma_f32_32x32x16_bf16 v[44:59], v[24:27], v[144:147], v[44:59]
    ds_read_b64_tr_b16 v[24:25], v16 offset:15360
    ds_read_b64_tr_b16 v[26:27], v16 offset:17920
    s_waitcnt lgkmcnt(8)
    v_mfma_f32_32x32x16_bf16 v[60:75], v[28:31], v[144:147], v[60:75]
    ds_read_b64_tr_b16 v[28:29], v16 offset:15424
    ds_read_b64_tr_b16 v[30:31], v16 offset:17984
    s_waitcnt lgkmcnt(8)
    v_mfma_f32_32x32x16_bf16 v[76:91], v[32:35], v[144:147], v[76:91]
    ds_read_b64_tr_b16 v[32:33], v16 offset:15488
    ds_read_b64_tr_b16 v[34:35], v16 offset:18048
    s_waitcnt lgkmcnt(8)
    v_mfma_f32_32x32x16_bf16 v[92:107], v[36:39], v[144:147], v[92:107]
    ds_read_b64_tr_b16 v[36:37], v16 offset:15552
    ds_read_b64_tr_b16 v[38:39], v16 offset:18112
    s_waitcnt lgkmcnt(8)
    v_mfma_f32_32x32x16_bf16 v[108:123], v[40:43], v[144:147], v[108:123]
    ds_read_b64_tr_b16 v[40:41], v16 offset:15616
    ds_read_b64_tr_b16 v[42:43], v16 offset:18176
    s_waitcnt vmcnt(21)
    s_waitcnt lgkmcnt(8)
    v_mfma_f32_32x32x16_bf16 v[44:59], v[24:27], v[148:151], v[44:59]
    s_waitcnt vmcnt(10)
    ds_read_b64_tr_b16 v[24:25], v8 offset:0
    ds_read_b64_tr_b16 v[26:27], v8 offset:2560
    s_waitcnt lgkmcnt(8)
    v_mfma_f32_32x32x16_bf16 v[60:75], v[28:31], v[148:151], v[60:75]
    ds_read_b64_tr_b16 v[28:29], v8 offset:64
    ds_read_b64_tr_b16 v[30:31], v8 offset:2624
    s_waitcnt lgkmcnt(8)
    v_mfma_f32_32x32x16_bf16 v[76:91], v[32:35], v[148:151], v[76:91]
    ds_read_b64_tr_b16 v[32:33], v8 offset:128
    ds_read_b64_tr_b16 v[34:35], v8 offset:2688
    s_waitcnt lgkmcnt(8)
    v_mfma_f32_32x32x16_bf16 v[92:107], v[36:39], v[148:151], v[92:107]
    ds_read_b64_tr_b16 v[36:37], v8 offset:192
    ds_read_b64_tr_b16 v[38:39], v8 offset:2752
    s_waitcnt lgkmcnt(8)
    v_mfma_f32_32x32x16_bf16 v[108:123], v[40:43], v[148:151], v[108:123]
    ds_read_b64_tr_b16 v[40:41], v8 offset:256
    ds_read_b64_tr_b16 v[42:43], v8 offset:2816
    s_waitcnt vmcnt(10)
    s_waitcnt lgkmcnt(8)
    v_mfma_f32_32x32x16_bf16 v[44:59], v[24:27], v[152:155], v[44:59]
    s_waitcnt vmcnt(5)
    ds_read_b64_tr_b16 v[24:25], v8 offset:6144
    ds_read_b64_tr_b16 v[26:27], v8 offset:8704
    s_waitcnt lgkmcnt(8)
    v_mfma_f32_32x32x16_bf16 v[60:75], v[28:31], v[152:155], v[60:75]
    ds_read_b64_tr_b16 v[28:29], v8 offset:6208
    ds_read_b64_tr_b16 v[30:31], v8 offset:8768
    s_waitcnt lgkmcnt(8)
    v_mfma_f32_32x32x16_bf16 v[76:91], v[32:35], v[152:155], v[76:91]
    ds_read_b64_tr_b16 v[32:33], v8 offset:6272
    ds_read_b64_tr_b16 v[34:35], v8 offset:8832
    s_waitcnt lgkmcnt(8)
    v_mfma_f32_32x32x16_bf16 v[92:107], v[36:39], v[152:155], v[92:107]
    ds_read_b64_tr_b16 v[36:37], v8 offset:6336
    ds_read_b64_tr_b16 v[38:39], v8 offset:8896
    s_waitcnt lgkmcnt(8)
    v_mfma_f32_32x32x16_bf16 v[108:123], v[40:43], v[152:155], v[108:123]
    ds_read_b64_tr_b16 v[40:41], v8 offset:6400
    ds_read_b64_tr_b16 v[42:43], v8 offset:8960
    s_waitcnt vmcnt(5)
    s_waitcnt lgkmcnt(8)
    v_mfma_f32_32x32x16_bf16 v[44:59], v[24:27], v[156:159], v[44:59]
    s_waitcnt vmcnt(0)
    ds_read_b64_tr_b16 v[24:25], v8 offset:12288
    ds_read_b64_tr_b16 v[26:27], v8 offset:14848
    s_waitcnt lgkmcnt(8)
    v_mfma_f32_32x32x16_bf16 v[60:75], v[28:31], v[156:159], v[60:75]
    ds_read_b64_tr_b16 v[28:29], v8 offset:12352
    ds_read_b64_tr_b16 v[30:31], v8 offset:14912
    s_waitcnt lgkmcnt(8)
    v_mfma_f32_32x32x16_bf16 v[76:91], v[32:35], v[156:159], v[76:91]
    ds_read_b64_tr_b16 v[32:33], v8 offset:12416
    ds_read_b64_tr_b16 v[34:35], v8 offset:14976
    s_waitcnt lgkmcnt(8)
    v_mfma_f32_32x32x16_bf16 v[92:107], v[36:39], v[156:159], v[92:107]
    ds_read_b64_tr_b16 v[36:37], v8 offset:12480
    ds_read_b64_tr_b16 v[38:39], v8 offset:15040
    s_waitcnt lgkmcnt(8)
    v_mfma_f32_32x32x16_bf16 v[108:123], v[40:43], v[156:159], v[108:123]
    ds_read_b64_tr_b16 v[40:41], v8 offset:12544
    ds_read_b64_tr_b16 v[42:43], v8 offset:15104
    s_waitcnt vmcnt(0)
    s_waitcnt lgkmcnt(8)
    v_mfma_f32_32x32x16_bf16 v[44:59], v[24:27], v[160:163], v[44:59]
    s_waitcnt lgkmcnt(6)
    v_mfma_f32_32x32x16_bf16 v[60:75], v[28:31], v[160:163], v[60:75]
    s_waitcnt lgkmcnt(4)
    v_mfma_f32_32x32x16_bf16 v[76:91], v[32:35], v[160:163], v[76:91]
    s_waitcnt lgkmcnt(2)
    v_mfma_f32_32x32x16_bf16 v[92:107], v[36:39], v[160:163], v[92:107]
    s_waitcnt lgkmcnt(0)
    v_mfma_f32_32x32x16_bf16 v[108:123], v[40:43], v[160:163], v[108:123]
    s_nop 7
    s_nop 3
    s_barrier
    s_cmp_eq_u32 s15, 0
    s_cbranch_scc0 k2_kernel_GX0
    v_add_u32 v16, 87104, v7
    v_add_u32 v15, 117824, v7
    ds_write_b128 v16, v[68:71] offset:18432
    ds_write_b128 v16, v[72:75] offset:19456
    ds_write_b128 v16, v[76:79] offset:24576
    ds_write_b128 v16, v[80:83] offset:25600
    ds_write_b128 v15, v[84:87] offset:0
    ds_write_b128 v15, v[88:91] offset:1024
    ds_write_b128 v15, v[92:95] offset:6144
    ds_write_b128 v15, v[96:99] offset:7168
    s_waitcnt lgkmcnt(4)
    ds_write_b128 v15, v[100:103] offset:12288
    ds_write_b128 v15, v[104:107] offset:13312
    ds_write_b128 v15, v[108:111] offset:18432
    ds_write_b128 v15, v[112:115] offset:19456
    ds_write_b128 v15, v[116:119] offset:24576
    ds_write_b128 v15, v[120:123] offset:25600
    v_and_b32 v11, 31, v1
    s_lshl_b32 s19, s17, 5
    v_add_u32 v11, s19, v11
    v_mul_u32_u24 v11, 1280, v11
    v_lshrrev_b32 v13, 5, v1
    v_lshl_add_u32 v11, v13, 4, v11
    s_mul_i32 s19, s18, 320
    s_waitcnt lgkmcnt(0)
    s_barrier
    ds_read_b128 v[124:127], v16 offset:0
    ds_read_b128 v[128:131], v16 offset:2048
    ds_read_b128 v[132:135], v16 offset:4096
    ds_read_b128 v[136:139], v16 offset:1024
    ds_read_b128 v[140:143], v16 offset:3072
    ds_read_b128 v[144:147], v16 offset:5120
    s_waitcnt lgkmcnt(5)
    v_add_f32 v44, v44, v124
    v_add_f32 v45, v45, v125
    v_add_f32 v46, v46, v126
    v_add_f32 v47, v47, v127
    s_waitcnt lgkmcnt(4)
    v_add_f32 v44, v44, v128
    v_add_f32 v45, v45, v129
    v_add_f32 v46, v46, v130
    v_add_f32 v47, v47, v131
    s_waitcnt lgkmcnt(3)
    v_add_f32 v44, v44, v132
    v_add_f32 v45, v45, v133
    v_add_f32 v46, v46, v134
    v_add_f32 v47, v47, v135
    s_waitcnt lgkmcnt(2)
    v_add_f32 v48, v48, v136
    v_add_f32 v49, v49, v137
    v_add_f32 v50, v50, v138
    v_add_f32 v51, v51, v139
    s_waitcnt lgkmcnt(1)
    v_add_f32 v48, v48, v140
    v_add_f32 v49, v49, v141
    v_add_f32 v50, v50, v142
    v_add_f32 v51, v51, v143
    s_waitcnt lgkmcnt(0)
    v_add_f32 v48, v48, v144
    v_add_f32 v49, v49, v145
    v_add_f32 v50, v50, v146
    v_add_f32 v51, v51, v147
    v_cvt_pk_bf16_f32 v148, v44, v45
    v_cvt_pk_bf16_f32 v149, v46, v47
    v_cvt_pk_bf16_f32 v150, v48, v49
    v_cvt_pk_bf16_f32 v151, v50, v51
    s_nop 1
    v_permlane32_swap_b32 v148, v150
    v_permlane32_swap_b32 v149, v151
    s_add_u32 s21, s19, 0
    s_nop 0
    buffer_store_dwordx4 v[148:151], v11, s[52:55], s21 offen
    ds_read_b128 v[124:127], v16 offset:6144
    ds_read_b128 v[128:131], v16 offset:8192
    ds_read_b128 v[132:135], v16 offset:10240
    ds_read_b128 v[136:139], v16 offset:7168
    ds_read_b128 v[140:143], v16 offset:9216
    ds_read_b128 v[144:147], v16 offset:11264
    s_waitcnt lgkmcnt(5)
    v_add_f32 v52, v52, v124
    v_add_f32 v53, v53, v125
    v_add_f32 v54, v54, v126
    v_add_f32 v55, v55, v127
    s_waitcnt lgkmcnt(4)
    v_add_f32 v52, v52, v128
    v_add_f32 v53, v53, v129
    v_add_f32 v54, v54, v130
    v_add_f32 v55, v55, v131
    s_waitcnt lgkmcnt(3)
    v_add_f32 v52, v52, v132
    v_add_f32 v53, v53, v133
    v_add_f32 v54, v54, v134
    v_add_f32 v55, v55, v135
    s_waitcnt lgkmcnt(2)
    v_add_f32 v56, v56, v136
    v_add_f32 v57, v57, v137
    v_add_f32 v58, v58, v138
    v_add_f32 v59, v59, v139
    s_waitcnt lgkmcnt(1)
    v_add_f32 v56, v56, v140
    v_add_f32 v57, v57, v141
    v_add_f32 v58, v58, v142
    v_add_f32 v59, v59, v143
    s_waitcnt lgkmcnt(0)
    v_add_f32 v56, v56, v144
    v_add_f32 v57, v57, v145
    v_add_f32 v58, v58, v146
    v_add_f32 v59, v59, v147
    v_cvt_pk_bf16_f32 v152, v52, v53
    v_cvt_pk_bf16_f32 v153, v54, v55
    v_cvt_pk_bf16_f32 v154, v56, v57
    v_cvt_pk_bf16_f32 v155, v58, v59
    s_nop 1
    v_permlane32_swap_b32 v152, v154
    v_permlane32_swap_b32 v153, v155
    s_add_u32 s21, s19, 32
    s_nop 0
    buffer_store_dwordx4 v[152:155], v11, s[52:55], s21 offen
    ds_read_b128 v[124:127], v16 offset:12288
    ds_read_b128 v[128:131], v16 offset:14336
    ds_read_b128 v[132:135], v16 offset:16384
    ds_read_b128 v[136:139], v16 offset:13312
    ds_read_b128 v[140:143], v16 offset:15360
    ds_read_b128 v[144:147], v16 offset:17408
    s_waitcnt lgkmcnt(5)
    v_add_f32 v60, v60, v124
    v_add_f32 v61, v61, v125
    v_add_f32 v62, v62, v126
    v_add_f32 v63, v63, v127
    s_waitcnt lgkmcnt(4)
    v_add_f32 v60, v60, v128
    v_add_f32 v61, v61, v129
    v_add_f32 v62, v62, v130
    v_add_f32 v63, v63, v131
    s_waitcnt lgkmcnt(3)
    v_add_f32 v60, v60, v132
    v_add_f32 v61, v61, v133
    v_add_f32 v62, v62, v134
    v_add_f32 v63, v63, v135
    s_waitcnt lgkmcnt(2)
    v_add_f32 v64, v64, v136
    v_add_f32 v65, v65, v137
    v_add_f32 v66, v66, v138
    v_add_f32 v67, v67, v139
    s_waitcnt lgkmcnt(1)
    v_add_f32 v64, v64, v140
    v_add_f32 v65, v65, v141
    v_add_f32 v66, v66, v142
    v_add_f32 v67, v67, v143
    s_waitcnt lgkmcnt(0)
    v_add_f32 v64, v64, v144
    v_add_f32 v65, v65, v145
    v_add_f32 v66, v66, v146
    v_add_f32 v67, v67, v147
    v_cvt_pk_bf16_f32 v148, v60, v61
    v_cvt_pk_bf16_f32 v149, v62, v63
    v_cvt_pk_bf16_f32 v150, v64, v65
    v_cvt_pk_bf16_f32 v151, v66, v67
    s_nop 1
    v_permlane32_swap_b32 v148, v150
    v_permlane32_swap_b32 v149, v151
    s_add_u32 s21, s19, 64
    s_nop 0
    buffer_store_dwordx4 v[148:151], v11, s[52:55], s21 offen
    s_branch k2_kernel_GEND
k2_kernel_GX0:
    s_cmp_eq_u32 s15, 1
    s_cbranch_scc0 k2_kernel_GX1
    v_add_u32 v16, 87104, v7
    v_add_u32 v15, 117824, v7
    ds_write_b128 v16, v[44:47] offset:0
    ds_write_b128 v16, v[48:51] offset:1024
    ds_write_b128 v16, v[52:55] offset:6144
    ds_write_b128 v16, v[56:59] offset:7168
    ds_write_b128 v16, v[60:63] offset:12288
    ds_write_b128 v16, v[64:67] offset:13312
    ds_write_b128 v15, v[92:95] offset:8192
    ds_write_b128 v15, v[96:99] offset:9216
    s_waitcnt lgkmcnt(4)
    ds_write_b128 v15, v[100:103] offset:14336
    ds_write_b128 v15, v[104:107] offset:15360
    ds_write_b128 v15, v[108:111] offset:20480
    ds_write_b128 v15, v[112:115] offset:21504
    ds_write_b128 v15, v[116:119] offset:26624
    ds_write_b128 v15, v[120:123] offset:27648
    v_and_b32 v11, 31, v1
    s_lshl_b32 s19, s17, 5
    v_add_u32 v11, s19, v11
    v_mul_u32_u24 v11, 1280, v11
    v_lshrrev_b32 v13, 5, v1
    v_lshl_add_u32 v11, v13, 4, v11
    s_mul_i32 s19, s18, 320
    s_waitcnt lgkmcnt(0)
    s_barrier
    ds_read_b128 v[124:127], v16 offset:18432
    ds_read_b128 v[128:131], v16 offset:20480
    ds_read_b128 v[132:135], v16 offset:22528
    ds_read_b128 v[136:139], v16 offset:19456
    ds_read_b128 v[140:143], v16 offset:21504
    ds_read_b128 v[144:147], v16 offset:23552
    s_waitcnt lgkmcnt(5)
    v_add_f32 v68, v68, v124
    v_add_f32 v69, v69, v125
    v_add_f32 v70, v70, v126
    v_add_f32 v71, v71, v127
    s_waitcnt lgkmcnt(4)
    v_add_f32 v68, v68, v128
    v_add_f32 v69, v69, v129
    v_add_f32 v70, v70, v130
    v_add_f32 v71, v71, v131
    s_waitcnt lgkmcnt(3)
    v_add_f32 v68, v68, v132
    v_add_f32 v69, v69, v133
    v_add_f32 v70, v70, v134
    v_add_f32 v71, v71, v135
    s_waitcnt lgkmcnt(2)
    v_add_f32 v72, v72, v136
    v_add_f32 v73, v73, v137
    v_add_f32 v74, v74, v138
    v_add_f32 v75, v75, v139
    s_waitcnt lgkmcnt(1)
    v_add_f32 v72, v72, v140
    v_add_f32 v73, v73, v141
    v_add_f32 v74, v74, v142
    v_add_f32 v75, v75, v143
    s_waitcnt lgkmcnt(0)
    v_add_f32 v72, v72, v144
    v_add_f32 v73, v73, v145
    v_add_f32 v74, v74, v146
    v_add_f32 v75, v75, v147
    v_cvt_pk_bf16_f32 v148, v68, v69
    v_cvt_pk_bf16_f32 v149, v70, v71
    v_cvt_pk_bf16_f32 v150, v72, v73
    v_cvt_pk_bf16_f32 v151, v74, v75
    s_nop 1
    v_permlane32_swap_b32 v148, v150
    v_permlane32_swap_b32 v149, v151
    s_add_u32 s21, s19, 96
    s_nop 0
    buffer_store_dwordx4 v[148:151], v11, s[52:55], s21 offen
    ds_read_b128 v[124:127], v16 offset:24576
    ds_read_b128 v[128:131], v16 offset:26624
    ds_read_b128 v[132:135], v16 offset:28672
    ds_read_b128 v[136:139], v16 offset:25600
    ds_read_b128 v[140:143], v16 offset:27648
    ds_read_b128 v[144:147], v16 offset:29696
    s_waitcnt lgkmcnt(5)
    v_add_f32 v76, v76, v124
    v_add_f32 v77, v77, v125
    v_add_f32 v78, v78, v126
    v_add_f32 v79, v79, v127
    s_waitcnt lgkmcnt(4)
    v_add_f32 v76, v76, v128
    v_add_f32 v77, v77, v129
    v_add_f32 v78, v78, v130
    v_add_f32 v79, v79, v131
    s_waitcnt lgkmcnt(3)
    v_add_f32 v76, v76, v132
    v_add_f32 v77, v77, v133
    v_add_f32 v78, v78, v134
    v_add_f32 v79, v79, v135
    s_waitcnt lgkmcnt(2)
    v_add_f32 v80, v80, v136
    v_add_f32 v81, v81, v137
    v_add_f32 v82, v82, v138
    v_add_f32 v83, v83, v139
    s_waitcnt lgkmcnt(1)
    v_add_f32 v80, v80, v140
    v_add_f32 v81, v81, v141
    v_add_f32 v82, v82, v142
    v_add_f32 v83, v83, v143
    s_waitcnt lgkmcnt(0)
    v_add_f32 v80, v80, v144
    v_add_f32 v81, v81, v145
    v_add_f32 v82, v82, v146
    v_add_f32 v83, v83, v147
    v_cvt_pk_bf16_f32 v152, v76, v77
    v_cvt_pk_bf16_f32 v153, v78, v79
    v_cvt_pk_bf16_f32 v154, v80, v81
    v_cvt_pk_bf16_f32 v155, v82, v83
    s_nop 1
    v_permlane32_swap_b32 v152, v154
    v_permlane32_swap_b32 v153, v155
    s_add_u32 s21, s19, 128
    s_nop 0
    buffer_store_dwordx4 v[152:155], v11, s[52:55], s21 offen
    ds_read_b128 v[124:127], v15 offset:0
    ds_read_b128 v[128:131], v15 offset:2048
    ds_read_b128 v[132:135], v15 offset:4096
    ds_read_b128 v[136:139], v15 offset:1024
    ds_read_b128 v[140:143], v15 offset:3072
    ds_read_b128 v[144:147], v15 offset:5120
    s_waitcnt lgkmcnt(5)
    v_add_f32 v84, v84, v124
    v_add_f32 v85, v85, v125
    v_add_f32 v86, v86, v126
    v_add_f32 v87, v87, v127
    s_waitcnt lgkmcnt(4)
    v_add_f32 v84, v84, v128
    v_add_f32 v85, v85, v129
    v_add_f32 v86, v86, v130
    v_add_f32 v87, v87, v131
    s_waitcnt lgkmcnt(3)
    v_add_f32 v84, v84, v132
    v_add_f32 v85, v85, v133
    v_add_f32 v86, v86, v134
    v_add_f32 v87, v87, v135
    s_waitcnt lgkmcnt(2)
    v_add_f32 v88, v88, v136
    v_add_f32 v89, v89, v137
    v_add_f32 v90, v90, v138
    v_add_f32 v91, v91, v139
    s_waitcnt lgkmcnt(1)
    v_add_f32 v88, v88, v140
    v_add_f32 v89, v89, v141
    v_add_f32 v90, v90, v142
    v_add_f32 v91, v91, v143
    s_waitcnt lgkmcnt(0)
    v_add_f32 v88, v88, v144
    v_add_f32 v89, v89, v145
    v_add_f32 v90, v90, v146
    v_add_f32 v91, v91, v147
    v_cvt_pk_bf16_f32 v148, v84, v85
    v_cvt_pk_bf16_f32 v149, v86, v87
    v_cvt_pk_bf16_f32 v150, v88, v89
    v_cvt_pk_bf16_f32 v151, v90, v91
    s_nop 1
    v_permlane32_swap_b32 v148, v150
    v_permlane32_swap_b32 v149, v151
    s_add_u32 s21, s19, 160
    s_nop 0
    buffer_store_dwordx4 v[148:151], v11, s[52:55], s21 offen
    s_branch k2_kernel_GEND
k2_kernel_GX1:
    s_cmp_eq_u32 s15, 2
    s_cbranch_scc0 k2_kernel_GX2
    v_add_u32 v16, 87104, v7
    v_add_u32 v15, 117824, v7
    ds_write_b128 v16, v[44:47] offset:2048
    ds_write_b128 v16, v[48:51] offset:3072
    ds_write_b128 v16, v[52:55] offset:8192
    ds_write_b128 v16, v[56:59] offset:9216
    ds_write_b128 v16, v[60:63] offset:14336
    ds_write_b128 v16, v[64:67] offset:15360
    ds_write_b128 v16, v[68:71] offset:20480
    ds_write_b128 v16, v[72:75] offset:21504
    s_waitcnt lgkmcnt(4)
    ds_write_b128 v16, v[76:79] offset:26624
    ds_write_b128 v16, v[80:83] offset:27648
    ds_write_b128 v15, v[84:87] offset:2048
    ds_write_b128 v15, v[88:91] offset:3072
    ds_write_b128 v15, v[108:111] offset:22528
    ds_write_b128 v15, v[112:115] offset:23552
    ds_write_b128 v15, v[116:119] offset:28672
    ds_write_b128 v15, v[120:123] offset:29696
    s_waitcnt lgkmcnt(4)
    v_and_b32 v11, 31, v1
    s_lshl_b32 s19, s17, 5
    v_add_u32 v11, s19, v11
    v_mul_u32_u24 v11, 1280, v11
    v_lshrrev_b32 v13, 5, v1
    v_lshl_add_u32 v11, v13, 4, v11
    s_mul_i32 s19, s18, 320
    s_waitcnt lgkmcnt(0)
    s_barrier
    ds_read_b128 v[124:127], v15 offset:6144
    ds_read_b128 v[128:131], v15 offset:8192
    ds_read_b128 v[132:135], v15 offset:10240
    ds_read_b128 v[136:139], v15 offset:7168
    ds_read_b128 v[140:143], v15 offset:9216
    ds_read_b128 v[144:147], v15 offset:11264
    s_waitcnt lgkmcnt(5)
    v_add_f32 v92, v92, v124
    v_add_f32 v93, v93, v125
    v_add_f32 v94, v94, v126
    v_add_f32 v95, v95, v127
    s_waitcnt lgkmcnt(4)
    v_add_f32 v92, v92, v128
    v_add_f32 v93, v93, v129
    v_add_f32 v94, v94, v130
    v_add_f32 v95, v95, v131
    s_waitcnt lgkmcnt(3)
    v_add_f32 v92, v92, v132
    v_add_f32 v93, v93, v133
    v_add_f32 v94, v94, v134
    v_add_f32 v95, v95, v135
    s_waitcnt lgkmcnt(2)
    v_add_f32 v96, v96, v136
    v_add_f32 v97, v97, v137
    v_add_f32 v98, v98, v138
    v_add_f32 v99, v99, v139
    s_waitcnt lgkmcnt(1)
    v_add_f32 v96, v96, v140
    v_add_f32 v97, v97, v141
    v_add_f32 v98, v98, v142
    v_add_f32 v99, v99, v143
    s_waitcnt lgkmcnt(0)
    v_add_f32 v96, v96, v144
    v_add_f32 v97, v97, v145
    v_add_f32 v98, v98, v146
    v_add_f32 v99, v99, v147
    v_cvt_pk_bf16_f32 v148, v92, v93
    v_cvt_pk_bf16_f32 v149, v94, v95
    v_cvt_pk_bf16_f32 v150, v96, v97
    v_cvt_pk_bf16_f32 v151, v98, v99
    s_nop 1
    v_permlane32_swap_b32 v148, v150
    v_permlane32_swap_b32 v149, v151
    s_add_u32 s21, s19, 192
    s_nop 0
    buffer_store_dwordx4 v[148:151], v11, s[52:55], s21 offen
    ds_read_b128 v[124:127], v15 offset:12288
    ds_read_b128 v[128:131], v15 offset:14336
    ds_read_b128 v[132:135], v15 offset:16384
    ds_read_b128 v[136:139], v15 offset:13312
    ds_read_b128 v[140:143], v15 offset:15360
    ds_read_b128 v[144:147], v15 offset:17408
    s_waitcnt lgkmcnt(5)
    v_add_f32 v100, v100, v124
    v_add_f32 v101, v101, v125
    v_add_f32 v102, v102, v126
    v_add_f32 v103, v103, v127
    s_waitcnt lgkmcnt(4)
    v_add_f32 v100, v100, v128
    v_add_f32 v101, v101, v129
    v_add_f32 v102, v102, v130
    v_add_f32 v103, v103, v131
    s_waitcnt lgkmcnt(3)
    v_add_f32 v100, v100, v132
    v_add_f32 v101, v101, v133
    v_add_f32 v102, v102, v134
    v_add_f32 v103, v103, v135
    s_waitcnt lgkmcnt(2)
    v_add_f32 v104, v104, v136
    v_add_f32 v105, v105, v137
    v_add_f32 v106, v106, v138
    v_add_f32 v107, v107, v139
    s_waitcnt lgkmcnt(1)
    v_add_f32 v104, v104, v140
    v_add_f32 v105, v105, v141
    v_add_f32 v106, v106, v142
    v_add_f32 v107, v107, v143
    s_waitcnt lgkmcnt(0)
    v_add_f32 v104, v104, v144
    v_add_f32 v105, v105, v145
    v_add_f32 v106, v106, v146
    v_add_f32 v107, v107, v147
    v_cvt_pk_bf16_f32 v152, v100, v101
    v_cvt_pk_bf16_f32 v153, v102, v103
    v_cvt_pk_bf16_f32 v154, v104, v105
    v_cvt_pk_bf16_f32 v155, v106, v107
    s_nop 1
    v_permlane32_swap_b32 v152, v154
    v_permlane32_swap_b32 v153, v155
    s_add_u32 s21, s19, 224
    s_nop 0
    buffer_store_dwordx4 v[152:155], v11, s[52:55], s21 offen
    s_branch k2_kernel_GEND
k2_kernel_GX2:
    s_cmp_eq_u32 s15, 3
    s_cbranch_scc0 k2_kernel_GX3
    v_add_u32 v16, 87104, v7
    v_add_u32 v15, 117824, v7
    ds_write_b128 v16, v[44:47] offset:4096
    ds_write_b128 v16, v[48:51] offset:5120
    ds_write_b128 v16, v[52:55] offset:10240
    ds_write_b128 v16, v[56:59] offset:11264
    ds_write_b128 v16, v[60:63] offset:16384
    ds_write_b128 v16, v[64:67] offset:17408
    ds_write_b128 v16, v[68:71] offset:22528
    ds_write_b128 v16, v[72:75] offset:23552
    s_waitcnt lgkmcnt(4)
    ds_write_b128 v16, v[76:79] offset:28672
    ds_write_b128 v16, v[80:83] offset:29696
    ds_write_b128 v15, v[84:87] offset:4096
    ds_write_b128 v15, v[88:91] offset:5120
    ds_write_b128 v15, v[92:95] offset:10240
    ds_write_b128 v15, v[96:99] offset:11264
    ds_write_b128 v15, v[100:103] offset:16384
    ds_write_b128 v15, v[104:107] offset:17408
    s_waitcnt lgkmcnt(4)
    v_and_b32 v11, 31, v1
    s_lshl_b32 s19, s17, 5
    v_add_u32 v11, s19, v11
    v_mul_u32_u24 v11, 1280, v11
    v_lshrrev_b32 v13, 5, v1
    v_lshl_add_u32 v11, v13, 4, v11
    s_mul_i32 s19, s18, 320
    s_waitcnt lgkmcnt(0)
    s_barrier
    ds_read_b128 v[124:127], v15 offset:18432
    ds_read_b128 v[128:131], v15 offset:20480
    ds_read_b128 v[132:135], v15 offset:22528
    ds_read_b128 v[136:139], v15 offset:19456
    ds_read_b128 v[140:143], v15 offset:21504
    ds_read_b128 v[144:147], v15 offset:23552
    s_waitcnt lgkmcnt(5)
    v_add_f32 v108, v108, v124
    v_add_f32 v109, v109, v125
    v_add_f32 v110, v110, v126
    v_add_f32 v111, v111, v127
    s_waitcnt lgkmcnt(4)
    v_add_f32 v108, v108, v128
    v_add_f32 v109, v109, v129
    v_add_f32 v110, v110, v130
    v_add_f32 v111, v111, v131
    s_waitcnt lgkmcnt(3)
    v_add_f32 v108, v108, v132
    v_add_f32 v109, v109, v133
    v_add_f32 v110, v110, v134
    v_add_f32 v111, v111, v135
    s_waitcnt lgkmcnt(2)
    v_add_f32 v112, v112, v136
    v_add_f32 v113, v113, v137
    v_add_f32 v114, v114, v138
    v_add_f32 v115, v115, v139
    s_waitcnt lgkmcnt(1)
    v_add_f32 v112, v112, v140
    v_add_f32 v113, v113, v141
    v_add_f32 v114, v114, v142
    v_add_f32 v115, v115, v143
    s_waitcnt lgkmcnt(0)
    v_add_f32 v112, v112, v144
    v_add_f32 v113, v113, v145
    v_add_f32 v114, v114, v146
    v_add_f32 v115, v115, v147
    v_cvt_pk_bf16_f32 v148, v108, v109
    v_cvt_pk_bf16_f32 v149, v110, v111
    v_cvt_pk_bf16_f32 v150, v112, v113
    v_cvt_pk_bf16_f32 v151, v114, v115
    s_nop 1
    v_permlane32_swap_b32 v148, v150
    v_permlane32_swap_b32 v149, v151
    s_add_u32 s21, s19, 256
    s_nop 0
    buffer_store_dwordx4 v[148:151], v11, s[52:55], s21 offen
    ds_read_b128 v[124:127], v15 offset:24576
    ds_read_b128 v[128:131], v15 offset:26624
    ds_read_b128 v[132:135], v15 offset:28672
    ds_read_b128 v[136:139], v15 offset:25600
    ds_read_b128 v[140:143], v15 offset:27648
    ds_read_b128 v[144:147], v15 offset:29696
    s_waitcnt lgkmcnt(5)
    v_add_f32 v116, v116, v124
    v_add_f32 v117, v117, v125
    v_add_f32 v118, v118, v126
    v_add_f32 v119, v119, v127
    s_waitcnt lgkmcnt(4)
    v_add_f32 v116, v116, v128
    v_add_f32 v117, v117, v129
    v_add_f32 v118, v118, v130
    v_add_f32 v119, v119, v131
    s_waitcnt lgkmcnt(3)
    v_add_f32 v116, v116, v132
    v_add_f32 v117, v117, v133
    v_add_f32 v118, v118, v134
    v_add_f32 v119, v119, v135
    s_waitcnt lgkmcnt(2)
    v_add_f32 v120, v120, v136
    v_add_f32 v121, v121, v137
    v_add_f32 v122, v122, v138
    v_add_f32 v123, v123, v139
    s_waitcnt lgkmcnt(1)
    v_add_f32 v120, v120, v140
    v_add_f32 v121, v121, v141
    v_add_f32 v122, v122, v142
    v_add_f32 v123, v123, v143
    s_waitcnt lgkmcnt(0)
    v_add_f32 v120, v120, v144
    v_add_f32 v121, v121, v145
    v_add_f32 v122, v122, v146
    v_add_f32 v123, v123, v147
    v_cvt_pk_bf16_f32 v152, v116, v117
    v_cvt_pk_bf16_f32 v153, v118, v119
    v_cvt_pk_bf16_f32 v154, v120, v121
    v_cvt_pk_bf16_f32 v155, v122, v123
    s_nop 1
    v_permlane32_swap_b32 v152, v154
    v_permlane32_swap_b32 v153, v155
    s_add_u32 s21, s19, 288
    s_nop 0
    buffer_store_dwordx4 v[152:155], v11, s[52:55], s21 offen
    s_branch k2_kernel_GEND
k2_kernel_GX3:
k2_kernel_GEND:
    s_endpgm
k2_kernel_FIN:
k2_kernel_END:
    s_endpgm
.section .rodata,"a"
.p2align 6
.amdhsa_kernel k2_kernel
  .amdhsa_next_free_vgpr 168
  .amdhsa_next_free_sgpr 102
  .amdhsa_accum_offset 168
  .amdhsa_group_segment_fixed_size 0
  .amdhsa_kernarg_size 88
  .amdhsa_user_sgpr_count 2
  .amdhsa_user_sgpr_kernarg_segment_ptr 1
  .amdhsa_system_sgpr_workgroup_id_x 1
  .amdhsa_float_denorm_mode_32 3
.end_amdhsa_kernel
.text
```
